```python
import torch

def _softmax(x, axis=-1):
    return torch.softmax(x, dim=axis)
def _gelu(x):
    return torch.nn.functional.gelu(x, approximate="tanh")
def _silu(x):
    return torch.nn.functional.silu(x)
def _sigmoid(x):
    return torch.sigmoid(x)
def _layernorm(x, axis=-1, eps=1e-5):
    m = x.mean(dim=axis, keepdim=True)
    v = x.var(dim=axis, keepdim=True, unbiased=False)
    return (x - m) / torch.sqrt(v + eps)
def _scatter_add(tgt, idx, src, axis=0):
    return tgt.clone().index_add_(axis, idx, src)
def _segment_sum(src, seg, n):
    out = torch.zeros((n,) + src.shape[1:], dtype=src.dtype)
    return out.index_add_(0, seg, src)
def _pad(x, pw):
    flat = tuple(v for pair in reversed(pw) for v in pair)
    return torch.nn.functional.pad(x, flat)

kernel_name = 'sequential_preLN__linear_kernel_hedgehog__glu_gated_bilinear__prompt'

def setup_inputs():

    _w = (lambda a: (lambda t: t.to(torch.bfloat16) if t.is_floating_point() else t)(torch.as_tensor(a)))
    def _A_setup():
        B, S, D, H = 1, 2048, 576, 32
        Dh = D // H
        return {
            "x": _w((lambda *s: torch.randn(*s, dtype=torch.bfloat16) * 0.05)(B, S, D)),
            "wqkv": _w((lambda *s: torch.randn(*s, dtype=torch.bfloat16) * 0.2)(D, 3 * D)),
            "w_phi": _w((lambda *s: torch.randn(*s, dtype=torch.bfloat16) * 0.2)(H, Dh, Dh) * (Dh ** -0.5)),
            "wo": _w((lambda *s: torch.randn(*s, dtype=torch.bfloat16) * 0.05)(D, D)),
        }
    _A_in = _A_setup()

    def _B_setup():
        B, S, D, F = 1, 2048, 576, 4608
        return {
            "x": _w((lambda *s: torch.randn(*s, dtype=torch.bfloat16) * 0.05)(B, S, D)),
            "w_gate": _w((lambda *s: torch.randn(*s, dtype=torch.bfloat16) * 0.4)(D, F) * (D ** -0.5)),
            "w_up": _w((lambda *s: torch.randn(*s, dtype=torch.bfloat16) * 0.4)(D, F) * (D ** -0.5)),
            "w_down": _w((lambda *s: torch.randn(*s, dtype=torch.bfloat16) * 0.4)(F, D) * (F ** -0.5)),
        }
    _B_in = _B_setup()

    return {
        "A_x": _A_in["x"],
        "A_wqkv": _A_in["wqkv"],
        "A_w_phi": _A_in["w_phi"],
        "A_wo": _A_in["wo"],
        "B_x": _B_in["x"],
        "B_w_gate": _B_in["w_gate"],
        "B_w_up": _B_in["w_up"],
        "B_w_down": _B_in["w_down"],
    }

def reference(A_x, A_wqkv, A_w_phi, A_wo, B_x, B_w_gate, B_w_up, B_w_down):
    def _A_ref(x, wqkv, w_phi, wo):
        B, S, D = x.shape
        H = 32; Dh = D // H
        qkv = (lambda x, *d: x.permute(*d))((x @ wqkv).reshape(B, S, 3, H, Dh), 2, 0, 3, 1, 4)
        q, k, v = qkv[0], qkv[1], qkv[2]
        pq = torch.einsum("bhsd,hdf->bhsf", q, w_phi)
        pk = torch.einsum("bhsd,hdf->bhsf", k, w_phi)
        phi_q = torch.concatenate([_softmax(pq, axis=-1), _softmax(-pq, axis=-1)], axis=-1)
        phi_k = torch.concatenate([_softmax(pk, axis=-1), _softmax(-pk, axis=-1)], axis=-1)
        kv = torch.einsum("bhsf,bhsd->bhfd", phi_k, v)
        z  = torch.einsum("bhsf->bhf", phi_k)
        num = torch.einsum("bhqf,bhfd->bhqd", phi_q, kv)
        den = torch.einsum("bhqf,bhf->bhq", phi_q, z)[..., None] + 1e-6
        o = num / den
        return (lambda x, *d: x.permute(*d))(o, 0, 2, 1, 3).reshape(B, S, D) @ wo

    def _B_ref(x, w_gate, w_up, w_down):
        g = torch.einsum("bsd,df->bsf", x, w_gate)
        u = torch.einsum("bsd,df->bsf", x, w_up)
        h = g * u
        return torch.einsum("bsf,fd->bsd", h, w_down)

    x = A_x
    h = x + _A_ref(_layernorm(x, axis=-1), A_wqkv, A_w_phi, A_wo)
    h2 = h + _B_ref(_layernorm(h, axis=-1), B_w_gate, B_w_up, B_w_down)
    return h2
```

```asm
; @launch grid=(256,1,1) block=(256,1,1) lds=163072
.amdgcn_target "amdgcn-amd-amdhsa--gfx950"
.text
.p2align 12
.globl sequential_preLN__linear_kernel_hedgehog__glu_gated_bilinear__prompt_kernel
.p2align 8
.type sequential_preLN__linear_kernel_hedgehog__glu_gated_bilinear__prompt_kernel,@function
sequential_preLN__linear_kernel_hedgehog__glu_gated_bilinear__prompt_kernel:
s_load_dwordx8 s[4:11], s[0:1], 0
s_cmp_ge_u32 s2, 256
s_cbranch_scc1 sequential_preLN__linear_kernel_hedgehog__glu_gated_bilinear__prompt_kernel_end
s_getpc_b64 s[94:95]
sequential_preLN__linear_kernel_hedgehog__glu_gated_bilinear__prompt_kernel_pc:
s_mov_b32 s96, s94
s_and_b32 s97, s95, 0xffff
s_mov_b32 s98, code_end-sequential_preLN__linear_kernel_hedgehog__glu_gated_bilinear__prompt_kernel_pc
s_mov_b32 s99, 0x20000
v_lshrrev_b32 v84, 5, v0
v_lshlrev_b32 v69, 7, v84
s_lshr_b32 s91, s2, 3
s_lshl_b32 s91, s91, 10
buffer_load_dword a255, v69, s[96:99], s91 offen
s_add_u32 s91, s91, 32768
buffer_load_dword a255, v69, s[96:99], s91 offen
s_load_dwordx4 s[64:67], s[0:1], 72
s_load_dwordx4 s[68:71], s[0:1], 40
s_load_dwordx4 s[72:75], s[0:1], 56
v_lshrrev_b32 v84, 6, v0
v_and_b32 v1, 63, v0
v_readfirstlane_b32 s12, v84
s_and_b32 s32, s2, 1
s_lshl_b32 s32, s32, 3
s_bfe_u32 s33, s2, 0x30003
s_add_u32 s13, s32, s33
s_bfe_u32 s32, s2, 0x20001
s_lshl_b32 s32, s32, 2
s_lshr_b32 s34, s2, 6
s_add_u32 s14, s32, s34
s_add_u32 s33, s33, s34
s_mul_i32 s34, s33, 86
s_lshr_b32 s34, s34, 8
s_mul_i32 s34, s34, 3
s_sub_u32 s33, s33, s34
v_lshrrev_b32 v84, 3, v1
v_and_b32 v85, 7, v1
v_lshrrev_b32 v86, 1, v84
v_xor_b32 v85, v85, v86
v_mul_u32_u24 v84, 1152, v84
v_lshl_add_u32 v6, v85, 4, v84
v_xor_b32 v7, 64, v6
v_add_u32 v7, 8192, v7
v_add_u32 v8, 16384, v6
v_add_u32 v9, 16384, v7
s_lshl_b32 s15, s14, 2
s_add_u32 s15, s15, s12
s_mul_i32 s49, s15, 36864
s_lshl_b32 s15, s15, 1
s_mul_i32 s35, s12, 36864
s_mul_i32 s34, s13, 72
s_and_b32 s34, s34, 0xfffffff0
s_mul_i32 s37, s12, 55296
s_add_u32 s34, s34, s37
s_movk_i32 s39, 3456
s_movk_i32 s38, 1152
v_mov_b32 v4, 1073741824
v_cmp_gt_u32 vcc, 32, v1
v_add_u32 v85, 0, v1
v_mul_u32_u24 v84, 205, v85
v_lshrrev_b32 v84, 10, v84
v_mad_i32_i24 v85, v84, -5, v85
v_lshlrev_b32 v85, 4, v85
v_and_b32 v87, 1, v84
v_bfe_u32 v86, v84, 1, 2
v_lshl_add_u32 v86, v87, 2, v86
v_and_or_b32 v86, v84, 8, v86
v_mad_u32_u24 v85, v86, s39, v85
v_lshrrev_b32 v84, 4, v84
v_add_u32 v84, 1, v84
v_mad_u32_u24 v10, v84, s38, v85
v_add_u32 v85, 64, v1
v_mul_u32_u24 v84, 205, v85
v_lshrrev_b32 v84, 10, v84
v_mad_i32_i24 v85, v84, -5, v85
v_lshlrev_b32 v85, 4, v85
v_subrev_u32 v85, 1024, v85
v_and_b32 v87, 1, v84
v_bfe_u32 v86, v84, 1, 2
v_lshl_add_u32 v86, v87, 2, v86
v_and_or_b32 v86, v84, 8, v86
v_mad_u32_u24 v85, v86, s39, v85
v_lshrrev_b32 v84, 4, v84
v_add_u32 v84, 1, v84
v_mad_u32_u24 v11, v84, s38, v85
v_add_u32 v85, 128, v1
v_mul_u32_u24 v84, 205, v85
v_lshrrev_b32 v84, 10, v84
v_mad_i32_i24 v85, v84, -5, v85
v_lshlrev_b32 v85, 4, v85
v_subrev_u32 v85, 2048, v85
v_and_b32 v87, 1, v84
v_bfe_u32 v86, v84, 1, 2
v_lshl_add_u32 v86, v87, 2, v86
v_and_or_b32 v86, v84, 8, v86
v_mad_u32_u24 v85, v86, s39, v85
v_lshrrev_b32 v84, 4, v84
v_add_u32 v84, 1, v84
v_mad_u32_u24 v12, v84, s38, v85
v_cndmask_b32 v12, v4, v12, vcc
s_mul_i32 s40, s33, 221184
s_add_u32 s40, s40, s34
s_lshl_b32 s32, s33, 7
s_add_u32 s32, s32, s49
s_waitcnt lgkmcnt(0)
s_mov_b32 s16, s4
s_and_b32 s17, s5, 0xffff
s_mov_b32 s18, 2359296
s_mov_b32 s19, 0x20000
s_add_u32 m0, s35, 24576
s_nop 0
buffer_load_dwordx4 v6, s[16:19], s32 offen offset:0 sc1 lds
buffer_load_dwordx4 v7, s[16:19], s32 offen offset:1024 sc1 lds
buffer_load_dwordx4 v8, s[16:19], s32 offen offset:2048 sc1 lds
buffer_load_dwordx4 v9, s[16:19], s32 offen offset:3072 sc1 lds
s_mov_b32 s20, s6
s_and_b32 s21, s7, 0xffff
s_mov_b32 s22, 1990656
s_mov_b32 s23, 0x20000
s_add_u32 m0, s35, 0
s_nop 0
buffer_load_dwordx4 v10, s[20:23], s40 offen offset:0 sc1 lds
buffer_load_dwordx4 v11, s[20:23], s40 offen offset:1024 sc1 lds
buffer_load_dwordx4 v12, s[20:23], s40 offen offset:2048 sc1 lds
s_add_u32 s33, s33, 1
s_cmp_eq_u32 s33, 3
s_cselect_b32 s33, 0, s33
s_mov_b32 s56, s8
s_and_b32 s57, s9, 0xffff
s_mov_b32 s58, 20736
s_mov_b32 s59, 0x20000
v_lshlrev_b32 v84, 3, v0
v_cmp_gt_u32 vcc, 162, v0
s_mul_i32 s37, s13, 1296
v_lshlrev_b32 v5, 4, v1
v_cndmask_b32 v84, v4, v84, vcc
buffer_load_dwordx2 v[80:81], v84, s[56:59], s37 offen
s_mov_b32 s28, s66
s_and_b32 s29, s67, 0xffff
s_mov_b32 s30, 268435456
s_mov_b32 s31, 0x20000
s_mov_b32 s24, s64
s_and_b32 s25, s65, 0xffff
s_mov_b32 s26, 256
s_mov_b32 s27, 0x20000
s_mov_b32 s60, s10
s_and_b32 s61, s11, 0xffff
s_mov_b32 s62, 663552
s_mov_b32 s63, 0x20000
s_mov_b64 s[64:65], s[74:75]
v_mov_b32 v88, 0
v_mov_b32 v89, 0
v_mov_b32 v90, 0
v_mov_b32 v91, 0
v_lshlrev_b32 v84, 4, v0
v_add_u32 v84, 147456, v84
v_min_u32 v85, 148848, v84
ds_write_b128 v84, v[88:91]
ds_write_b128 v85, v[88:91] offset:4096
v_and_b32 v2, 15, v1
v_lshrrev_b32 v3, 4, v1
s_mov_b32 s37, 0x3f803f80
v_accvgpr_write_b32 a144, s37
v_accvgpr_write_b32 a145, s37
v_accvgpr_write_b32 a146, s37
v_accvgpr_write_b32 a147, s37
v_lshrrev_b32 v84, 1, v2
v_xor_b32 v84, v84, v3
v_lshlrev_b32 v84, 4, v84
v_lshl_add_u32 v84, v2, 7, v84
v_add_u32 v15, s35, v84
v_xor_b32 v16, 64, v15
s_and_b32 s36, s13, 1
s_lshl_b32 s36, s36, 3
v_bfe_u32 v84, v1, 2, 3
v_mul_u32_u24 v84, 160, v84
v_lshrrev_b32 v85, 5, v1
v_mul_u32_u24 v85, 36864, v85
v_add3_u32 v84, v84, v85, s36
v_and_b32 v85, 3, v1
v_lshl_add_u32 v17, v85, 3, v84
v_add_u32 v23, 64, v84
v_cmp_eq_u32 vcc, 1, v85
v_add_u32 v84, 1344, v84
s_and_b32 s51, s12, 1
s_lshr_b32 s52, s12, 1
s_lshl_b32 s37, s51, 5
s_mul_i32 s53, s52, 1280
v_cndmask_b32 v19, v23, v84, vcc
s_add_u32 s53, s53, s37
v_add_u32 v21, s53, v17
v_add_u32 v18, 73728, v17
v_add_u32 v20, 73728, v19
v_add_u32 v22, 73728, v21
v_cmp_gt_u32 vcc, 2, v85
s_sub_u32 s37, 156808, s36
v_mov_b32 v84, s37
v_mov_b32 v86, 2560
v_cndmask_b32 v19, v84, v19, vcc
v_cndmask_b32 v20, v84, v20, vcc
v_cndmask_b32 v78, 0, v86, vcc
v_and_b32 v86, 0x70, v5
v_add_u32 v84, 156800, v86
ds_write_b128 v84, a[144:147]
s_lshr_b32 s54, s13, 3
s_xor_b32 s54, s54, s13
s_and_b32 s54, s54, 1
v_subrev_u32 v13, 1152, v10
v_cmp_gt_u32 vcc, 16, v1
v_subrev_u32 v92, 1152, v11
v_lshlrev_b32 v49, 2, v2
v_cndmask_b32 v14, v4, v92, vcc
v_lshlrev_b32 v92, 3, v2
v_cndmask_b32 v67, v4, v92, vcc
v_accvgpr_write_b32 a154, 0
v_accvgpr_write_b32 a155, 0
v_accvgpr_write_b32 a162, 0
v_accvgpr_write_b32 a163, 0
v_accvgpr_write_b32 a170, 0
v_accvgpr_write_b32 a171, 0
v_mov_b32 v154, 0
v_mov_b32 v155, 0
v_mov_b32 v174, 0
v_mov_b32 v175, 0
v_mov_b32 v162, 0
v_mov_b32 v163, 0
v_mov_b32 v186, 0
v_mov_b32 v187, 0
v_and_b32 v92, 3, v2
v_cmp_eq_u32 s[74:75], 1, v92
v_cmp_eq_u32 s[76:77], 2, v92
v_cmp_eq_u32 s[78:79], 3, v92
v_lshrrev_b32 v93, 2, v2
v_lshl_add_u32 v93, v93, 4, v2
v_lshlrev_b32 v31, 2, v93
s_lshl_b32 s55, s12, 6
s_add_u32 s55, s55, 152960
v_add_u32 v32, s55, v49
s_min_u32 s55, s55, 153088
v_add_u32 v33, s55, v49
v_lshlrev_b32 v34, 4, v3
v_add_u32 v34, 152960, v34
v_lshrrev_b32 v84, 3, v0
v_min_u32 v84, 17, v84
v_mul_u32_u24 v84, 3456, v84
s_lshr_b32 s37, s2, 3
s_mul_i32 s37, s37, 62208
s_add_u32 s37, s37, 512
buffer_load_dword a255, v84, s[20:23], s37 offen
s_mul_i32 s41, s33, 221184
s_add_u32 s41, s41, s34
s_lshl_b32 s32, s33, 7
s_add_u32 s32, s32, s49
s_add_u32 m0, s35, 28672
s_nop 0
buffer_load_dwordx4 v6, s[16:19], s32 offen offset:0 sc1 lds
buffer_load_dwordx4 v7, s[16:19], s32 offen offset:1024 sc1 lds
buffer_load_dwordx4 v8, s[16:19], s32 offen offset:2048 sc1 lds
buffer_load_dwordx4 v9, s[16:19], s32 offen offset:3072 sc1 lds
s_add_u32 m0, s35, 2560
s_nop 0
buffer_load_dwordx4 v10, s[20:23], s41 offen offset:0 sc1 lds
buffer_load_dwordx4 v11, s[20:23], s41 offen offset:1024 sc1 lds
buffer_load_dwordx4 v12, s[20:23], s41 offen offset:2048 sc1 lds
s_add_u32 s33, s33, 1
s_cmp_eq_u32 s33, 3
s_cselect_b32 s33, 0, s33
s_lshr_b32 s4, s2, 3
s_lshl_b32 s4, s4, 2
s_add_u32 s4, s4, s12
s_mul_i32 s5, s4, 1821
s_lshr_b32 s5, s5, 16
s_mul_i32 s6, s5, 36
s_sub_u32 s6, s4, s6
s_and_b32 s7, s2, 7
s_lshr_b32 s8, s6, 1
s_mul_i32 s8, s8, 36
s_and_b32 s9, s6, 1
s_lshl_b32 s9, s9, 4
s_add_u32 s8, s8, s9
s_mul_i32 s9, s6, 144
s_sub_u32 s9, s9, 4576
s_cmp_ge_u32 s6, 32
s_cselect_b32 s8, s9, s8
s_cselect_b32 s9, 32, 0
s_cmp_eq_u32 s5, 0
s_cselect_b32 s56, s68, s70
s_cselect_b32 s57, s69, s71
s_lshl_b32 s10, s6, 4
s_movk_i32 s11, 9216
s_cmp_ge_u32 s5, 2
s_cselect_b32 s56, s72, s56
s_cselect_b32 s57, s73, s57
s_cselect_b32 s8, s10, s8
s_cselect_b32 s9, 0, s9
s_cselect_b32 s11, s38, s11
s_cselect_b32 s10, 663552, s38
s_and_b32 s57, s57, 0xffff
s_mov_b32 s58, 5308416
s_mul_i32 s10, s10, s7
s_mul_i32 s8, s8, s11
s_add_u32 s8, s8, s10
s_add_u32 s8, s8, 1024
v_lshrrev_b32 v92, 1, v2
v_lshrrev_b32 v93, 3, v2
v_mad_u32_u24 v92, v93, s9, v92
v_mul_lo_u32 v92, v92, s11
s_lshl_b32 s9, s9, 1
s_add_u32 s9, s9, 8
s_mul_i32 s9, s9, s11
s_add_u32 s9, s9, s8
v_and_b32 v93, 1, v1
v_lshl_add_u32 v93, v3, 1, v93
v_lshl_add_u32 v70, v93, 4, v92
s_mul_i32 s10, s7, 221184
s_mul_i32 s5, s5, 18432
s_add_u32 s10, s10, s5
s_lshl_b32 s6, s6, 9
s_add_u32 s10, s10, s6
s_add_u32 s10, s10, 14680064
s_cmp_ge_u32 s4, 108
s_cselect_b32 s10, 1073741824, s10
s_cmp_lt_u32 s4, 64
s_cselect_b32 s96, s68, s70
s_cselect_b32 s97, s69, s71
s_and_b32 s97, s97, 0xffff
s_mov_b32 s98, 5308416
s_mov_b32 s99, 0x20000
s_and_b32 s11, s4, 63
s_mul_i32 s11, s11, 82944
s_mul_i32 s7, s7, 1152
s_add_u32 s11, s11, s7
v_min_u32 v92, 35, v1
v_lshrrev_b32 v93, 2, v92
v_mul_u32_u24 v93, 68, v93
v_add_lshl_u32 v69, v92, v93, 7
s_cmp_eq_u32 s12, 0
s_cbranch_scc1 ipad0
s_cmp_eq_u32 s12, 1
s_cbranch_scc1 ipad1
s_cmp_eq_u32 s12, 2
s_cbranch_scc1 ipad2
s_branch ipad3
s_nop 0
iret0:
s_waitcnt vmcnt(9) lgkmcnt(0)
s_barrier
v_mov_b32 v88, 0
v_mov_b32 v89, 0
v_mov_b32 v90, 0
v_mov_b32 v91, 0
s_lshl_b32 s3, s2, 2
s_add_u32 s3, s3, s12
s_lshl_b32 s3, s3, 10
s_add_u32 s3, s3, 10485760
s_lshr_b32 s50, s2, 5
s_xor_b32 s50, s50, 7
s_or_b32 s50, s50, s54
s_cbranch_scc1 sequential_preLN__linear_kernel_hedgehog__glu_gated_bilinear__prompt_kernel_nz
s_and_b32 s91, s2, 7
s_lshl_b32 s91, s91, 1
s_bfe_u32 s37, s2, 0x10004
s_add_u32 s91, s91, s37
s_lshl_b32 s91, s91, 2
s_add_u32 s37, s91, s12
s_mul_i32 s37, s37, 3072
s_add_u32 s37, s37, 13631488
buffer_store_dwordx4 v[88:91], v5, s[28:31], s37 offen offset:0 sc1
buffer_store_dwordx4 v[88:91], v5, s[28:31], s37 offen offset:1024 sc1
buffer_store_dwordx4 v[88:91], v5, s[28:31], s37 offen offset:2048 sc1
sequential_preLN__linear_kernel_hedgehog__glu_gated_bilinear__prompt_kernel_nz:
s_xor_b32 s37, s12, 3
s_or_b32 s37, s37, s54
s_lshl_b32 s37, s37, 4
s_lshr_b32 s90, s2, 4
s_add_u32 s90, s90, s37
s_cmp_ge_u32 s90, 9
s_cbranch_scc1 sequential_preLN__linear_kernel_hedgehog__glu_gated_bilinear__prompt_kernel_ns0
s_and_b32 s92, s2, 7
s_mul_i32 s92, s92, 9
s_add_u32 s92, s92, s90
s_lshr_b32 s37, s92, 1
s_mul_i32 s37, s37, 18
s_and_b32 s93, s92, 1
s_lshl_b32 s93, s93, 3
s_add_u32 s37, s37, s93
s_mul_i32 s93, s92, 72
s_sub_u32 s93, s93, 4592
s_cmp_ge_u32 s92, 64
s_cselect_b32 s37, s93, s37
s_cselect_b32 s93, 16, 0
s_mul_i32 s37, s37, 1152
v_lshrrev_b32 v85, 3, v1
v_mad_u32_u24 v85, v3, s93, v85
v_mul_u32_u24 v85, 1152, v85
v_and_b32 v86, 7, v1
v_lshl_add_u32 v85, v86, 4, v85
buffer_load_dwordx4 v[212:215], v85, s[60:63], s37 offen offset:0
buffer_load_dwordx4 v[216:219], v85, s[60:63], s37 offen offset:128
buffer_load_dwordx4 v[220:223], v85, s[60:63], s37 offen offset:256
buffer_load_dwordx4 v[224:227], v85, s[60:63], s37 offen offset:384
buffer_load_dwordx4 v[228:231], v85, s[60:63], s37 offen offset:512
buffer_load_dwordx4 v[232:235], v85, s[60:63], s37 offen offset:640
buffer_load_dwordx4 v[236:239], v85, s[60:63], s37 offen offset:768
buffer_load_dwordx4 v[240:243], v85, s[60:63], s37 offen offset:896
buffer_load_dwordx4 v[244:247], v85, s[60:63], s37 offen offset:1024
sequential_preLN__linear_kernel_hedgehog__glu_gated_bilinear__prompt_kernel_ns0:
ds_read_b128 a[0:3], v15 offset:24576
ds_read_b128 a[4:7], v15 offset:26624
ds_read_b64_tr_b16 a[180:181], v21 offset:0
ds_read_b64_tr_b16 a[182:183], v21 offset:80
ds_read_b64_tr_b16 a[184:185], v19 offset:0
ds_read_b64_tr_b16 a[186:187], v19 offset:80
ds_read_b64_tr_b16 a[188:189], v17 offset:0
ds_read_b64_tr_b16 a[190:191], v17 offset:80
ds_read_b64_tr_b16 a[192:193], v17 offset:32
ds_read_b64_tr_b16 a[194:195], v17 offset:112
ds_read_b64_tr_b16 a[196:197], v17 offset:1280
ds_read_b64_tr_b16 a[198:199], v17 offset:1360
ds_read_b64_tr_b16 a[200:201], v17 offset:1312
ds_read_b64_tr_b16 a[202:203], v17 offset:1392
s_mul_i32 s42, s33, 221184
s_add_u32 s42, s42, s34
s_lshl_b32 s32, s33, 7
s_add_u32 s32, s32, s49
s_add_u32 m0, s35, 32768
s_nop 0
buffer_load_dwordx4 v6, s[16:19], s32 offen offset:0 sc1 lds
buffer_load_dwordx4 v7, s[16:19], s32 offen offset:1024 sc1 lds
buffer_load_dwordx4 v8, s[16:19], s32 offen offset:2048 sc1 lds
buffer_load_dwordx4 v9, s[16:19], s32 offen offset:3072 sc1 lds
s_add_u32 m0, s35, 5120
s_nop 0
buffer_load_dwordx4 v10, s[20:23], s42 offen offset:0 sc1 lds
buffer_load_dwordx4 v11, s[20:23], s42 offen offset:1024 sc1 lds
buffer_load_dwordx4 v12, s[20:23], s42 offen offset:2048 sc1 lds
s_add_u32 s33, s33, 1
s_cmp_eq_u32 s33, 3
s_cselect_b32 s33, 0, s33
s_add_u32 s33, s33, 3
s_waitcnt lgkmcnt(8)
v_mfma_f32_16x16x32_bf16 v[196:199], a[0:3], a[0:3], 0
ds_read_b128 a[8:11], v16 offset:24576
v_add_u32 v19, v78, v19
v_min_u32 v96, 162, v0
v_mfma_f32_16x16x32_bf16 v[200:203], a[4:7], a[4:7], 0
ds_read_b128 a[12:15], v16 offset:26624
v_lshl_add_u32 v96, v96, 1, 0
v_mfma_f32_16x16x32_bf16 v[208:211], a[144:147], a[180:183], 0
ds_read_b64_tr_b16 a[204:205], v22 offset:0
v_mul_u32_u24 v92, 7282, v96
v_lshrrev_b32 v92, 16, v92
v_mfma_f32_16x16x32_bf16 v[204:207], a[184:187], a[144:147], 0
ds_read_b64_tr_b16 a[206:207], v22 offset:80
v_mad_i32_i24 v93, v92, -9, v96
v_mfma_f32_16x16x32_bf16 v[132:135], a[184:187], a[0:3], 0
ds_read_b64_tr_b16 a[208:209], v20 offset:0
v_lshlrev_b32 v93, 1, v93
v_cmp_le_u32 vcc, 18, v92
v_mfma_f32_16x16x32_bf16 v[144:147], a[184:187], a[4:7], 0
s_waitcnt lgkmcnt(9)
ds_read_b64_tr_b16 a[210:211], v20 offset:80
v_mul_u32_u24 v94, 96, v92
v_mfma_f32_16x16x32_bf16 v[112:115], a[188:191], a[4:7], 0
ds_read_b64_tr_b16 a[212:213], v18 offset:0
v_add_u32 v94, 147456, v94
v_cndmask_b32 v95, 0, 16, vcc
v_mfma_f32_16x16x32_bf16 v[100:103], a[188:191], a[0:3], 0
ds_read_b64_tr_b16 a[214:215], v18 offset:80
v_add_u32 v94, v94, v95
v_mfma_f32_16x16x32_bf16 v[104:107], a[192:195], a[0:3], 0
ds_read_b64_tr_b16 a[216:217], v18 offset:32
v_add_u32 v95, 0, v93
v_cmp_le_u32 vcc, 9, v95
v_mfma_f32_16x16x32_bf16 v[116:119], a[192:195], a[4:7], 0
s_waitcnt lgkmcnt(9)
ds_read_b64_tr_b16 a[218:219], v18 offset:112
v_subrev_u32 v97, 9, v95
v_mfma_f32_16x16x32_bf16 v[136:139], a[196:199], a[4:7], 0
ds_read_b64_tr_b16 a[220:221], v18 offset:1280
v_cndmask_b32 v95, v95, v97, vcc
v_cndmask_b32 v97, 0, 8, vcc
v_mfma_f32_16x16x32_bf16 v[124:127], a[196:199], a[0:3], 0
ds_read_b64_tr_b16 a[222:223], v18 offset:1360
v_lshrrev_b32 v98, 2, v95
v_mfma_f32_16x16x32_bf16 v[128:131], a[200:203], a[0:3], 0
ds_read_b64_tr_b16 a[224:225], v18 offset:1312
v_and_b32 v95, 3, v95
v_lshl_add_u32 v97, v98, 5, v97
v_mfma_f32_16x16x32_bf16 v[140:143], a[200:203], a[4:7], 0
s_waitcnt lgkmcnt(7)
ds_read_b64_tr_b16 a[226:227], v18 offset:1392
v_lshl_add_u32 v97, v95, 1, v97
s_waitcnt vmcnt(7)
s_barrier
v_mfma_f32_16x16x32_bf16 v[196:199], a[8:11], a[8:11], v[196:199]
ds_read_b128 a[16:19], v15 offset:28672
v_add_u32 v20, v78, v20
s_mul_i32 s43, s33, 221184
v_mfma_f32_16x16x32_bf16 v[200:203], a[12:15], a[12:15], v[200:203]
s_add_u32 s43, s43, s34
ds_read_b128 a[20:23], v15 offset:30720
s_lshl_b32 s32, s33, 7
v_mfma_f32_16x16x32_bf16 v[208:211], a[144:147], a[204:207], v[208:211]
s_add_u32 s32, s32, s49
ds_read_b64_tr_b16 a[180:181], v21 offset:2560
s_add_u32 m0, s35, 24576
v_add_u32 v97, v94, v97
v_mfma_f32_16x16x32_bf16 v[204:207], a[208:211], a[144:147], v[204:207]
buffer_load_dwordx4 v6, s[16:19], s32 offen offset:0 sc1 lds
ds_read_b64_tr_b16 a[182:183], v21 offset:2640
v_mfma_f32_16x16x32_bf16 v[132:135], a[208:211], a[8:11], v[132:135]
ds_read_b64_tr_b16 a[184:185], v19 offset:0
ds_write_b16 v97, v80
v_add_u32 v95, 1, v93
v_mfma_f32_16x16x32_bf16 v[144:147], a[208:211], a[12:15], v[144:147]
s_waitcnt lgkmcnt(10)
ds_read_b64_tr_b16 a[186:187], v19 offset:80
s_branch iskip0
.p2align 12
ipad0:
s_branch iret0
iskip0:
v_cmp_le_u32 vcc, 9, v95
v_mfma_f32_16x16x32_bf16 v[112:115], a[212:215], a[12:15], v[112:115]
ds_read_b64_tr_b16 a[188:189], v17 offset:2560
v_subrev_u32 v97, 9, v95
v_cndmask_b32 v95, v95, v97, vcc
v_mfma_f32_16x16x32_bf16 v[100:103], a[212:215], a[8:11], v[100:103]
buffer_load_dwordx4 v7, s[16:19], s32 offen offset:1024 sc1 lds
ds_read_b64_tr_b16 a[190:191], v17 offset:2640
v_mfma_f32_16x16x32_bf16 v[104:107], a[216:219], a[8:11], v[104:107]
ds_read_b64_tr_b16 a[192:193], v17 offset:2592
v_cndmask_b32 v97, 0, 8, vcc
v_lshrrev_b32 v98, 2, v95
v_mfma_f32_16x16x32_bf16 v[116:119], a[216:219], a[12:15], v[116:119]
s_waitcnt lgkmcnt(10)
ds_read_b64_tr_b16 a[194:195], v17 offset:2672
v_and_b32 v95, 3, v95
v_mfma_f32_16x16x32_bf16 v[136:139], a[220:223], a[12:15], v[136:139]
ds_read_b64_tr_b16 a[196:197], v17 offset:3840
v_lshl_add_u32 v97, v98, 5, v97
v_lshl_add_u32 v97, v95, 1, v97
v_mfma_f32_16x16x32_bf16 v[124:127], a[220:223], a[8:11], v[124:127]
buffer_load_dwordx4 v8, s[16:19], s32 offen offset:2048 sc1 lds
ds_read_b64_tr_b16 a[198:199], v17 offset:3920
v_mfma_f32_16x16x32_bf16 v[128:131], a[224:227], a[8:11], v[128:131]
ds_read_b64_tr_b16 a[200:201], v17 offset:3872
v_add_u32 v97, v94, v97
ds_write_b16_d16_hi v97, v80
v_mfma_f32_16x16x32_bf16 v[140:143], a[224:227], a[12:15], v[140:143]
s_waitcnt lgkmcnt(8)
ds_read_b64_tr_b16 a[202:203], v17 offset:3952
v_min_u32 v96, 162, v0
v_mfma_f32_16x16x32_bf16 v[196:199], a[16:19], a[16:19], v[196:199]
ds_read_b128 a[24:27], v16 offset:28672
v_add_u32 v19, v78, v19
v_lshl_add_u32 v96, v96, 1, 1
v_mfma_f32_16x16x32_bf16 v[200:203], a[20:23], a[20:23], v[200:203]
buffer_load_dwordx4 v9, s[16:19], s32 offen offset:3072 sc1 lds
ds_read_b128 a[28:31], v16 offset:30720
v_mfma_f32_16x16x32_bf16 v[208:211], a[144:147], a[180:183], v[208:211]
s_add_u32 m0, s35, 7680
ds_read_b64_tr_b16 a[204:205], v22 offset:2560
v_mul_u32_u24 v92, 7282, v96
v_lshrrev_b32 v92, 16, v92
v_mfma_f32_16x16x32_bf16 v[204:207], a[184:187], a[144:147], v[204:207]
ds_read_b64_tr_b16 a[206:207], v22 offset:2640
v_mad_i32_i24 v93, v92, -9, v96
v_mfma_f32_16x16x32_bf16 v[132:135], a[184:187], a[16:19], v[132:135]
ds_read_b64_tr_b16 a[208:209], v20 offset:0
v_lshlrev_b32 v93, 1, v93
v_cmp_le_u32 vcc, 18, v92
v_mfma_f32_16x16x32_bf16 v[144:147], a[184:187], a[20:23], v[144:147]
s_waitcnt lgkmcnt(10)
buffer_load_dwordx4 v10, s[20:23], s43 offen offset:0 sc1 lds
ds_read_b64_tr_b16 a[210:211], v20 offset:80
v_mfma_f32_16x16x32_bf16 v[112:115], a[188:191], a[20:23], v[112:115]
ds_read_b64_tr_b16 a[212:213], v18 offset:2560
v_mul_u32_u24 v94, 96, v92
v_add_u32 v94, 147456, v94
v_mfma_f32_16x16x32_bf16 v[100:103], a[188:191], a[16:19], v[100:103]
ds_read_b64_tr_b16 a[214:215], v18 offset:2640
v_cndmask_b32 v95, 0, 16, vcc
v_mfma_f32_16x16x32_bf16 v[104:107], a[192:195], a[16:19], v[104:107]
ds_read_b64_tr_b16 a[216:217], v18 offset:2592
v_add_u32 v94, v94, v95
v_add_u32 v95, 0, v93
v_mfma_f32_16x16x32_bf16 v[116:119], a[192:195], a[20:23], v[116:119]
s_waitcnt lgkmcnt(9)
buffer_load_dwordx4 v11, s[20:23], s43 offen offset:1024 sc1 lds
ds_read_b64_tr_b16 a[218:219], v18 offset:2672
v_mfma_f32_16x16x32_bf16 v[136:139], a[196:199], a[20:23], v[136:139]
ds_read_b64_tr_b16 a[220:221], v18 offset:3840
v_cmp_le_u32 vcc, 9, v95
v_subrev_u32 v97, 9, v95
v_mfma_f32_16x16x32_bf16 v[124:127], a[196:199], a[16:19], v[124:127]
ds_read_b64_tr_b16 a[222:223], v18 offset:3920
v_cndmask_b32 v95, v95, v97, vcc
v_mfma_f32_16x16x32_bf16 v[128:131], a[200:203], a[16:19], v[128:131]
ds_read_b64_tr_b16 a[224:225], v18 offset:3872
v_cndmask_b32 v97, 0, 8, vcc
v_lshrrev_b32 v98, 2, v95
v_mfma_f32_16x16x32_bf16 v[140:143], a[200:203], a[20:23], v[140:143]
s_waitcnt lgkmcnt(7)
buffer_load_dwordx4 v12, s[20:23], s43 offen offset:2048 sc1 lds
ds_read_b64_tr_b16 a[226:227], v18 offset:3952
s_waitcnt vmcnt(7)
s_barrier
s_or_b32 s37, s50, s12
s_cbranch_scc1 sequential_preLN__linear_kernel_hedgehog__glu_gated_bilinear__prompt_kernel_nrdy
v_min_u32 v84, 1, v0
v_lshlrev_b32 v84, 30, v84
v_mov_b32 v85, 1
buffer_store_dword v85, v84, s[24:27], s91 offen sc1
sequential_preLN__linear_kernel_hedgehog__glu_gated_bilinear__prompt_kernel_nrdy:
s_cmp_ge_u32 s90, 9
s_cbranch_scc1 sequential_preLN__linear_kernel_hedgehog__glu_gated_bilinear__prompt_kernel_nr1
s_mov_b32 s37, 0x3f803f80
v_mov_b32 v88, 0
v_dot2c_f32_bf16 v88, s37, v212
v_dot2c_f32_bf16 v88, s37, v213
v_dot2c_f32_bf16 v88, s37, v214
v_dot2c_f32_bf16 v88, s37, v215
v_dot2c_f32_bf16 v88, s37, v216
v_dot2c_f32_bf16 v88, s37, v217
v_dot2c_f32_bf16 v88, s37, v218
v_dot2c_f32_bf16 v88, s37, v219
v_dot2c_f32_bf16 v88, s37, v220
v_dot2c_f32_bf16 v88, s37, v221
v_dot2c_f32_bf16 v88, s37, v222
v_dot2c_f32_bf16 v88, s37, v223
v_dot2c_f32_bf16 v88, s37, v224
v_dot2c_f32_bf16 v88, s37, v225
v_dot2c_f32_bf16 v88, s37, v226
v_dot2c_f32_bf16 v88, s37, v227
v_dot2c_f32_bf16 v88, s37, v228
v_dot2c_f32_bf16 v88, s37, v229
v_dot2c_f32_bf16 v88, s37, v230
v_dot2c_f32_bf16 v88, s37, v231
v_dot2c_f32_bf16 v88, s37, v232
v_dot2c_f32_bf16 v88, s37, v233
v_dot2c_f32_bf16 v88, s37, v234
v_dot2c_f32_bf16 v88, s37, v235
v_dot2c_f32_bf16 v88, s37, v236
v_dot2c_f32_bf16 v88, s37, v237
v_dot2c_f32_bf16 v88, s37, v238
v_dot2c_f32_bf16 v88, s37, v239
v_dot2c_f32_bf16 v88, s37, v240
v_dot2c_f32_bf16 v88, s37, v241
v_dot2c_f32_bf16 v88, s37, v242
v_dot2c_f32_bf16 v88, s37, v243
v_dot2c_f32_bf16 v88, s37, v244
v_dot2c_f32_bf16 v88, s37, v245
v_dot2c_f32_bf16 v88, s37, v246
v_dot2c_f32_bf16 v88, s37, v247
s_nop 2
v_add_f32_dpp v88, v88, v88 quad_perm:[1,0,3,2] row_mask:0xf bank_mask:0xf
s_nop 1
v_add_f32_dpp v88, v88, v88 quad_perm:[2,3,0,1] row_mask:0xf bank_mask:0xf
s_nop 1
v_add_f32_dpp v88, v88, v88 row_half_mirror row_mask:0xf bank_mask:0xf
v_mul_f32 v88, 0x3ae38e39, v88
v_cvt_pk_bf16_f32 v89, v88, v88
v_and_b32 v90, 0xffff0000, v89
v_sub_f32 v90, v88, v90
v_cvt_pk_bf16_f32 v88, v88, v90
v_mov_b32 v89, 0
v_and_b32 v84, 7, v1
v_cmp_eq_u32 s[94:95], 0, v84
v_lshrrev_b32 v85, 5, v1
v_mul_u32_u24 v85, 48, v85
v_add_u32 v85, v85, v1
v_cndmask_b32 v85, v4, v85, s[94:95]
s_lshr_b32 s37, s92, 1
s_mul_i32 s37, s37, 160
s_and_b32 s93, s92, 1
s_lshl_b32 s93, s93, 5
s_add_u32 s37, s37, s93
s_add_u32 s37, s37, 12648448
buffer_store_dwordx2 v[88:89], v85, s[28:31], s37 offen sc1
sequential_preLN__linear_kernel_hedgehog__glu_gated_bilinear__prompt_kernel_nr1:
v_mfma_f32_16x16x32_bf16 v[196:199], a[24:27], a[24:27], v[196:199]
ds_read_b128 a[32:35], v15 offset:32768
v_add_u32 v20, v78, v20
s_add_u32 s33, s33, 1
v_mfma_f32_16x16x32_bf16 v[200:203], a[28:31], a[28:31], v[200:203]
s_cmp_eq_u32 s33, 6
s_cselect_b32 s33, 3, s33
ds_read_b128 a[36:39], v15 offset:34816
v_mfma_f32_16x16x32_bf16 v[208:211], a[144:147], a[204:207], v[208:211]
s_mul_i32 s44, s33, 221184
ds_read_b64_tr_b16 a[180:181], v21 offset:5120
s_add_u32 s44, s44, s34
s_lshl_b32 s32, s33, 7
v_mfma_f32_16x16x32_bf16 v[204:207], a[208:211], a[144:147], v[204:207]
s_add_u32 s32, s32, s49
ds_read_b64_tr_b16 a[182:183], v21 offset:5200
s_add_u32 m0, s35, 28672
v_mfma_f32_16x16x32_bf16 v[132:135], a[208:211], a[24:27], v[132:135]
buffer_load_dwordx4 v6, s[16:19], s32 offen offset:0 sc1 lds
ds_read_b64_tr_b16 a[184:185], v19 offset:0
v_mfma_f32_16x16x32_bf16 v[144:147], a[208:211], a[28:31], v[144:147]
s_waitcnt lgkmcnt(9)
ds_read_b64_tr_b16 a[186:187], v19 offset:80
v_and_b32 v95, 3, v95
v_mfma_f32_16x16x32_bf16 v[112:115], a[212:215], a[28:31], v[112:115]
ds_read_b64_tr_b16 a[188:189], v17 offset:5120
v_lshl_add_u32 v97, v98, 5, v97
v_lshl_add_u32 v97, v95, 1, v97
v_mfma_f32_16x16x32_bf16 v[100:103], a[212:215], a[24:27], v[100:103]
ds_read_b64_tr_b16 a[190:191], v17 offset:5200
v_add_u32 v97, v94, v97
v_mfma_f32_16x16x32_bf16 v[104:107], a[216:219], a[24:27], v[104:107]
buffer_load_dwordx4 v7, s[16:19], s32 offen offset:1024 sc1 lds
ds_read_b64_tr_b16 a[192:193], v17 offset:5152
v_mfma_f32_16x16x32_bf16 v[116:119], a[216:219], a[28:31], v[116:119]
s_waitcnt lgkmcnt(9)
ds_read_b64_tr_b16 a[194:195], v17 offset:5232
ds_write_b16 v97, v81
v_mfma_f32_16x16x32_bf16 v[136:139], a[220:223], a[28:31], v[136:139]
ds_read_b64_tr_b16 a[196:197], v17 offset:6400
v_add_u32 v95, 1, v93
v_cmp_le_u32 vcc, 9, v95
v_mfma_f32_16x16x32_bf16 v[124:127], a[220:223], a[24:27], v[124:127]
ds_read_b64_tr_b16 a[198:199], v17 offset:6480
v_subrev_u32 v97, 9, v95
v_mfma_f32_16x16x32_bf16 v[128:131], a[224:227], a[24:27], v[128:131]
buffer_load_dwordx4 v8, s[16:19], s32 offen offset:2048 sc1 lds
ds_read_b64_tr_b16 a[200:201], v17 offset:6432
v_mfma_f32_16x16x32_bf16 v[140:143], a[224:227], a[28:31], v[140:143]
s_waitcnt lgkmcnt(8)
ds_read_b64_tr_b16 a[202:203], v17 offset:6512
v_cndmask_b32 v95, v95, v97, vcc
v_mfma_f32_16x16x32_bf16 v[196:199], a[32:35], a[32:35], v[196:199]
ds_read_b128 a[40:43], v16 offset:32768
v_add_u32 v19, v78, v19
v_cndmask_b32 v97, 0, 8, vcc
v_mfma_f32_16x16x32_bf16 v[200:203], a[36:39], a[36:39], v[200:203]
ds_read_b128 a[44:47], v16 offset:34816
v_lshrrev_b32 v98, 2, v95
v_mfma_f32_16x16x32_bf16 v[208:211], a[144:147], a[180:183], v[208:211]
buffer_load_dwordx4 v9, s[16:19], s32 offen offset:3072 sc1 lds
ds_read_b64_tr_b16 a[204:205], v22 offset:5120
v_mfma_f32_16x16x32_bf16 v[204:207], a[184:187], a[144:147], v[204:207]
s_add_u32 m0, s35, 10240
ds_read_b64_tr_b16 a[206:207], v22 offset:5200
v_and_b32 v95, 3, v95
v_mfma_f32_16x16x32_bf16 v[132:135], a[184:187], a[32:35], v[132:135]
ds_read_b64_tr_b16 a[208:209], v20 offset:0
v_lshl_add_u32 v97, v98, 5, v97
v_lshl_add_u32 v97, v95, 1, v97
v_mfma_f32_16x16x32_bf16 v[144:147], a[184:187], a[36:39], v[144:147]
s_waitcnt lgkmcnt(10)
ds_read_b64_tr_b16 a[210:211], v20 offset:80
v_add_u32 v97, v94, v97
v_mfma_f32_16x16x32_bf16 v[112:115], a[188:191], a[36:39], v[112:115]
buffer_load_dwordx4 v10, s[20:23], s44 offen offset:0 sc1 lds
ds_read_b64_tr_b16 a[212:213], v18 offset:5120
v_mfma_f32_16x16x32_bf16 v[100:103], a[188:191], a[32:35], v[100:103]
ds_read_b64_tr_b16 a[214:215], v18 offset:5200
ds_write_b16_d16_hi v97, v81
v_mfma_f32_16x16x32_bf16 v[104:107], a[192:195], a[32:35], v[104:107]
ds_read_b64_tr_b16 a[216:217], v18 offset:5152
v_mul_u32_u24 v35, 240, v2
v_add_u32 v35, s35, v35
v_mfma_f32_16x16x32_bf16 v[116:119], a[192:195], a[36:39], v[116:119]
s_waitcnt lgkmcnt(10)
ds_read_b64_tr_b16 a[218:219], v18 offset:5232
v_lshl_add_u32 v36, v3, 3, v35
v_mfma_f32_16x16x32_bf16 v[136:139], a[196:199], a[36:39], v[136:139]
buffer_load_dwordx4 v11, s[20:23], s44 offen offset:1024 sc1 lds
ds_read_b64_tr_b16 a[220:221], v18 offset:6400
v_mfma_f32_16x16x32_bf16 v[124:127], a[196:199], a[32:35], v[124:127]
ds_read_b64_tr_b16 a[222:223], v18 offset:6480
v_min_u32 v92, 1, v3
v_mfma_f32_16x16x32_bf16 v[128:131], a[200:203], a[32:35], v[128:131]
ds_read_b64_tr_b16 a[224:225], v18 offset:6432
v_lshl_add_u32 v37, v92, 2, v36
v_cmp_eq_u32 s[88:89], 1, v3
v_mfma_f32_16x16x32_bf16 v[140:143], a[200:203], a[36:39], v[140:143]
s_waitcnt lgkmcnt(8)
ds_read_b64_tr_b16 a[226:227], v18 offset:6512
v_mad_u32_u24 v40, v3, 40, v35
s_waitcnt vmcnt(6)
s_barrier
v_mfma_f32_16x16x32_bf16 v[196:199], a[40:43], a[40:43], v[196:199]
ds_read_b128 a[48:51], v15 offset:24576
v_add_u32 v20, v78, v20
v_mov_b32 v48, 1
v_mfma_f32_16x16x32_bf16 v[200:203], a[44:47], a[44:47], v[200:203]
buffer_load_dwordx4 v12, s[20:23], s44 offen offset:2048 sc1 lds
ds_read_b128 a[52:55], v15 offset:26624
v_mfma_f32_16x16x32_bf16 v[208:211], a[144:147], a[204:207], v[208:211]
s_add_u32 s33, s33, 1
ds_read_b64_tr_b16 a[180:181], v21 offset:7680
s_cmp_eq_u32 s33, 6
s_cselect_b32 s33, 3, s33
v_mfma_f32_16x16x32_bf16 v[204:207], a[208:211], a[144:147], v[204:207]
s_mul_i32 s45, s33, 221184
ds_read_b64_tr_b16 a[182:183], v21 offset:7760
s_add_u32 s45, s45, s34
v_mfma_f32_16x16x32_bf16 v[132:135], a[208:211], a[40:43], v[132:135]
s_lshl_b32 s32, s33, 7
ds_read_b64_tr_b16 a[184:185], v19 offset:0
s_add_u32 s32, s32, s49
s_add_u32 m0, s35, 32768
v_mfma_f32_16x16x32_bf16 v[144:147], a[208:211], a[44:47], v[144:147]
s_waitcnt lgkmcnt(9)
buffer_load_dwordx4 v6, s[16:19], s32 offen offset:0 sc1 lds
ds_read_b64_tr_b16 a[186:187], v19 offset:80
v_mfma_f32_16x16x32_bf16 v[112:115], a[212:215], a[44:47], v[112:115]
ds_read_b64_tr_b16 a[188:189], v17 offset:7680
v_cndmask_b32 v92, 0, 32, s[88:89]
v_add_u32 v38, v92, v35
v_mfma_f32_16x16x32_bf16 v[100:103], a[212:215], a[40:43], v[100:103]
ds_read_b64_tr_b16 a[190:191], v17 offset:7760
v_cndmask_b32 v92, 4, 0, s[88:89]
v_mfma_f32_16x16x32_bf16 v[104:107], a[216:219], a[40:43], v[104:107]
ds_read_b64_tr_b16 a[192:193], v17 offset:7712
v_add_u32 v39, v92, v35
v_mov_b32 v35, 0x3f80
v_mfma_f32_16x16x32_bf16 v[116:119], a[216:219], a[44:47], v[116:119]
s_waitcnt lgkmcnt(9)
buffer_load_dwordx4 v7, s[16:19], s32 offen offset:1024 sc1 lds
ds_read_b64_tr_b16 a[194:195], v17 offset:7792
v_mfma_f32_16x16x32_bf16 v[136:139], a[220:223], a[44:47], v[136:139]
ds_read_b64_tr_b16 a[196:197], v17 offset:8960
v_cmp_eq_u32 vcc, s51, v48
v_lshrrev_b32 v92, 2, v1
v_mfma_f32_16x16x32_bf16 v[124:127], a[220:223], a[40:43], v[124:127]
ds_read_b64_tr_b16 a[198:199], v17 offset:9040
v_mul_u32_u24 v92, 480, v92
v_mfma_f32_16x16x32_bf16 v[128:131], a[224:227], a[40:43], v[128:131]
ds_read_b64_tr_b16 a[200:201], v17 offset:8992
v_and_b32 v93, 3, v1
v_lshlrev_b32 v93, 3, v93
v_mfma_f32_16x16x32_bf16 v[140:143], a[224:227], a[44:47], v[140:143]
s_waitcnt lgkmcnt(7)
buffer_load_dwordx4 v8, s[16:19], s32 offen offset:2048 sc1 lds
ds_read_b64_tr_b16 a[202:203], v17 offset:9072
v_mfma_f32_16x16x32_bf16 v[196:199], a[48:51], a[48:51], v[196:199]
s_mul_i32 s55, s52, 80
ds_read_b128 a[56:59], v16 offset:24576
v_add_u32 v19, v78, v19
v_add3_u32 v41, v92, v93, s55
v_mfma_f32_16x16x32_bf16 v[200:203], a[52:55], a[52:55], v[200:203]
ds_read_b128 a[60:63], v16 offset:26624
v_cndmask_b32 v93, v93, 32, vcc
v_mfma_f32_16x16x32_bf16 v[208:211], a[144:147], a[180:183], v[208:211]
s_mul_i32 s55, s52, 40
ds_read_b64_tr_b16 a[204:205], v22 offset:7680
s_add_u32 s55, s55, 160
v_add3_u32 v43, v92, v93, s55
v_mfma_f32_16x16x32_bf16 v[204:207], a[184:187], a[144:147], v[204:207]
buffer_load_dwordx4 v9, s[16:19], s32 offen offset:3072 sc1 lds
ds_read_b64_tr_b16 a[206:207], v22 offset:7760
v_mfma_f32_16x16x32_bf16 v[132:135], a[184:187], a[48:51], v[132:135]
s_add_u32 m0, s35, 12800
ds_read_b64_tr_b16 a[208:209], v20 offset:0
v_add_u32 v42, 73728, v41
v_add_u32 v44, 73728, v43
v_mfma_f32_16x16x32_bf16 v[144:147], a[184:187], a[52:55], v[144:147]
s_waitcnt lgkmcnt(9)
ds_read_b64_tr_b16 a[210:211], v20 offset:80
s_movk_i32 s55, 320
v_mfma_f32_16x16x32_bf16 v[112:115], a[188:191], a[52:55], v[112:115]
ds_read_b64_tr_b16 a[212:213], v18 offset:7680
v_lshlrev_b32 v92, 3, v2
v_mad_u32_u24 v93, v3, s55, v92
v_mfma_f32_16x16x32_bf16 v[100:103], a[188:191], a[48:51], v[100:103]
buffer_load_dwordx4 v10, s[20:23], s45 offen offset:0 sc1 lds
ds_read_b64_tr_b16 a[214:215], v18 offset:7760
v_mfma_f32_16x16x32_bf16 v[104:107], a[192:195], a[48:51], v[104:107]
ds_read_b64_tr_b16 a[216:217], v18 offset:7712
v_lshl_add_u32 v92, v3, 28, v92
v_add_u32 v92, 1280, v92
v_mfma_f32_16x16x32_bf16 v[116:119], a[192:195], a[52:55], v[116:119]
s_waitcnt lgkmcnt(9)
ds_read_b64_tr_b16 a[218:219], v18 offset:7792
v_cndmask_b32 v45, v93, v92, vcc
v_mfma_f32_16x16x32_bf16 v[136:139], a[196:199], a[52:55], v[136:139]
ds_read_b64_tr_b16 a[220:221], v18 offset:8960
v_and_b32 v92, 8, v2
v_lshl_add_u32 v79, v92, 27, v45
v_mfma_f32_16x16x32_bf16 v[124:127], a[196:199], a[48:51], v[124:127]
buffer_load_dwordx4 v11, s[20:23], s45 offen offset:1024 sc1 lds
ds_read_b64_tr_b16 a[222:223], v18 offset:9040
v_mfma_f32_16x16x32_bf16 v[128:131], a[200:203], a[48:51], v[128:131]
ds_read_b64_tr_b16 a[224:225], v18 offset:8992
v_lshrrev_b32 v46, 2, v1
v_lshlrev_b32 v46, 7, v46
v_mfma_f32_16x16x32_bf16 v[140:143], a[200:203], a[52:55], v[140:143]
s_waitcnt lgkmcnt(7)
ds_read_b64_tr_b16 a[226:227], v18 offset:9072
v_min_u32 v47, 1, v0
s_waitcnt vmcnt(6)
s_barrier
v_mfma_f32_16x16x32_bf16 v[196:199], a[56:59], a[56:59], v[196:199]
ds_read_b128 a[64:67], v15 offset:28672
v_add_u32 v20, v78, v20
v_lshlrev_b32 v47, 30, v47
v_mfma_f32_16x16x32_bf16 v[200:203], a[60:63], a[60:63], v[200:203]
buffer_load_dwordx4 v12, s[20:23], s45 offen offset:2048 sc1 lds
ds_read_b128 a[68:71], v15 offset:30720
v_mfma_f32_16x16x32_bf16 v[208:211], a[144:147], a[204:207], v[208:211]
s_add_u32 s33, s33, 1
ds_read_b64_tr_b16 a[180:181], v21 offset:10240
s_cmp_eq_u32 s33, 6
s_cselect_b32 s33, 3, s33
v_mfma_f32_16x16x32_bf16 v[204:207], a[208:211], a[144:147], v[204:207]
s_add_u32 s33, s33, 3
ds_read_b64_tr_b16 a[182:183], v21 offset:10320
s_mul_i32 s46, s33, 221184
v_mfma_f32_16x16x32_bf16 v[132:135], a[208:211], a[56:59], v[132:135]
s_add_u32 s46, s46, s34
ds_read_b64_tr_b16 a[184:185], v19 offset:0
s_lshl_b32 s32, s33, 7
s_add_u32 s32, s32, s49
v_mfma_f32_16x16x32_bf16 v[144:147], a[208:211], a[60:63], v[144:147]
s_waitcnt lgkmcnt(9)
ds_read_b64_tr_b16 a[186:187], v19 offset:80
s_add_u32 m0, s35, 24576
v_mfma_f32_16x16x32_bf16 v[112:115], a[212:215], a[60:63], v[112:115]
buffer_load_dwordx4 v6, s[16:19], s32 offen offset:0 sc1 lds
ds_read_b64_tr_b16 a[188:189], v17 offset:10240
v_mfma_f32_16x16x32_bf16 v[100:103], a[212:215], a[56:59], v[100:103]
ds_read_b64_tr_b16 a[190:191], v17 offset:10320
v_cmp_eq_u32 vcc, s52, v48
v_mfma_f32_16x16x32_bf16 v[104:107], a[216:219], a[56:59], v[104:107]
s_lshl_b32 s55, s51, 5
ds_read_b64_tr_b16 a[192:193], v17 offset:10272
v_add_u32 v92, s55, v17
v_add_u32 v24, 73728, v23
v_mfma_f32_16x16x32_bf16 v[116:119], a[216:219], a[60:63], v[116:119]
s_waitcnt lgkmcnt(9)
ds_read_b64_tr_b16 a[194:195], v17 offset:10352
v_cndmask_b32 v25, v92, v23, vcc
v_mfma_f32_16x16x32_bf16 v[136:139], a[220:223], a[60:63], v[136:139]
buffer_load_dwordx4 v7, s[16:19], s32 offen offset:1024 sc1 lds
ds_read_b64_tr_b16 a[196:197], v17 offset:11520
v_mfma_f32_16x16x32_bf16 v[124:127], a[220:223], a[56:59], v[124:127]
ds_read_b64_tr_b16 a[198:199], v17 offset:11600
v_add_u32 v26, 73728, v25
v_mfma_f32_16x16x32_bf16 v[128:131], a[224:227], a[56:59], v[128:131]
s_lshl_b32 s55, s36, 1
ds_read_b64_tr_b16 a[200:201], v17 offset:11552
s_sub_u32 s55, 8, s55
v_add_u32 v27, s55, v17
v_mfma_f32_16x16x32_bf16 v[140:143], a[224:227], a[60:63], v[140:143]
s_waitcnt lgkmcnt(7)
ds_read_b64_tr_b16 a[202:203], v17 offset:11632
v_add_u32 v28, s55, v18
v_mfma_f32_16x16x32_bf16 v[196:199], a[64:67], a[64:67], v[196:199]
ds_read_b128 a[72:75], v16 offset:28672
v_add_u32 v19, v78, v19
v_add_u32 v29, s55, v23
v_mfma_f32_16x16x32_bf16 v[200:203], a[68:71], a[68:71], v[200:203]
buffer_load_dwordx4 v8, s[16:19], s32 offen offset:2048 sc1 lds
ds_read_b128 a[76:79], v16 offset:30720
v_mfma_f32_16x16x32_bf16 v[208:211], a[144:147], a[180:183], v[208:211]
ds_read_b64_tr_b16 a[204:205], v22 offset:10240
v_add_u32 v30, s55, v24
v_add_u32 v93, 0, v1
v_mfma_f32_16x16x32_bf16 v[204:207], a[184:187], a[144:147], v[204:207]
ds_read_b64_tr_b16 a[206:207], v22 offset:10320
v_mul_u32_u24 v92, 205, v93
v_mfma_f32_16x16x32_bf16 v[132:135], a[184:187], a[64:67], v[132:135]
ds_read_b64_tr_b16 a[208:209], v20 offset:0
v_lshrrev_b32 v92, 10, v92
v_mad_i32_i24 v93, v92, -5, v93
v_mfma_f32_16x16x32_bf16 v[144:147], a[184:187], a[68:71], v[144:147]
s_waitcnt lgkmcnt(9)
buffer_load_dwordx4 v9, s[16:19], s32 offen offset:3072 sc1 lds
ds_read_b64_tr_b16 a[210:211], v20 offset:80
v_mfma_f32_16x16x32_bf16 v[112:115], a[188:191], a[68:71], v[112:115]
s_add_u32 m0, s35, 15360
ds_read_b64_tr_b16 a[212:213], v18 offset:10240
v_lshlrev_b32 v93, 4, v93
v_mad_u32_u24 v56, v92, s38, v93
v_mfma_f32_16x16x32_bf16 v[100:103], a[188:191], a[64:67], v[100:103]
ds_read_b64_tr_b16 a[214:215], v18 offset:10320
v_and_b32 v95, 1, v92
v_mfma_f32_16x16x32_bf16 v[104:107], a[192:195], a[64:67], v[104:107]
ds_read_b64_tr_b16 a[216:217], v18 offset:10272
v_bfe_u32 v94, v92, 1, 2
v_lshl_add_u32 v94, v95, 2, v94
v_mfma_f32_16x16x32_bf16 v[116:119], a[192:195], a[68:71], v[116:119]
s_waitcnt lgkmcnt(9)
buffer_load_dwordx4 v10, s[20:23], s46 offen offset:0 sc1 lds
ds_read_b64_tr_b16 a[218:219], v18 offset:10352
v_mfma_f32_16x16x32_bf16 v[136:139], a[196:199], a[68:71], v[136:139]
ds_read_b64_tr_b16 a[220:221], v18 offset:11520
v_and_or_b32 v95, v92, 8, v94
v_mad_u32_u24 v52, v95, s38, v93
v_mfma_f32_16x16x32_bf16 v[124:127], a[196:199], a[64:67], v[124:127]
ds_read_b64_tr_b16 a[222:223], v18 offset:11600
v_and_b32 v92, 8, v92
v_mfma_f32_16x16x32_bf16 v[128:131], a[200:203], a[64:67], v[128:131]
ds_read_b64_tr_b16 a[224:225], v18 offset:11552
v_mul_u32_u24 v92, 9, v92
v_lshrrev_b32 v95, 1, v94
v_mfma_f32_16x16x32_bf16 v[140:143], a[200:203], a[68:71], v[140:143]
s_waitcnt lgkmcnt(7)
buffer_load_dwordx4 v11, s[20:23], s46 offen offset:1024 sc1 lds
ds_read_b64_tr_b16 a[226:227], v18 offset:11632
s_waitcnt vmcnt(6)
s_barrier
v_mfma_f32_16x16x32_bf16 v[196:199], a[72:75], a[72:75], v[196:199]
ds_read_b128 a[80:83], v15 offset:32768
v_add_u32 v20, v78, v20
v_mad_u32_u24 v92, v95, 16, v92
v_mfma_f32_16x16x32_bf16 v[200:203], a[76:79], a[76:79], v[200:203]
ds_read_b128 a[84:87], v15 offset:34816
v_add_u32 v92, v92, v94
v_mfma_f32_16x16x32_bf16 v[208:211], a[144:147], a[204:207], v[208:211]
ds_read_b64_tr_b16 a[180:181], v21 offset:12800
v_mad_u32_u24 v54, v92, s38, v93
v_add_u32 v93, 64, v1
v_mfma_f32_16x16x32_bf16 v[204:207], a[208:211], a[144:147], v[204:207]
buffer_load_dwordx4 v12, s[20:23], s46 offen offset:2048 sc1 lds
ds_read_b64_tr_b16 a[182:183], v21 offset:12880
v_mfma_f32_16x16x32_bf16 v[132:135], a[208:211], a[72:75], v[132:135]
s_add_u32 s33, s33, 1
ds_read_b64_tr_b16 a[184:185], v19 offset:0
s_cmp_eq_u32 s33, 9
s_cselect_b32 s33, 6, s33
v_mfma_f32_16x16x32_bf16 v[144:147], a[208:211], a[76:79], v[144:147]
s_waitcnt lgkmcnt(9)
ds_read_b64_tr_b16 a[186:187], v19 offset:80
s_mul_i32 s47, s33, 221184
v_mfma_f32_16x16x32_bf16 v[112:115], a[212:215], a[76:79], v[112:115]
s_add_u32 s47, s47, s34
ds_read_b64_tr_b16 a[188:189], v17 offset:12800
s_lshl_b32 s32, s33, 7
s_add_u32 s32, s32, s49
v_mfma_f32_16x16x32_bf16 v[100:103], a[212:215], a[72:75], v[100:103]
s_add_u32 m0, s35, 28672
ds_read_b64_tr_b16 a[190:191], v17 offset:12880
v_mul_u32_u24 v92, 205, v93
v_mfma_f32_16x16x32_bf16 v[104:107], a[216:219], a[72:75], v[104:107]
buffer_load_dwordx4 v6, s[16:19], s32 offen offset:0 sc1 lds
ds_read_b64_tr_b16 a[192:193], v17 offset:12832
v_mfma_f32_16x16x32_bf16 v[116:119], a[216:219], a[76:79], v[116:119]
s_waitcnt lgkmcnt(9)
ds_read_b64_tr_b16 a[194:195], v17 offset:12912
v_lshrrev_b32 v92, 10, v92
v_mfma_f32_16x16x32_bf16 v[136:139], a[220:223], a[76:79], v[136:139]
ds_read_b64_tr_b16 a[196:197], v17 offset:14080
v_mad_i32_i24 v93, v92, -5, v93
v_lshlrev_b32 v93, 4, v93
v_mfma_f32_16x16x32_bf16 v[124:127], a[220:223], a[72:75], v[124:127]
ds_read_b64_tr_b16 a[198:199], v17 offset:14160
v_subrev_u32 v93, 1024, v93
v_mfma_f32_16x16x32_bf16 v[128:131], a[224:227], a[72:75], v[128:131]
buffer_load_dwordx4 v7, s[16:19], s32 offen offset:1024 sc1 lds
ds_read_b64_tr_b16 a[200:201], v17 offset:14112
v_mfma_f32_16x16x32_bf16 v[140:143], a[224:227], a[76:79], v[140:143]
s_waitcnt lgkmcnt(7)
ds_read_b64_tr_b16 a[202:203], v17 offset:14192
v_mad_u32_u24 v57, v92, s38, v93
v_mfma_f32_16x16x32_bf16 v[196:199], a[80:83], a[80:83], v[196:199]
ds_read_b128 a[88:91], v16 offset:32768
v_add_u32 v19, v78, v19
v_and_b32 v95, 1, v92
v_mfma_f32_16x16x32_bf16 v[200:203], a[84:87], a[84:87], v[200:203]
ds_read_b128 a[92:95], v16 offset:34816
v_bfe_u32 v94, v92, 1, 2
v_mfma_f32_16x16x32_bf16 v[208:211], a[144:147], a[180:183], v[208:211]
buffer_load_dwordx4 v8, s[16:19], s32 offen offset:2048 sc1 lds
ds_read_b64_tr_b16 a[204:205], v22 offset:12800
v_mfma_f32_16x16x32_bf16 v[204:207], a[184:187], a[144:147], v[204:207]
ds_read_b64_tr_b16 a[206:207], v22 offset:12880
v_lshl_add_u32 v94, v95, 2, v94
v_mfma_f32_16x16x32_bf16 v[132:135], a[184:187], a[80:83], v[132:135]
ds_read_b64_tr_b16 a[208:209], v20 offset:0
v_and_or_b32 v95, v92, 8, v94
v_mad_u32_u24 v53, v95, s38, v93
v_mfma_f32_16x16x32_bf16 v[144:147], a[184:187], a[84:87], v[144:147]
s_waitcnt lgkmcnt(9)
ds_read_b64_tr_b16 a[210:211], v20 offset:80
v_and_b32 v92, 8, v92
v_mfma_f32_16x16x32_bf16 v[112:115], a[188:191], a[84:87], v[112:115]
buffer_load_dwordx4 v9, s[16:19], s32 offen offset:3072 sc1 lds
ds_read_b64_tr_b16 a[212:213], v18 offset:12800
v_mfma_f32_16x16x32_bf16 v[100:103], a[188:191], a[80:83], v[100:103]
s_add_u32 m0, s35, 17920
ds_read_b64_tr_b16 a[214:215], v18 offset:12880
v_mul_u32_u24 v92, 9, v92
v_mfma_f32_16x16x32_bf16 v[104:107], a[192:195], a[80:83], v[104:107]
ds_read_b64_tr_b16 a[216:217], v18 offset:12832
v_lshrrev_b32 v95, 1, v94
v_mad_u32_u24 v92, v95, 16, v92
v_mfma_f32_16x16x32_bf16 v[116:119], a[192:195], a[84:87], v[116:119]
s_waitcnt lgkmcnt(9)
ds_read_b64_tr_b16 a[218:219], v18 offset:12912
v_add_u32 v92, v92, v94
v_mfma_f32_16x16x32_bf16 v[136:139], a[196:199], a[84:87], v[136:139]
buffer_load_dwordx4 v10, s[20:23], s47 offen offset:0 sc1 lds
ds_read_b64_tr_b16 a[220:221], v18 offset:14080
v_mfma_f32_16x16x32_bf16 v[124:127], a[196:199], a[80:83], v[124:127]
ds_read_b64_tr_b16 a[222:223], v18 offset:14160
v_mad_u32_u24 v55, v92, s38, v93
v_mfma_f32_16x16x32_bf16 v[128:131], a[200:203], a[80:83], v[128:131]
ds_read_b64_tr_b16 a[224:225], v18 offset:14112
v_add_u32 v93, 128, v1
v_mul_u32_u24 v92, 205, v93
v_mfma_f32_16x16x32_bf16 v[140:143], a[200:203], a[84:87], v[140:143]
s_waitcnt lgkmcnt(7)
ds_read_b64_tr_b16 a[226:227], v18 offset:14192
v_lshrrev_b32 v92, 10, v92
v_mfma_f32_16x16x32_bf16 v[196:199], a[88:91], a[88:91], v[196:199]
v_add_u32 v20, v78, v20
v_mad_i32_i24 v93, v92, -5, v93
v_lshlrev_b32 v93, 4, v93
v_mfma_f32_16x16x32_bf16 v[200:203], a[92:95], a[92:95], v[200:203]
buffer_load_dwordx4 v11, s[20:23], s47 offen offset:1024 sc1 lds
v_mfma_f32_16x16x32_bf16 v[208:211], a[144:147], a[204:207], v[208:211]
v_subrev_u32 v93, 2048, v93
v_mad_u32_u24 v58, v92, s38, v93
v_and_b32 v92, 1073741824, v14
v_mfma_f32_16x16x32_bf16 v[204:207], a[208:211], a[144:147], v[204:207]
v_or_b32 v53, v53, v92
v_or_b32 v55, v55, v92
v_mfma_f32_16x16x32_bf16 v[132:135], a[208:211], a[88:91], v[132:135]
v_and_b32 v92, 1073741824, v12
v_or_b32 v58, v58, v92
v_lshrrev_b32 v92, 2, v1
v_mfma_f32_16x16x32_bf16 v[144:147], a[208:211], a[92:95], v[144:147]
s_waitcnt lgkmcnt(4)
buffer_load_dwordx4 v12, s[20:23], s47 offen offset:2048 sc1 lds
v_mfma_f32_16x16x32_bf16 v[112:115], a[212:215], a[92:95], v[112:115]
s_add_u32 s33, s33, 1
s_cmp_eq_u32 s33, 9
s_cselect_b32 s33, 6, s33
v_mul_u32_u24 v92, 96, v92
v_mfma_f32_16x16x32_bf16 v[100:103], a[212:215], a[88:91], v[100:103]
v_and_b32 v93, 3, v1
v_lshl_add_u32 v92, v93, 3, v92
v_mfma_f32_16x16x32_bf16 v[104:107], a[216:219], a[88:91], v[104:107]
s_branch iskip1
.p2align 12
ipad1:
s_branch iret0
iskip1:
v_add_u32 v99, 147456, v92
v_mfma_f32_16x16x32_bf16 v[116:119], a[216:219], a[92:95], v[116:119]
s_waitcnt lgkmcnt(0)
v_mfma_f32_16x16x32_bf16 v[136:139], a[220:223], a[92:95], v[136:139]
v_mfma_f32_16x16x32_bf16 v[124:127], a[220:223], a[88:91], v[124:127]
v_mfma_f32_16x16x32_bf16 v[128:131], a[224:227], a[88:91], v[128:131]
v_mfma_f32_16x16x32_bf16 v[140:143], a[224:227], a[92:95], v[140:143]
s_waitcnt vmcnt(7)
s_barrier
ds_read_b128 a[96:99], v15 offset:24576
ds_read_b128 a[100:103], v15 offset:26624
ds_read_b64_tr_b16 a[180:181], v21 offset:15360
ds_read_b64_tr_b16 a[182:183], v21 offset:15440
ds_read_b64_tr_b16 a[184:185], v19 offset:0
ds_read_b64_tr_b16 a[186:187], v19 offset:80
ds_read_b64_tr_b16 a[188:189], v17 offset:15360
ds_read_b64_tr_b16 a[190:191], v17 offset:15440
ds_read_b64_tr_b16 a[192:193], v17 offset:15392
ds_read_b64_tr_b16 a[194:195], v17 offset:15472
ds_read_b64_tr_b16 a[196:197], v17 offset:16640
ds_read_b64_tr_b16 a[198:199], v17 offset:16720
ds_read_b64_tr_b16 a[200:201], v17 offset:16672
ds_read_b64_tr_b16 a[202:203], v17 offset:16752
s_waitcnt lgkmcnt(8)
v_mfma_f32_16x16x32_bf16 v[196:199], a[96:99], a[96:99], v[196:199]
ds_read_b128 a[104:107], v16 offset:24576
v_add_u32 v19, v78, v19
v_mfma_f32_16x16x32_bf16 v[200:203], a[100:103], a[100:103], v[200:203]
s_mul_i32 s48, s33, 221184
ds_read_b128 a[108:111], v16 offset:26624
s_add_u32 s48, s48, s34
v_mfma_f32_16x16x32_bf16 v[208:211], a[144:147], a[180:183], v[208:211]
s_lshl_b32 s32, s33, 7
ds_read_b64_tr_b16 a[204:205], v22 offset:15360
s_add_u32 s32, s32, s49
v_mfma_f32_16x16x32_bf16 v[204:207], a[184:187], a[144:147], v[204:207]
s_add_u32 m0, s35, 32768
ds_read_b64_tr_b16 a[206:207], v22 offset:15440
v_mfma_f32_16x16x32_bf16 v[132:135], a[184:187], a[96:99], v[132:135]
buffer_load_dwordx4 v6, s[16:19], s32 offen offset:0 sc1 lds
ds_read_b64_tr_b16 a[208:209], v20 offset:0
v_mfma_f32_16x16x32_bf16 v[144:147], a[184:187], a[100:103], v[144:147]
s_waitcnt lgkmcnt(9)
ds_read_b64_tr_b16 a[210:211], v20 offset:80
v_mfma_f32_16x16x32_bf16 v[112:115], a[188:191], a[100:103], v[112:115]
ds_read_b64_tr_b16 a[212:213], v18 offset:15360
v_mfma_f32_16x16x32_bf16 v[100:103], a[188:191], a[96:99], v[100:103]
ds_read_b64_tr_b16 a[214:215], v18 offset:15440
v_mfma_f32_16x16x32_bf16 v[104:107], a[192:195], a[96:99], v[104:107]
buffer_load_dwordx4 v7, s[16:19], s32 offen offset:1024 sc1 lds
ds_read_b64_tr_b16 a[216:217], v18 offset:15392
v_mfma_f32_16x16x32_bf16 v[116:119], a[192:195], a[100:103], v[116:119]
s_waitcnt lgkmcnt(9)
ds_read_b64_tr_b16 a[218:219], v18 offset:15472
v_mfma_f32_16x16x32_bf16 v[136:139], a[196:199], a[100:103], v[136:139]
ds_read_b64_tr_b16 a[220:221], v18 offset:16640
v_mfma_f32_16x16x32_bf16 v[124:127], a[196:199], a[96:99], v[124:127]
ds_read_b64_tr_b16 a[222:223], v18 offset:16720
v_mfma_f32_16x16x32_bf16 v[128:131], a[200:203], a[96:99], v[128:131]
buffer_load_dwordx4 v8, s[16:19], s32 offen offset:2048 sc1 lds
ds_read_b64_tr_b16 a[224:225], v18 offset:16672
v_mfma_f32_16x16x32_bf16 v[140:143], a[200:203], a[100:103], v[140:143]
s_waitcnt lgkmcnt(7)
ds_read_b64_tr_b16 a[226:227], v18 offset:16752
v_mfma_f32_16x16x32_bf16 v[196:199], a[104:107], a[104:107], v[196:199]
v_add_u32 v20, v78, v20
v_mfma_f32_16x16x32_bf16 v[200:203], a[108:111], a[108:111], v[200:203]
v_mfma_f32_16x16x32_bf16 v[208:211], a[144:147], a[204:207], v[208:211]
buffer_load_dwordx4 v9, s[16:19], s32 offen offset:3072 sc1 lds
v_mfma_f32_16x16x32_bf16 v[204:207], a[208:211], a[144:147], v[204:207]
s_add_u32 m0, s35, 20480
v_mfma_f32_16x16x32_bf16 v[132:135], a[208:211], a[104:107], v[132:135]
v_mfma_f32_16x16x32_bf16 v[144:147], a[208:211], a[108:111], v[144:147]
s_waitcnt lgkmcnt(4)
v_mfma_f32_16x16x32_bf16 v[112:115], a[212:215], a[108:111], v[112:115]
buffer_load_dwordx4 v10, s[20:23], s48 offen offset:0 sc1 lds
v_mfma_f32_16x16x32_bf16 v[100:103], a[212:215], a[104:107], v[100:103]
v_mfma_f32_16x16x32_bf16 v[104:107], a[216:219], a[104:107], v[104:107]
v_mfma_f32_16x16x32_bf16 v[116:119], a[216:219], a[108:111], v[116:119]
s_waitcnt lgkmcnt(0)
v_mfma_f32_16x16x32_bf16 v[136:139], a[220:223], a[108:111], v[136:139]
buffer_load_dwordx4 v11, s[20:23], s48 offen offset:1024 sc1 lds
v_mfma_f32_16x16x32_bf16 v[124:127], a[220:223], a[104:107], v[124:127]
v_mfma_f32_16x16x32_bf16 v[128:131], a[224:227], a[104:107], v[128:131]
v_mfma_f32_16x16x32_bf16 v[140:143], a[224:227], a[108:111], v[140:143]
buffer_load_dwordx4 v12, s[20:23], s48 offen offset:2048 sc1 lds
s_waitcnt vmcnt(7)
s_barrier
ds_read_b128 a[112:115], v15 offset:28672
ds_read_b128 a[116:119], v15 offset:30720
ds_read_b64_tr_b16 a[180:181], v21 offset:17920
ds_read_b64_tr_b16 a[182:183], v21 offset:18000
ds_read_b64_tr_b16 a[184:185], v19 offset:0
ds_read_b64_tr_b16 a[186:187], v19 offset:80
ds_read_b64_tr_b16 a[188:189], v17 offset:17920
ds_read_b64_tr_b16 a[190:191], v17 offset:18000
ds_read_b64_tr_b16 a[192:193], v17 offset:17952
ds_read_b64_tr_b16 a[194:195], v17 offset:18032
ds_read_b64_tr_b16 a[196:197], v17 offset:19200
ds_read_b64_tr_b16 a[198:199], v17 offset:19280
ds_read_b64_tr_b16 a[200:201], v17 offset:19232
ds_read_b64_tr_b16 a[202:203], v17 offset:19312
s_waitcnt lgkmcnt(8)
v_mfma_f32_16x16x32_bf16 v[196:199], a[112:115], a[112:115], v[196:199]
ds_read_b128 a[120:123], v16 offset:28672
v_add_u32 v19, v78, v19
v_mfma_f32_16x16x32_bf16 v[200:203], a[116:119], a[116:119], v[200:203]
s_add_u32 m0, s35, 24576
ds_read_b128 a[124:127], v16 offset:30720
v_mfma_f32_16x16x32_bf16 v[208:211], a[144:147], a[180:183], v[208:211]
buffer_load_dwordx4 v13, s[20:23], s40 offen offset:0 sc1 lds
ds_read_b64_tr_b16 a[204:205], v22 offset:17920
v_mfma_f32_16x16x32_bf16 v[204:207], a[184:187], a[144:147], v[204:207]
ds_read_b64_tr_b16 a[206:207], v22 offset:18000
v_mfma_f32_16x16x32_bf16 v[132:135], a[184:187], a[112:115], v[132:135]
ds_read_b64_tr_b16 a[208:209], v20 offset:0
v_mfma_f32_16x16x32_bf16 v[144:147], a[184:187], a[116:119], v[144:147]
s_waitcnt lgkmcnt(9)
ds_read_b64_tr_b16 a[210:211], v20 offset:80
v_mfma_f32_16x16x32_bf16 v[112:115], a[188:191], a[116:119], v[112:115]
buffer_load_dwordx4 v14, s[20:23], s40 offen offset:1024 sc1 lds
ds_read_b64_tr_b16 a[212:213], v18 offset:17920
v_mfma_f32_16x16x32_bf16 v[100:103], a[188:191], a[112:115], v[100:103]
s_add_u32 m0, s35, 25856
ds_read_b64_tr_b16 a[214:215], v18 offset:18000
v_mfma_f32_16x16x32_bf16 v[104:107], a[192:195], a[112:115], v[104:107]
ds_read_b64_tr_b16 a[216:217], v18 offset:17952
v_mfma_f32_16x16x32_bf16 v[116:119], a[192:195], a[116:119], v[116:119]
s_waitcnt lgkmcnt(9)
ds_read_b64_tr_b16 a[218:219], v18 offset:18032
v_mfma_f32_16x16x32_bf16 v[136:139], a[196:199], a[116:119], v[136:139]
buffer_load_dwordx4 v13, s[20:23], s41 offen offset:0 sc1 lds
ds_read_b64_tr_b16 a[220:221], v18 offset:19200
v_mfma_f32_16x16x32_bf16 v[124:127], a[196:199], a[112:115], v[124:127]
ds_read_b64_tr_b16 a[222:223], v18 offset:19280
v_mfma_f32_16x16x32_bf16 v[128:131], a[200:203], a[112:115], v[128:131]
ds_read_b64_tr_b16 a[224:225], v18 offset:19232
v_mfma_f32_16x16x32_bf16 v[140:143], a[200:203], a[116:119], v[140:143]
s_waitcnt lgkmcnt(7)
ds_read_b64_tr_b16 a[226:227], v18 offset:19312
v_mfma_f32_16x16x32_bf16 v[196:199], a[120:123], a[120:123], v[196:199]
v_add_u32 v20, v78, v20
v_mfma_f32_16x16x32_bf16 v[200:203], a[124:127], a[124:127], v[200:203]
buffer_load_dwordx4 v14, s[20:23], s41 offen offset:1024 sc1 lds
v_mfma_f32_16x16x32_bf16 v[208:211], a[144:147], a[204:207], v[208:211]
v_mfma_f32_16x16x32_bf16 v[204:207], a[208:211], a[144:147], v[204:207]
v_mfma_f32_16x16x32_bf16 v[132:135], a[208:211], a[120:123], v[132:135]
v_mfma_f32_16x16x32_bf16 v[144:147], a[208:211], a[124:127], v[144:147]
s_waitcnt lgkmcnt(4)
v_mfma_f32_16x16x32_bf16 v[112:115], a[212:215], a[124:127], v[112:115]
v_mfma_f32_16x16x32_bf16 v[100:103], a[212:215], a[120:123], v[100:103]
v_mfma_f32_16x16x32_bf16 v[104:107], a[216:219], a[120:123], v[104:107]
v_mfma_f32_16x16x32_bf16 v[116:119], a[216:219], a[124:127], v[116:119]
s_waitcnt lgkmcnt(0)
v_mfma_f32_16x16x32_bf16 v[136:139], a[220:223], a[124:127], v[136:139]
v_mfma_f32_16x16x32_bf16 v[124:127], a[220:223], a[120:123], v[124:127]
v_mfma_f32_16x16x32_bf16 v[128:131], a[224:227], a[120:123], v[128:131]
v_mfma_f32_16x16x32_bf16 v[140:143], a[224:227], a[124:127], v[140:143]
s_waitcnt vmcnt(4)
s_barrier
ds_read_b128 a[128:131], v15 offset:32768
ds_read_b128 a[132:135], v15 offset:34816
ds_read_b64_tr_b16 a[180:181], v21 offset:20480
ds_read_b64_tr_b16 a[182:183], v21 offset:20560
ds_read_b64_tr_b16 a[184:185], v19 offset:0
ds_read_b64_tr_b16 a[186:187], v19 offset:80
ds_read_b64_tr_b16 a[188:189], v17 offset:20480
ds_read_b64_tr_b16 a[190:191], v17 offset:20560
ds_read_b64_tr_b16 a[192:193], v17 offset:20512
ds_read_b64_tr_b16 a[194:195], v17 offset:20592
ds_read_b64_tr_b16 a[196:197], v17 offset:21760
ds_read_b64_tr_b16 a[198:199], v17 offset:21840
ds_read_b64_tr_b16 a[200:201], v17 offset:21792
ds_read_b64_tr_b16 a[202:203], v17 offset:21872
s_waitcnt lgkmcnt(8)
v_mfma_f32_16x16x32_bf16 v[196:199], a[128:131], a[128:131], v[196:199]
s_add_u32 m0, s35, 27136
ds_read_b128 a[136:139], v16 offset:32768
v_mfma_f32_16x16x32_bf16 v[200:203], a[132:135], a[132:135], v[200:203]
buffer_load_dwordx4 v13, s[20:23], s42 offen offset:0 sc1 lds
ds_read_b128 a[140:143], v16 offset:34816
v_mfma_f32_16x16x32_bf16 v[208:211], a[144:147], a[180:183], v[208:211]
ds_read_b64_tr_b16 a[204:205], v22 offset:20480
v_mfma_f32_16x16x32_bf16 v[204:207], a[184:187], a[144:147], v[204:207]
ds_read_b64_tr_b16 a[206:207], v22 offset:20560
v_mfma_f32_16x16x32_bf16 v[132:135], a[184:187], a[128:131], v[132:135]
ds_read_b64_tr_b16 a[208:209], v20 offset:0
v_mfma_f32_16x16x32_bf16 v[144:147], a[184:187], a[132:135], v[144:147]
s_waitcnt lgkmcnt(9)
buffer_load_dwordx4 v14, s[20:23], s42 offen offset:1024 sc1 lds
ds_read_b64_tr_b16 a[210:211], v20 offset:80
v_mfma_f32_16x16x32_bf16 v[112:115], a[188:191], a[132:135], v[112:115]
s_add_u32 m0, s35, 28416
ds_read_b64_tr_b16 a[212:213], v18 offset:20480
v_mfma_f32_16x16x32_bf16 v[100:103], a[188:191], a[128:131], v[100:103]
ds_read_b64_tr_b16 a[214:215], v18 offset:20560
v_mfma_f32_16x16x32_bf16 v[104:107], a[192:195], a[128:131], v[104:107]
ds_read_b64_tr_b16 a[216:217], v18 offset:20512
v_mfma_f32_16x16x32_bf16 v[116:119], a[192:195], a[132:135], v[116:119]
s_waitcnt lgkmcnt(9)
buffer_load_dwordx4 v13, s[20:23], s43 offen offset:0 sc1 lds
ds_read_b64_tr_b16 a[218:219], v18 offset:20592
v_mfma_f32_16x16x32_bf16 v[136:139], a[196:199], a[132:135], v[136:139]
ds_read_b64_tr_b16 a[220:221], v18 offset:21760
v_mfma_f32_16x16x32_bf16 v[124:127], a[196:199], a[128:131], v[124:127]
ds_read_b64_tr_b16 a[222:223], v18 offset:21840
v_mfma_f32_16x16x32_bf16 v[128:131], a[200:203], a[128:131], v[128:131]
ds_read_b64_tr_b16 a[224:225], v18 offset:21792
v_mfma_f32_16x16x32_bf16 v[140:143], a[200:203], a[132:135], v[140:143]
s_waitcnt lgkmcnt(7)
buffer_load_dwordx4 v14, s[20:23], s43 offen offset:1024 sc1 lds
ds_read_b64_tr_b16 a[226:227], v18 offset:21872
v_mfma_f32_16x16x32_bf16 v[196:199], a[136:139], a[136:139], v[196:199]
s_add_u32 m0, s35, 29696
v_mfma_f32_16x16x32_bf16 v[200:203], a[140:143], a[140:143], v[200:203]
v_mfma_f32_16x16x32_bf16 v[208:211], a[144:147], a[204:207], v[208:211]
v_mfma_f32_16x16x32_bf16 v[204:207], a[208:211], a[144:147], v[204:207]
buffer_load_dwordx4 v13, s[20:23], s44 offen offset:0 sc1 lds
v_mfma_f32_16x16x32_bf16 v[132:135], a[208:211], a[136:139], v[132:135]
v_mfma_f32_16x16x32_bf16 v[144:147], a[208:211], a[140:143], v[144:147]
s_waitcnt lgkmcnt(4)
v_mfma_f32_16x16x32_bf16 v[112:115], a[212:215], a[140:143], v[112:115]
v_mfma_f32_16x16x32_bf16 v[100:103], a[212:215], a[136:139], v[100:103]
buffer_load_dwordx4 v14, s[20:23], s44 offen offset:1024 sc1 lds
v_mfma_f32_16x16x32_bf16 v[104:107], a[216:219], a[136:139], v[104:107]
ds_read_b64_tr_b16 a[148:149], v99 offset:0
ds_read_b64_tr_b16 a[150:151], v99 offset:1536
v_mfma_f32_16x16x32_bf16 v[116:119], a[216:219], a[140:143], v[116:119]
s_waitcnt lgkmcnt(2)
ds_read_b64_tr_b16 a[152:153], v99 offset:3072
ds_read_b64_tr_b16 a[156:157], v99 offset:32
v_mfma_f32_16x16x32_bf16 v[136:139], a[220:223], a[140:143], v[136:139]
ds_read_b64_tr_b16 a[158:159], v99 offset:1568
ds_read_b64_tr_b16 a[160:161], v99 offset:3104
v_mfma_f32_16x16x32_bf16 v[124:127], a[220:223], a[136:139], v[124:127]
ds_read_b64_tr_b16 a[164:165], v99 offset:64
ds_read_b64_tr_b16 a[166:167], v99 offset:1600
v_mfma_f32_16x16x32_bf16 v[128:131], a[224:227], a[136:139], v[128:131]
ds_read_b64_tr_b16 a[168:169], v99 offset:3136
v_cndmask_b32 v84, v196, v197, s[74:75]
v_mfma_f32_16x16x32_bf16 v[140:143], a[224:227], a[140:143], v[140:143]
v_cndmask_b32 v84, v84, v198, s[76:77]
v_cndmask_b32 v84, v84, v199, s[78:79]
ds_bpermute_b32 v86, v31, v84
v_cndmask_b32 v85, v200, v201, s[74:75]
v_cndmask_b32 v85, v85, v202, s[76:77]
v_cndmask_b32 v85, v85, v203, s[78:79]
ds_bpermute_b32 v87, v31, v85
ds_write_b32 v32, v208
v_mul_f32 v88, 0x3ae38e39, v132
v_mul_f32 v76, 0x3ae38e39, v132
v_mul_f32 v89, 0x3ae38e39, v144
v_mul_f32 v77, 0x3ae38e39, v144
v_permlane32_swap_b32 v88, v76
s_nop 0
v_permlane32_swap_b32 v89, v77
s_waitcnt lgkmcnt(0)
s_barrier
ds_read_b128 v[212:215], v34 offset:0
ds_read_b128 v[216:219], v34 offset:64
ds_read_b128 v[220:223], v34 offset:128
ds_read_b128 v[224:227], v34 offset:192
s_mov_b32 s90, 0x3ae38e39
v_pk_mul_f32 v[86:87], v[86:87], s[90:91] op_sel_hi:[1,0]
v_pk_fma_f32 v[86:87], v[76:77], v[76:77], v[86:87] neg_lo:[1,0,0] neg_hi:[1,0,0]
v_max_f32 v86, 0, v86
v_add_f32 v86, 0x3727c5ac, v86
v_rsq_f32 v74, v86
v_max_f32 v87, 0, v87
v_add_f32 v87, 0x3727c5ac, v87
v_rsq_f32 v75, v87
v_pk_fma_f32 v[132:133], v[204:205], v[76:77], v[132:133] op_sel:[0,0,0] op_sel_hi:[1,0,1] neg_lo:[1,0,0] neg_hi:[1,0,0]
v_pk_fma_f32 v[134:135], v[206:207], v[76:77], v[134:135] op_sel:[0,0,0] op_sel_hi:[1,0,1] neg_lo:[1,0,0] neg_hi:[1,0,0]
v_cvt_pk_bf16_f32 v152, v132, v133
v_cvt_pk_bf16_f32 v153, v134, v135
v_pk_fma_f32 v[144:145], v[204:205], v[76:77], v[144:145] op_sel:[0,1,0] op_sel_hi:[1,1,1] neg_lo:[1,0,0] neg_hi:[1,0,0]
v_pk_fma_f32 v[146:147], v[206:207], v[76:77], v[146:147] op_sel:[0,1,0] op_sel_hi:[1,1,1] neg_lo:[1,0,0] neg_hi:[1,0,0]
v_cvt_pk_bf16_f32 v160, v144, v145
v_cvt_pk_bf16_f32 v161, v146, v147
s_waitcnt lgkmcnt(2)
v_pk_fma_f32 v[100:101], v[212:213], v[76:77], v[100:101] op_sel:[0,0,0] op_sel_hi:[1,0,1] neg_lo:[1,0,0] neg_hi:[1,0,0]
v_pk_fma_f32 v[102:103], v[214:215], v[76:77], v[102:103] op_sel:[0,0,0] op_sel_hi:[1,0,1] neg_lo:[1,0,0] neg_hi:[1,0,0]
v_cvt_pk_bf16_f32 v148, v100, v101
v_cvt_pk_bf16_f32 v149, v102, v103
v_pk_fma_f32 v[104:105], v[216:217], v[76:77], v[104:105] op_sel:[0,0,0] op_sel_hi:[1,0,1] neg_lo:[1,0,0] neg_hi:[1,0,0]
v_pk_fma_f32 v[106:107], v[218:219], v[76:77], v[106:107] op_sel:[0,0,0] op_sel_hi:[1,0,1] neg_lo:[1,0,0] neg_hi:[1,0,0]
v_cvt_pk_bf16_f32 v150, v104, v105
v_cvt_pk_bf16_f32 v151, v106, v107
v_pk_fma_f32 v[112:113], v[212:213], v[76:77], v[112:113] op_sel:[0,1,0] op_sel_hi:[1,1,1] neg_lo:[1,0,0] neg_hi:[1,0,0]
v_pk_fma_f32 v[114:115], v[214:215], v[76:77], v[114:115] op_sel:[0,1,0] op_sel_hi:[1,1,1] neg_lo:[1,0,0] neg_hi:[1,0,0]
v_cvt_pk_bf16_f32 v156, v112, v113
v_cvt_pk_bf16_f32 v157, v114, v115
v_pk_fma_f32 v[116:117], v[216:217], v[76:77], v[116:117] op_sel:[0,1,0] op_sel_hi:[1,1,1] neg_lo:[1,0,0] neg_hi:[1,0,0]
v_pk_fma_f32 v[118:119], v[218:219], v[76:77], v[118:119] op_sel:[0,1,0] op_sel_hi:[1,1,1] neg_lo:[1,0,0] neg_hi:[1,0,0]
v_cvt_pk_bf16_f32 v158, v116, v117
v_cvt_pk_bf16_f32 v159, v118, v119
s_waitcnt lgkmcnt(0)
v_pk_fma_f32 v[124:125], v[220:221], v[76:77], v[124:125] op_sel:[0,0,0] op_sel_hi:[1,0,1] neg_lo:[1,0,0] neg_hi:[1,0,0]
v_pk_fma_f32 v[126:127], v[222:223], v[76:77], v[126:127] op_sel:[0,0,0] op_sel_hi:[1,0,1] neg_lo:[1,0,0] neg_hi:[1,0,0]
v_pk_fma_f32 v[128:129], v[224:225], v[76:77], v[128:129] op_sel:[0,0,0] op_sel_hi:[1,0,1] neg_lo:[1,0,0] neg_hi:[1,0,0]
v_pk_fma_f32 v[130:131], v[226:227], v[76:77], v[130:131] op_sel:[0,0,0] op_sel_hi:[1,0,1] neg_lo:[1,0,0] neg_hi:[1,0,0]
v_pk_mul_f32 v[124:125], v[124:125], v[74:75] op_sel:[0,0] op_sel_hi:[1,0]
v_pk_mul_f32 v[126:127], v[126:127], v[74:75] op_sel:[0,0] op_sel_hi:[1,0]
v_pk_mul_f32 v[128:129], v[128:129], v[74:75] op_sel:[0,0] op_sel_hi:[1,0]
v_pk_mul_f32 v[130:131], v[130:131], v[74:75] op_sel:[0,0] op_sel_hi:[1,0]
v_pk_mul_f32 v[132:133], v[132:133], v[74:75] op_sel:[0,0] op_sel_hi:[1,0]
v_pk_mul_f32 v[134:135], v[134:135], v[74:75] op_sel:[0,0] op_sel_hi:[1,0]
v_pk_fma_f32 v[136:137], v[220:221], v[76:77], v[136:137] op_sel:[0,1,0] op_sel_hi:[1,1,1] neg_lo:[1,0,0] neg_hi:[1,0,0]
v_pk_fma_f32 v[138:139], v[222:223], v[76:77], v[138:139] op_sel:[0,1,0] op_sel_hi:[1,1,1] neg_lo:[1,0,0] neg_hi:[1,0,0]
v_pk_fma_f32 v[140:141], v[224:225], v[76:77], v[140:141] op_sel:[0,1,0] op_sel_hi:[1,1,1] neg_lo:[1,0,0] neg_hi:[1,0,0]
v_pk_fma_f32 v[142:143], v[226:227], v[76:77], v[142:143] op_sel:[0,1,0] op_sel_hi:[1,1,1] neg_lo:[1,0,0] neg_hi:[1,0,0]
v_pk_mul_f32 v[136:137], v[136:137], v[74:75] op_sel:[0,1] op_sel_hi:[1,1]
v_pk_mul_f32 v[138:139], v[138:139], v[74:75] op_sel:[0,1] op_sel_hi:[1,1]
v_pk_mul_f32 v[140:141], v[140:141], v[74:75] op_sel:[0,1] op_sel_hi:[1,1]
v_pk_mul_f32 v[142:143], v[142:143], v[74:75] op_sel:[0,1] op_sel_hi:[1,1]
v_pk_mul_f32 v[144:145], v[144:145], v[74:75] op_sel:[0,1] op_sel_hi:[1,1]
v_pk_mul_f32 v[146:147], v[146:147], v[74:75] op_sel:[0,1] op_sel_hi:[1,1]
v_mfma_f32_16x16x32_bf16 v[100:103], a[148:151], v[148:151], 0
s_xor_b32 s55, s13, 1
v_mul_f32 v72, 0x3fb8aa3b, v74
v_mul_f32 v73, 0x3fb8aa3b, v75
v_mfma_f32_16x16x32_bf16 v[100:103], a[152:155], v[152:155], v[100:103]
s_mul_i32 s39, s55, 72
v_cvt_pk_bf16_f32 v124, v124, v125
v_cvt_pk_bf16_f32 v125, v126, v127
v_mfma_f32_16x16x32_bf16 v[104:107], a[156:159], v[148:151], 0
s_and_b32 s39, s39, 0xfffffff0
v_cvt_pk_bf16_f32 v126, v128, v129
v_cvt_pk_bf16_f32 v127, v130, v131
v_mfma_f32_16x16x32_bf16 v[104:107], a[160:163], v[152:155], v[104:107]
s_mul_i32 s32, s12, 20736
v_cvt_pk_bf16_f32 v128, v132, v133
v_cvt_pk_bf16_f32 v129, v134, v135
v_mfma_f32_16x16x32_bf16 v[108:111], a[164:167], v[148:151], 0
s_add_u32 s32, s32, s39
v_cndmask_b32 v128, v35, v128, s[88:89]
v_cndmask_b32 v129, v35, v129, s[88:89]
v_mfma_f32_16x16x32_bf16 v[108:111], a[168:171], v[152:155], v[108:111]
s_lshl_b32 s34, s12, 8
v_cvt_pk_bf16_f32 v136, v136, v137
v_cvt_pk_bf16_f32 v137, v138, v139
v_mfma_f32_16x16x32_bf16 v[112:115], a[148:151], v[156:159], 0
s_cmp_eq_u32 s12, 0
s_cselect_b32 s33, 1, 0
v_cvt_pk_bf16_f32 v138, v140, v141
v_cvt_pk_bf16_f32 v139, v142, v143
v_mfma_f32_16x16x32_bf16 v[112:115], a[152:155], v[160:163], v[112:115]
s_mul_i32 s100, s12, 165888
v_cvt_pk_bf16_f32 v140, v144, v145
v_cvt_pk_bf16_f32 v141, v146, v147
v_mfma_f32_16x16x32_bf16 v[116:119], a[156:159], v[156:159], 0
s_add_u32 s100, s100, s39
v_cndmask_b32 v140, v35, v140, s[88:89]
v_cndmask_b32 v141, v35, v141, s[88:89]
v_mfma_f32_16x16x32_bf16 v[116:119], a[160:163], v[160:163], v[116:119]
s_add_u32 s100, s100, 18432
ds_write_b64 v36, v[124:125] offset:160
ds_write_b32 v37, v126 offset:192
v_mfma_f32_16x16x32_bf16 v[120:123], a[164:167], v[156:159], 0
s_add_u32 s101, s49, s39
ds_write_b32 v36, v127 offset:200
v_mfma_f32_16x16x32_bf16 v[120:123], a[168:171], v[160:163], v[120:123]
v_max3_f32 v84, v100, v101, v102
v_min3_f32 v86, v100, v101, v102
ds_write_b32 v38, v128 offset:196
v_max3_f32 v85, v112, v113, v114
v_min3_f32 v87, v112, v113, v114
ds_write_b32 v39, v129 offset:232
v_max3_f32 v84, v84, v103, v104
v_min3_f32 v86, v86, v103, v104
ds_write_b64 v36, v[136:137] offset:4000
v_max3_f32 v85, v85, v115, v116
v_min3_f32 v87, v87, v115, v116
ds_write_b32 v37, v138 offset:4032
v_max3_f32 v84, v84, v105, v106
v_min3_f32 v86, v86, v105, v106
ds_write_b32 v36, v139 offset:4040
v_max3_f32 v85, v85, v117, v118
v_min3_f32 v87, v87, v117, v118
ds_write_b32 v38, v140 offset:4036
v_max3_f32 v84, v84, v107, v108
v_min3_f32 v86, v86, v107, v108
ds_write_b32 v39, v141 offset:4072
v_max3_f32 v85, v85, v119, v120
v_min3_f32 v87, v87, v119, v120
v_pk_mov_b32 v[88:89], v[84:85], v[84:85] op_sel:[0,1]
v_pk_mov_b32 v[90:91], v[86:87], v[86:87] op_sel:[0,1]
s_nop 0
v_permlane16_swap_b32 v88, v84
v_permlane16_swap_b32 v89, v85
v_permlane16_swap_b32 v90, v86
v_permlane16_swap_b32 v91, v87
v_max_f32 v84, v84, v88
v_max_f32 v85, v85, v89
v_min_f32 v86, v86, v90
v_min_f32 v87, v87, v91
v_pk_mul_f32 v[84:85], v[84:85], v[72:73]
v_pk_mul_f32 v[86:87], v[86:87], v[72:73]
v_pk_fma_f32 v[124:125], v[100:101], v[72:73], v[86:87] op_sel:[0,0,0] op_sel_hi:[1,0,0] neg_lo:[1,0,0] neg_hi:[1,0,0]
v_pk_fma_f32 v[100:101], v[100:101], v[72:73], v[84:85] op_sel:[0,0,0] op_sel_hi:[1,0,0] neg_lo:[0,0,1] neg_hi:[0,0,1]
v_pk_fma_f32 v[126:127], v[102:103], v[72:73], v[86:87] op_sel:[0,0,0] op_sel_hi:[1,0,0] neg_lo:[1,0,0] neg_hi:[1,0,0]
v_pk_fma_f32 v[102:103], v[102:103], v[72:73], v[84:85] op_sel:[0,0,0] op_sel_hi:[1,0,0] neg_lo:[0,0,1] neg_hi:[0,0,1]
v_pk_fma_f32 v[128:129], v[104:105], v[72:73], v[86:87] op_sel:[0,0,0] op_sel_hi:[1,0,0] neg_lo:[1,0,0] neg_hi:[1,0,0]
s_add_u32 m0, s35, 30976
v_pk_fma_f32 v[104:105], v[104:105], v[72:73], v[84:85] op_sel:[0,0,0] op_sel_hi:[1,0,0] neg_lo:[0,0,1] neg_hi:[0,0,1]
v_pk_fma_f32 v[130:131], v[106:107], v[72:73], v[86:87] op_sel:[0,0,0] op_sel_hi:[1,0,0] neg_lo:[1,0,0] neg_hi:[1,0,0]
v_pk_fma_f32 v[106:107], v[106:107], v[72:73], v[84:85] op_sel:[0,0,0] op_sel_hi:[1,0,0] neg_lo:[0,0,1] neg_hi:[0,0,1]
v_pk_fma_f32 v[132:133], v[108:109], v[72:73], v[86:87] op_sel:[0,0,0] op_sel_hi:[1,0,0] neg_lo:[1,0,0] neg_hi:[1,0,0]
v_pk_fma_f32 v[108:109], v[108:109], v[72:73], v[84:85] op_sel:[0,0,0] op_sel_hi:[1,0,0] neg_lo:[0,0,1] neg_hi:[0,0,1]
buffer_load_dwordx4 v13, s[20:23], s45 offen offset:0 sc1 lds
v_pk_fma_f32 v[136:137], v[112:113], v[72:73], v[86:87] op_sel:[0,1,1] op_sel_hi:[1,1,1] neg_lo:[1,0,0] neg_hi:[1,0,0]
v_pk_fma_f32 v[112:113], v[112:113], v[72:73], v[84:85] op_sel:[0,1,1] op_sel_hi:[1,1,1] neg_lo:[0,0,1] neg_hi:[0,0,1]
v_pk_fma_f32 v[138:139], v[114:115], v[72:73], v[86:87] op_sel:[0,1,1] op_sel_hi:[1,1,1] neg_lo:[1,0,0] neg_hi:[1,0,0]
v_pk_fma_f32 v[114:115], v[114:115], v[72:73], v[84:85] op_sel:[0,1,1] op_sel_hi:[1,1,1] neg_lo:[0,0,1] neg_hi:[0,0,1]
v_pk_fma_f32 v[140:141], v[116:117], v[72:73], v[86:87] op_sel:[0,1,1] op_sel_hi:[1,1,1] neg_lo:[1,0,0] neg_hi:[1,0,0]
buffer_load_dwordx4 v14, s[20:23], s45 offen offset:1024 sc1 lds
v_pk_fma_f32 v[116:117], v[116:117], v[72:73], v[84:85] op_sel:[0,1,1] op_sel_hi:[1,1,1] neg_lo:[0,0,1] neg_hi:[0,0,1]
v_pk_fma_f32 v[142:143], v[118:119], v[72:73], v[86:87] op_sel:[0,1,1] op_sel_hi:[1,1,1] neg_lo:[1,0,0] neg_hi:[1,0,0]
v_pk_fma_f32 v[118:119], v[118:119], v[72:73], v[84:85] op_sel:[0,1,1] op_sel_hi:[1,1,1] neg_lo:[0,0,1] neg_hi:[0,0,1]
v_pk_fma_f32 v[144:145], v[120:121], v[72:73], v[86:87] op_sel:[0,1,1] op_sel_hi:[1,1,1] neg_lo:[1,0,0] neg_hi:[1,0,0]
v_pk_fma_f32 v[120:121], v[120:121], v[72:73], v[84:85] op_sel:[0,1,1] op_sel_hi:[1,1,1] neg_lo:[0,0,1] neg_hi:[0,0,1]
s_add_u32 m0, s35, 32256
v_exp_f32 v100, v100
v_exp_f32 v101, v101
v_exp_f32 v102, v102
v_exp_f32 v103, v103
v_exp_f32 v104, v104
buffer_load_dwordx4 v13, s[20:23], s46 offen offset:0 sc1 lds
v_exp_f32 v105, v105
v_exp_f32 v106, v106
v_exp_f32 v107, v107
v_exp_f32 v108, v108
v_exp_f32 v112, v112
buffer_load_dwordx4 v14, s[20:23], s46 offen offset:1024 sc1 lds
v_exp_f32 v113, v113
v_exp_f32 v114, v114
v_exp_f32 v115, v115
v_exp_f32 v116, v116
v_exp_f32 v117, v117
s_add_u32 m0, s35, 33536
v_exp_f32 v118, v118
v_exp_f32 v119, v119
v_exp_f32 v120, v120
v_exp_f32 v124, v124
v_exp_f32 v125, v125
buffer_load_dwordx4 v13, s[20:23], s47 offen offset:0 sc1 lds
v_exp_f32 v126, v126
v_exp_f32 v127, v127
v_exp_f32 v128, v128
v_exp_f32 v129, v129
v_exp_f32 v130, v130
buffer_load_dwordx4 v14, s[20:23], s47 offen offset:1024 sc1 lds
v_exp_f32 v131, v131
v_exp_f32 v132, v132
v_exp_f32 v136, v136
v_exp_f32 v137, v137
v_exp_f32 v138, v138
s_add_u32 m0, s35, 34816
v_exp_f32 v139, v139
v_exp_f32 v140, v140
v_exp_f32 v141, v141
v_exp_f32 v142, v142
v_exp_f32 v143, v143
buffer_load_dwordx4 v13, s[20:23], s48 offen offset:0 sc1 lds
v_exp_f32 v144, v144
v_pk_add_f32 v[110:111], v[100:101], v[102:103]
v_pk_add_f32 v[122:123], v[112:113], v[114:115]
v_pk_add_f32 v[134:135], v[124:125], v[126:127]
v_pk_add_f32 v[146:147], v[136:137], v[138:139]
buffer_load_dwordx4 v14, s[20:23], s48 offen offset:1024 sc1 lds
v_pk_add_f32 v[110:111], v[110:111], v[104:105]
v_pk_add_f32 v[122:123], v[122:123], v[116:117]
v_pk_add_f32 v[134:135], v[134:135], v[128:129]
v_pk_add_f32 v[146:147], v[146:147], v[140:141]
v_pk_add_f32 v[110:111], v[110:111], v[106:107]
buffer_load_dword v50, v49, s[24:27], s34 offen sc1
v_pk_add_f32 v[122:123], v[122:123], v[118:119]
v_pk_add_f32 v[134:135], v[134:135], v[130:131]
v_pk_add_f32 v[146:147], v[146:147], v[142:143]
v_add_f32 v84, v110, v108
v_add_f32 v85, v122, v120
buffer_load_dwordx4 a[172:175], v70, s[56:59], s8 offen
v_add_f32 v86, v134, v132
v_add_f32 v87, v146, v144
v_add_f32 v84, v84, v111
v_add_f32 v85, v85, v123
v_add_f32 v86, v86, v135
buffer_load_dwordx4 a[176:179], v70, s[56:59], s9 offen
v_add_f32 v87, v87, v147
v_pk_mov_b32 v[88:89], v[84:85], v[84:85] op_sel:[0,1]
v_pk_mov_b32 v[90:91], v[86:87], v[86:87] op_sel:[0,1]
s_nop 0
v_permlane16_swap_b32 v88, v84
v_permlane16_swap_b32 v89, v85
buffer_load_dword a255, v69, s[96:99], s11 offen offset:0
v_permlane16_swap_b32 v90, v86
v_permlane16_swap_b32 v91, v87
v_pk_add_f32 v[84:85], v[84:85], v[88:89]
v_pk_add_f32 v[86:87], v[86:87], v[90:91]
v_rcp_f32 v84, v84
v_rcp_f32 v85, v85
v_rcp_f32 v86, v86
v_rcp_f32 v87, v87
v_pk_mul_f32 v[100:101], v[100:101], v[84:85] op_sel:[0,0] op_sel_hi:[1,0]
v_pk_mul_f32 v[102:103], v[102:103], v[84:85] op_sel:[0,0] op_sel_hi:[1,0]
v_pk_mul_f32 v[104:105], v[104:105], v[84:85] op_sel:[0,0] op_sel_hi:[1,0]
v_pk_mul_f32 v[106:107], v[106:107], v[84:85] op_sel:[0,0] op_sel_hi:[1,0]
v_mul_f32 v108, v108, v84
v_cvt_pk_bf16_f32 v164, v100, v101
v_cvt_pk_bf16_f32 v165, v102, v103
v_cvt_pk_bf16_f32 v166, v104, v105
v_cvt_pk_bf16_f32 v167, v106, v107
v_cvt_pk_bf16_f32 v168, v108, 0
v_pk_mul_f32 v[124:125], v[124:125], v[86:87] op_sel:[0,0] op_sel_hi:[1,0]
v_pk_mul_f32 v[126:127], v[126:127], v[86:87] op_sel:[0,0] op_sel_hi:[1,0]
v_pk_mul_f32 v[128:129], v[128:129], v[86:87] op_sel:[0,0] op_sel_hi:[1,0]
ds_write_b64 v40, v[164:165] offset:0
v_pk_mul_f32 v[130:131], v[130:131], v[86:87] op_sel:[0,0] op_sel_hi:[1,0]
v_mul_f32 v132, v132, v86
v_cvt_pk_bf16_f32 v169, v124, v125
ds_write_b64 v40, v[166:167] offset:8
v_cvt_pk_bf16_f32 v170, v126, v127
v_cvt_pk_bf16_f32 v171, v128, v129
v_cvt_pk_bf16_f32 v172, v130, v131
v_cvt_pk_bf16_f32 v173, v132, 0
v_pk_mul_f32 v[112:113], v[112:113], v[84:85] op_sel:[0,1] op_sel_hi:[1,1]
v_pk_mul_f32 v[114:115], v[114:115], v[84:85] op_sel:[0,1] op_sel_hi:[1,1]
v_pk_mul_f32 v[116:117], v[116:117], v[84:85] op_sel:[0,1] op_sel_hi:[1,1]
ds_write_b64 v40, v[168:169] offset:16
v_pk_mul_f32 v[118:119], v[118:119], v[84:85] op_sel:[0,1] op_sel_hi:[1,1]
v_mul_f32 v120, v120, v85
v_cvt_pk_bf16_f32 v176, v112, v113
ds_write_b64 v40, v[170:171] offset:24
v_cvt_pk_bf16_f32 v177, v114, v115
v_cvt_pk_bf16_f32 v178, v116, v117
v_cvt_pk_bf16_f32 v179, v118, v119
ds_write_b64 v40, v[172:173] offset:32
v_cvt_pk_bf16_f32 v180, v120, 0
v_pk_mul_f32 v[136:137], v[136:137], v[86:87] op_sel:[0,1] op_sel_hi:[1,1]
v_pk_mul_f32 v[138:139], v[138:139], v[86:87] op_sel:[0,1] op_sel_hi:[1,1]
v_pk_mul_f32 v[140:141], v[140:141], v[86:87] op_sel:[0,1] op_sel_hi:[1,1]
s_waitcnt lgkmcnt(13)
ds_write_b64 v40, v[176:177] offset:3840
v_pk_mul_f32 v[142:143], v[142:143], v[86:87] op_sel:[0,1] op_sel_hi:[1,1]
v_mul_f32 v144, v144, v87
v_cvt_pk_bf16_f32 v181, v136, v137
ds_write_b64 v40, v[178:179] offset:3848
v_cvt_pk_bf16_f32 v182, v138, v139
v_cvt_pk_bf16_f32 v183, v140, v141
v_cvt_pk_bf16_f32 v184, v142, v143
v_cvt_pk_bf16_f32 v185, v144, 0
s_waitcnt lgkmcnt(13)
ds_write_b64 v40, v[180:181] offset:3856
ds_write_b64 v40, v[182:183] offset:3864
s_waitcnt lgkmcnt(13)
ds_write_b64 v40, v[184:185] offset:3872
s_waitcnt vmcnt(16) lgkmcnt(0)
s_barrier
ds_read_b64_tr_b16 v[188:189], v43 offset:0
ds_read_b64_tr_b16 v[190:191], v43 offset:240
ds_read_b64_tr_b16 v[192:193], v41 offset:0
ds_read_b64_tr_b16 v[194:195], v41 offset:240
ds_read_b64_tr_b16 v[196:197], v41 offset:32
ds_read_b64_tr_b16 v[198:199], v41 offset:272
ds_read_b64_tr_b16 v[200:201], v41 offset:64
ds_read_b64_tr_b16 v[202:203], v41 offset:304
ds_read_b64_tr_b16 v[204:205], v43 offset:36864
ds_read_b64_tr_b16 v[206:207], v43 offset:37104
ds_read_b64_tr_b16 v[208:209], v41 offset:36864
ds_read_b64_tr_b16 v[210:211], v41 offset:37104
ds_read_b64_tr_b16 v[212:213], v41 offset:36896
ds_read_b64_tr_b16 v[214:215], v41 offset:37136
s_branch iskip2
.p2align 12
ipad2:
s_branch iret0
iskip2:
s_mul_i32 s50, s13, 51200
s_add_u32 s50, s50, 8388608
s_mul_i32 s37, s14, 3200
s_mul_i32 s53, s52, 1600
s_add_u32 s37, s37, s53
s_add_u32 s53, s50, s37
v_mov_b32 v88, 0
v_mov_b32 v89, 0
v_mov_b32 v90, 0
v_mov_b32 v91, 0
buffer_store_dwordx4 v[88:91], v5, s[28:31], s3 offen sc1
s_waitcnt lgkmcnt(6)
v_mfma_f32_16x16x32_bf16 v[124:127], v[188:191], v[192:195], 0
ds_read_b64_tr_b16 v[216:217], v41 offset:36928
ds_read_b64_tr_b16 v[218:219], v41 offset:37168
ds_read_b64_tr_b16 v[220:221], v44 offset:0
v_mfma_f32_16x16x32_bf16 v[128:131], v[188:191], v[196:199], 0
ds_read_b64_tr_b16 v[222:223], v44 offset:240
ds_read_b64_tr_b16 v[224:225], v42 offset:0
ds_read_b64_tr_b16 v[226:227], v42 offset:240
v_mfma_f32_16x16x32_bf16 v[132:135], v[188:191], v[200:203], 0
ds_read_b64_tr_b16 v[228:229], v42 offset:32
ds_read_b64_tr_b16 v[230:231], v42 offset:272
ds_read_b64_tr_b16 v[232:233], v42 offset:64
s_waitcnt lgkmcnt(7)
v_mfma_f32_16x16x32_bf16 v[124:127], v[204:207], v[208:211], v[124:127]
ds_read_b64_tr_b16 v[234:235], v42 offset:304
ds_read_b64_tr_b16 v[236:237], v44 offset:36864
ds_read_b64_tr_b16 v[238:239], v44 offset:37104
v_mfma_f32_16x16x32_bf16 v[128:131], v[204:207], v[212:215], v[128:131]
ds_read_b64_tr_b16 v[240:241], v42 offset:36864
ds_read_b64_tr_b16 v[242:243], v42 offset:37104
ds_read_b64_tr_b16 v[244:245], v42 offset:36896
v_mfma_f32_16x16x32_bf16 v[132:135], v[204:207], v[216:219], v[132:135]
ds_read_b64_tr_b16 v[246:247], v42 offset:37136
ds_read_b64_tr_b16 v[248:249], v42 offset:36928
s_waitcnt lgkmcnt(13)
ds_read_b64_tr_b16 v[250:251], v42 offset:37168
s_waitcnt lgkmcnt(8)
v_mfma_f32_16x16x32_bf16 v[124:127], v[220:223], v[224:227], v[124:127]
v_mfma_f32_16x16x32_bf16 v[128:131], v[220:223], v[228:231], v[128:131]
v_mfma_f32_16x16x32_bf16 v[132:135], v[220:223], v[232:235], v[132:135]
s_waitcnt lgkmcnt(0)
v_mfma_f32_16x16x32_bf16 v[124:127], v[236:239], v[240:243], v[124:127]
v_mfma_f32_16x16x32_bf16 v[128:131], v[236:239], v[244:247], v[128:131]
v_mfma_f32_16x16x32_bf16 v[132:135], v[236:239], v[248:251], v[132:135]
ds_read_b64_tr_b16 a[180:181], v25 offset:24576
ds_read_b64_tr_b16 a[182:183], v25 offset:24656
ds_read_b64_tr_b16 a[184:185], v17 offset:24576
ds_read_b64_tr_b16 a[186:187], v17 offset:24656
ds_read_b64_tr_b16 a[188:189], v17 offset:24608
ds_read_b64_tr_b16 a[190:191], v17 offset:24688
ds_read_b64_tr_b16 a[192:193], v23 offset:24576
ds_read_b64_tr_b16 a[194:195], v23 offset:24656
v_cvt_pk_bf16_f32 v124, v124, v125
v_cvt_pk_bf16_f32 v125, v126, v127
buffer_store_dwordx2 v[124:125], v45, s[28:31], s53 offen offset:0 sc1
v_cvt_pk_bf16_f32 v128, v128, v129
v_cvt_pk_bf16_f32 v129, v130, v131
buffer_store_dwordx2 v[128:129], v45, s[28:31], s53 offen offset:128 sc1
v_cvt_pk_bf16_f32 v132, v132, v133
v_cvt_pk_bf16_f32 v133, v134, v135
buffer_store_dwordx2 v[132:133], v79, s[28:31], s53 offen offset:256 sc1
ds_read_b64_tr_b16 a[196:197], v26 offset:24576
ds_read_b64_tr_b16 a[198:199], v26 offset:24656
ds_read_b64_tr_b16 a[200:201], v18 offset:24576
ds_read_b64_tr_b16 a[202:203], v18 offset:24656
ds_read_b64_tr_b16 a[204:205], v18 offset:24608
ds_read_b64_tr_b16 a[206:207], v18 offset:24688
ds_read_b64_tr_b16 a[208:209], v24 offset:24576
s_waitcnt lgkmcnt(13)
ds_read_b64_tr_b16 a[210:211], v24 offset:24656
s_waitcnt lgkmcnt(8)
v_mfma_f32_16x16x32_bf16 v[208:211], a[144:147], a[180:183], 0
s_add_u32 m0, s35, 20480
ds_read_b64_tr_b16 a[212:213], v25 offset:25856
ds_read_b64_tr_b16 a[214:215], v25 offset:25936
v_mfma_f32_16x16x32_bf16 v[100:103], a[184:187], a[0:3], 0
buffer_load_dwordx4 v56, s[16:19], s101 offen offset:0 sc1 lds
ds_read_b64_tr_b16 a[216:217], v17 offset:25856
v_mfma_f32_16x16x32_bf16 v[112:115], a[184:187], a[4:7], 0
s_lshl_b32 s78, s13, 11
ds_read_b64_tr_b16 a[218:219], v17 offset:25936
v_lshrrev_b32 v95, 5, v1
v_mfma_f32_16x16x32_bf16 v[104:107], a[188:191], a[0:3], 0
s_add_u32 s78, s78, 13631488
ds_read_b64_tr_b16 a[220:221], v17 offset:25888
v_lshlrev_b32 v92, 4, v2
v_mfma_f32_16x16x32_bf16 v[116:119], a[188:191], a[4:7], 0
s_lshl_b32 s79, s14, 7
ds_read_b64_tr_b16 a[222:223], v17 offset:25968
v_lshl_add_u32 v68, v3, 9, v92
v_mfma_f32_16x16x32_bf16 v[108:111], a[192:195], a[0:3], 0
buffer_load_dwordx4 v57, s[16:19], s101 offen offset:1024 sc1 lds
ds_read_b64_tr_b16 a[224:225], v23 offset:25856
v_mfma_f32_16x16x32_bf16 v[120:123], a[192:195], a[4:7], 0
s_waitcnt lgkmcnt(7)
ds_read_b64_tr_b16 a[226:227], v23 offset:25936
s_add_u32 s79, s79, s78
v_mfma_f32_16x16x32_bf16 v[208:211], a[144:147], a[196:199], v[208:211]
ds_read_b64_tr_b16 a[180:181], v26 offset:25856
ds_read_b64_tr_b16 a[182:183], v26 offset:25936
v_mfma_f32_16x16x32_bf16 v[100:103], a[200:203], a[8:11], v[100:103]
ds_read_b64_tr_b16 a[184:185], v18 offset:25856
v_lshl_add_u32 v92, v95, 2, v92
v_mfma_f32_16x16x32_bf16 v[112:115], a[200:203], a[12:15], v[112:115]
buffer_load_dwordx4 v58, s[16:19], s101 offen offset:2048 sc1 lds
ds_read_b64_tr_b16 a[186:187], v18 offset:25936
v_mfma_f32_16x16x32_bf16 v[104:107], a[204:207], a[8:11], v[104:107]
s_mov_b32 s91, 0x3f800000
ds_read_b64_tr_b16 a[188:189], v18 offset:25888
v_and_b32 v93, 1, v3
v_mfma_f32_16x16x32_bf16 v[116:119], a[204:207], a[12:15], v[116:119]
s_lshr_b32 s94, s15, 2
ds_read_b64_tr_b16 a[190:191], v18 offset:25968
v_lshl_add_u32 v63, v93, 3, v92
v_mfma_f32_16x16x32_bf16 v[108:111], a[208:211], a[8:11], v[108:111]
s_mul_i32 s45, s94, 73728
ds_read_b64_tr_b16 a[192:193], v24 offset:25856
v_min_u32 v64, 1, v1
v_mfma_f32_16x16x32_bf16 v[120:123], a[208:211], a[12:15], v[120:123]
s_waitcnt lgkmcnt(7)
ds_read_b64_tr_b16 a[194:195], v24 offset:25936
s_and_b32 s94, s15, 3
v_mfma_f32_16x16x32_bf16 v[208:211], a[144:147], a[212:215], v[208:211]
s_waitcnt vmcnt(10)
ds_read_b64_tr_b16 a[196:197], v25 offset:27136
ds_read_b64_tr_b16 a[198:199], v25 offset:27216
v_mfma_f32_16x16x32_bf16 v[100:103], a[216:219], a[16:19], v[100:103]
ds_read_b64_tr_b16 a[200:201], v17 offset:27136
v_cmp_eq_u32 s[92:93], s33, v50
v_mfma_f32_16x16x32_bf16 v[112:115], a[216:219], a[20:23], v[112:115]
ds_read_b64_tr_b16 a[202:203], v17 offset:27216
v_lshlrev_b32 v64, 30, v64
v_mfma_f32_16x16x32_bf16 v[104:107], a[220:223], a[16:19], v[104:107]
s_lshl_b32 s94, s94, 10
ds_read_b64_tr_b16 a[204:205], v17 offset:27168
v_mov_b32 v84, -1
v_mfma_f32_16x16x32_bf16 v[116:119], a[220:223], a[20:23], v[116:119]
s_add_u32 s45, s45, s94
ds_read_b64_tr_b16 a[206:207], v17 offset:27248
v_mov_b32 v85, -1
v_mfma_f32_16x16x32_bf16 v[108:111], a[224:227], a[16:19], v[108:111]
s_lshr_b32 s94, s13, 3
ds_read_b64_tr_b16 a[208:209], v23 offset:27136
v_mov_b32 v86, -1
v_mfma_f32_16x16x32_bf16 v[120:123], a[224:227], a[20:23], v[120:123]
s_waitcnt lgkmcnt(7)
ds_read_b64_tr_b16 a[210:211], v23 offset:27216
s_add_u32 s94, s94, 16
v_mfma_f32_16x16x32_bf16 v[208:211], a[144:147], a[180:183], v[208:211]
s_cmp_eq_u64 s[92:93], exec
s_cbranch_scc0 sequential_preLN__linear_kernel_hedgehog__glu_gated_bilinear__prompt_kernel_slow0
sequential_preLN__linear_kernel_hedgehog__glu_gated_bilinear__prompt_kernel_back0:
ds_read_b64_tr_b16 a[212:213], v26 offset:27136
ds_read_b64_tr_b16 a[214:215], v26 offset:27216
v_mfma_f32_16x16x32_bf16 v[100:103], a[184:187], a[24:27], v[100:103]
ds_read_b64_tr_b16 a[216:217], v18 offset:27136
v_mov_b32 v87, -1
v_mfma_f32_16x16x32_bf16 v[112:115], a[184:187], a[28:31], v[112:115]
s_lshl_b32 s94, s94, 12
ds_read_b64_tr_b16 a[218:219], v18 offset:27216
v_cmp_gt_u32 vcc, 200, v0
v_mfma_f32_16x16x32_bf16 v[104:107], a[188:191], a[24:27], v[104:107]
s_add_u32 s43, s45, s94
ds_read_b64_tr_b16 a[220:221], v18 offset:27168
v_lshlrev_b32 v92, 4, v0
v_mfma_f32_16x16x32_bf16 v[116:119], a[188:191], a[28:31], v[116:119]
s_and_b32 s94, s13, 7
ds_read_b64_tr_b16 a[222:223], v18 offset:27248
v_mul_u32_u24 v97, 3277, v0
v_mfma_f32_16x16x32_bf16 v[108:111], a[192:195], a[24:27], v[108:111]
s_lshl_b32 s94, s94, 8
ds_read_b64_tr_b16 a[224:225], v24 offset:27136
v_cndmask_b32 v59, v4, v92, vcc
v_mfma_f32_16x16x32_bf16 v[120:123], a[192:195], a[28:31], v[120:123]
s_waitcnt lgkmcnt(7)
ds_read_b64_tr_b16 a[226:227], v24 offset:27216
s_add_u32 s47, s43, s94
s_waitcnt vmcnt(3)
s_barrier
v_mfma_f32_16x16x32_bf16 v[208:211], a[144:147], a[196:199], v[208:211]
buffer_store_dword v48, v47, s[28:31], s79 offen sc1
ds_read_b64_tr_b16 a[180:181], v25 offset:28416
v_mfma_f32_16x16x32_bf16 v[100:103], a[200:203], a[32:35], v[100:103]
ds_read_b64_tr_b16 a[182:183], v25 offset:28496
ds_read_b64_tr_b16 a[184:185], v17 offset:28416
v_mfma_f32_16x16x32_bf16 v[112:115], a[200:203], a[36:39], v[112:115]
ds_read_b64_tr_b16 a[186:187], v17 offset:28496
v_lshrrev_b32 v97, 16, v97
v_mfma_f32_16x16x32_bf16 v[104:107], a[204:207], a[32:35], v[104:107]
s_add_u32 s47, s47, 5242880
ds_read_b64_tr_b16 a[188:189], v17 offset:28448
v_mul_u32_u24 v96, 20, v97
v_mfma_f32_16x16x32_bf16 v[116:119], a[204:207], a[36:39], v[116:119]
s_lshl_b32 s94, s55, 12
ds_read_b64_tr_b16 a[190:191], v17 offset:28528
v_sub_u32 v96, v0, v96
v_mfma_f32_16x16x32_bf16 v[108:111], a[208:211], a[32:35], v[108:111]
s_add_u32 s42, s45, s94
ds_read_b64_tr_b16 a[192:193], v23 offset:28416
v_cmp_gt_u32 vcc, 20, v96
v_mfma_f32_16x16x32_bf16 v[120:123], a[208:211], a[36:39], v[120:123]
s_waitcnt lgkmcnt(7)
ds_read_b64_tr_b16 a[194:195], v23 offset:28496
s_add_u32 s42, s42, 0
v_mfma_f32_16x16x32_bf16 v[208:211], a[144:147], a[212:215], v[208:211]
s_add_u32 m0, s35, 8192
ds_read_b64_tr_b16 a[196:197], v26 offset:28416
ds_read_b64_tr_b16 a[198:199], v26 offset:28496
v_mfma_f32_16x16x32_bf16 v[100:103], a[216:219], a[40:43], v[100:103]
buffer_load_dwordx4 v52, s[60:63], s32 offen offset:0 sc1 lds
ds_read_b64_tr_b16 a[200:201], v18 offset:28416
v_mfma_f32_16x16x32_bf16 v[112:115], a[216:219], a[44:47], v[112:115]
ds_read_b64_tr_b16 a[202:203], v18 offset:28496
v_mul_u32_u24 v98, 80, v96
v_mfma_f32_16x16x32_bf16 v[104:107], a[220:223], a[40:43], v[104:107]
s_add_u32 s45, s45, 5242880
ds_read_b64_tr_b16 a[204:205], v18 offset:28448
v_mul_u32_u24 v95, 52, v97
v_mfma_f32_16x16x32_bf16 v[116:119], a[220:223], a[44:47], v[116:119]
s_lshl_b32 s94, s13, 12
ds_read_b64_tr_b16 a[206:207], v18 offset:28528
v_lshrrev_b32 v95, 8, v95
v_mfma_f32_16x16x32_bf16 v[108:111], a[224:227], a[40:43], v[108:111]
buffer_load_dwordx4 v53, s[60:63], s32 offen offset:1024 sc1 lds
ds_read_b64_tr_b16 a[208:209], v24 offset:28416
v_mfma_f32_16x16x32_bf16 v[120:123], a[224:227], a[44:47], v[120:123]
s_waitcnt lgkmcnt(7)
ds_read_b64_tr_b16 a[210:211], v24 offset:28496
s_add_u32 s32, s32, 82944
v_mfma_f32_16x16x32_bf16 v[208:211], a[144:147], a[180:183], v[208:211]
s_add_u32 m0, s35, 9472
ds_read_b64_tr_b16 a[212:213], v25 offset:29696
ds_read_b64_tr_b16 a[214:215], v25 offset:29776
v_mfma_f32_16x16x32_bf16 v[100:103], a[184:187], a[48:51], v[100:103]
s_add_u32 s46, s45, s94
ds_read_b64_tr_b16 a[216:217], v17 offset:29696
v_mul_u32_u24 v95, 1560, v95
v_mfma_f32_16x16x32_bf16 v[112:115], a[184:187], a[52:55], v[112:115]
buffer_load_dwordx4 v52, s[60:63], s32 offen offset:0 sc1 lds
ds_read_b64_tr_b16 a[218:219], v17 offset:29776
v_mfma_f32_16x16x32_bf16 v[104:107], a[188:191], a[48:51], v[104:107]
s_lshl_b32 s41, s14, 13
ds_read_b64_tr_b16 a[220:221], v17 offset:29728
v_lshl_add_u32 v98, v97, 3, v98
v_mfma_f32_16x16x32_bf16 v[116:119], a[188:191], a[52:55], v[116:119]
s_add_u32 s41, s41, 13664256
ds_read_b64_tr_b16 a[222:223], v17 offset:29808
v_add_u32 v98, v98, v95
v_mfma_f32_16x16x32_bf16 v[108:111], a[192:195], a[48:51], v[108:111]
s_lshl_b32 s94, s13, 7
ds_read_b64_tr_b16 a[224:225], v23 offset:29696
v_cndmask_b32 v98, v4, v98, vcc
v_mfma_f32_16x16x32_bf16 v[120:123], a[192:195], a[52:55], v[120:123]
s_waitcnt lgkmcnt(7)
buffer_load_dwordx4 v53, s[60:63], s32 offen offset:1024 sc1 lds
ds_read_b64_tr_b16 a[226:227], v23 offset:29776
v_mfma_f32_16x16x32_bf16 v[208:211], a[144:147], a[196:199], v[208:211]
s_add_u32 s32, s32, 82944
ds_read_b64_tr_b16 a[180:181], v26 offset:29696
ds_read_b64_tr_b16 a[182:183], v26 offset:29776
v_mfma_f32_16x16x32_bf16 v[100:103], a[200:203], a[56:59], v[100:103]
s_add_u32 m0, s35, 10752
ds_read_b64_tr_b16 a[184:185], v18 offset:29696
s_add_u32 s40, s41, s94
v_mfma_f32_16x16x32_bf16 v[112:115], a[200:203], a[60:63], v[112:115]
ds_read_b64_tr_b16 a[186:187], v18 offset:29776
v_min_u32 v98, 3200, v98
v_mfma_f32_16x16x32_bf16 v[104:107], a[204:207], a[56:59], v[104:107]
buffer_load_dwordx4 v52, s[60:63], s32 offen offset:0 sc1 lds
ds_read_b64_tr_b16 a[188:189], v18 offset:29728
v_mfma_f32_16x16x32_bf16 v[116:119], a[204:207], a[60:63], v[116:119]
s_movk_i32 s90, 0x3f80
ds_read_b64_tr_b16 a[190:191], v18 offset:29808
v_add_u32 v60, 153472, v98
v_mfma_f32_16x16x32_bf16 v[108:111], a[208:211], a[56:59], v[108:111]
s_mov_b64 s[76:77], -1
ds_read_b64_tr_b16 a[192:193], v24 offset:29696
v_bfe_u32 v98, v1, 1, 1
v_mfma_f32_16x16x32_bf16 v[120:123], a[208:211], a[60:63], v[120:123]
s_waitcnt lgkmcnt(7)
ds_read_b64_tr_b16 a[194:195], v24 offset:29776
v_lshrrev_b32 v95, 5, v1
v_mfma_f32_16x16x32_bf16 v[208:211], a[144:147], a[212:215], v[208:211]
buffer_load_dwordx4 v53, s[60:63], s32 offen offset:1024 sc1 lds
ds_read_b64_tr_b16 a[196:197], v25 offset:30976
v_mfma_f32_16x16x32_bf16 v[100:103], a[216:219], a[64:67], v[100:103]
s_add_u32 s32, s32, 82944
ds_read_b64_tr_b16 a[198:199], v25 offset:31056
ds_read_b64_tr_b16 a[200:201], v17 offset:30976
v_mfma_f32_16x16x32_bf16 v[112:115], a[216:219], a[68:71], v[112:115]
ds_read_b64_tr_b16 a[202:203], v17 offset:31056
v_cmp_eq_u32 vcc, v98, v95
v_mfma_f32_16x16x32_bf16 v[104:107], a[220:223], a[64:67], v[104:107]
ds_read_b64_tr_b16 a[204:205], v17 offset:31008
v_bfe_u32 v97, v1, 2, 2
v_mfma_f32_16x16x32_bf16 v[116:119], a[220:223], a[68:71], v[116:119]
ds_read_b64_tr_b16 a[206:207], v17 offset:31088
v_mad_u32_u24 v96, v3, 20, v97
v_mfma_f32_16x16x32_bf16 v[108:111], a[224:227], a[64:67], v[108:111]
ds_read_b64_tr_b16 a[208:209], v23 offset:30976
v_mul_u32_u24 v96, 40, v96
v_mfma_f32_16x16x32_bf16 v[120:123], a[224:227], a[68:71], v[120:123]
s_waitcnt lgkmcnt(7)
ds_read_b64_tr_b16 a[210:211], v23 offset:31056
v_add_u32 v96, 153472, v96
v_mfma_f32_16x16x32_bf16 v[208:211], a[144:147], a[180:183], v[208:211]
s_add_u32 m0, s35, 12032
ds_read_b64_tr_b16 a[212:213], v26 offset:30976
ds_read_b64_tr_b16 a[214:215], v26 offset:31056
v_mfma_f32_16x16x32_bf16 v[100:103], a[184:187], a[72:75], v[100:103]
buffer_load_dwordx4 v52, s[60:63], s32 offen offset:0 sc1 lds
ds_read_b64_tr_b16 a[216:217], v18 offset:30976
v_mfma_f32_16x16x32_bf16 v[112:115], a[184:187], a[76:79], v[112:115]
ds_read_b64_tr_b16 a[218:219], v18 offset:31056
v_and_b32 v97, 1, v1
v_mfma_f32_16x16x32_bf16 v[104:107], a[188:191], a[72:75], v[104:107]
ds_read_b64_tr_b16 a[220:221], v18 offset:31008
v_lshl_add_u32 v94, v97, 4, v96
v_mfma_f32_16x16x32_bf16 v[116:119], a[188:191], a[76:79], v[116:119]
ds_read_b64_tr_b16 a[222:223], v18 offset:31088
v_mov_b32 v98, 152064
v_mfma_f32_16x16x32_bf16 v[108:111], a[192:195], a[72:75], v[108:111]
buffer_load_dwordx4 v53, s[60:63], s32 offen offset:1024 sc1 lds
ds_read_b64_tr_b16 a[224:225], v24 offset:30976
v_mfma_f32_16x16x32_bf16 v[120:123], a[192:195], a[76:79], v[120:123]
s_waitcnt lgkmcnt(7)
ds_read_b64_tr_b16 a[226:227], v24 offset:31056
s_add_u32 s32, s32, 82944
v_mfma_f32_16x16x32_bf16 v[208:211], a[144:147], a[196:199], v[208:211]
ds_read_b64_tr_b16 a[180:181], v25 offset:32256
ds_read_b64_tr_b16 a[182:183], v25 offset:32336
v_mfma_f32_16x16x32_bf16 v[100:103], a[200:203], a[80:83], v[100:103]
ds_read_b64_tr_b16 a[184:185], v17 offset:32256
v_cndmask_b32 v61, v98, v94, vcc
v_mfma_f32_16x16x32_bf16 v[112:115], a[200:203], a[84:87], v[112:115]
buffer_store_dwordx4 v[84:87], v5, s[28:31], s46 offen offset:0 sc1
ds_read_b64_tr_b16 a[186:187], v17 offset:32336
v_mfma_f32_16x16x32_bf16 v[104:107], a[204:207], a[80:83], v[104:107]
ds_read_b64_tr_b16 a[188:189], v17 offset:32288
v_cndmask_b32 v62, v98, v96, vcc
v_mfma_f32_16x16x32_bf16 v[116:119], a[204:207], a[84:87], v[116:119]
ds_read_b64_tr_b16 a[190:191], v17 offset:32368
v_mfma_f32_16x16x32_bf16 v[108:111], a[208:211], a[80:83], v[108:111]
ds_read_b64_tr_b16 a[192:193], v23 offset:32256
v_mfma_f32_16x16x32_bf16 v[120:123], a[208:211], a[84:87], v[120:123]
s_waitcnt lgkmcnt(7)
buffer_store_dwordx4 v[84:87], v5, s[28:31], s46 offen offset:1024 sc1
ds_read_b64_tr_b16 a[194:195], v23 offset:32336
v_mfma_f32_16x16x32_bf16 v[208:211], a[144:147], a[212:215], v[208:211]
s_add_u32 m0, s35, 13312
ds_read_b64_tr_b16 a[196:197], v26 offset:32256
ds_read_b64_tr_b16 a[198:199], v26 offset:32336
v_mfma_f32_16x16x32_bf16 v[100:103], a[216:219], a[88:91], v[100:103]
ds_read_b64_tr_b16 a[200:201], v18 offset:32256
v_mfma_f32_16x16x32_bf16 v[112:115], a[216:219], a[92:95], v[112:115]
ds_read_b64_tr_b16 a[202:203], v18 offset:32336
v_mfma_f32_16x16x32_bf16 v[104:107], a[220:223], a[88:91], v[104:107]
buffer_load_dwordx4 v52, s[60:63], s32 offen offset:0 sc1 lds
ds_read_b64_tr_b16 a[204:205], v18 offset:32288
v_mfma_f32_16x16x32_bf16 v[116:119], a[220:223], a[92:95], v[116:119]
ds_read_b64_tr_b16 a[206:207], v18 offset:32368
v_mfma_f32_16x16x32_bf16 v[108:111], a[224:227], a[88:91], v[108:111]
ds_read_b64_tr_b16 a[208:209], v24 offset:32256
v_mfma_f32_16x16x32_bf16 v[120:123], a[224:227], a[92:95], v[120:123]
s_waitcnt lgkmcnt(7)
ds_read_b64_tr_b16 a[210:211], v24 offset:32336
v_mfma_f32_16x16x32_bf16 v[208:211], a[144:147], a[180:183], v[208:211]
buffer_load_dwordx4 v53, s[60:63], s32 offen offset:1024 sc1 lds
ds_read_b64_tr_b16 a[212:213], v25 offset:33536
v_mfma_f32_16x16x32_bf16 v[100:103], a[184:187], a[96:99], v[100:103]
s_add_u32 s32, s32, 82944
ds_read_b64_tr_b16 a[214:215], v25 offset:33616
ds_read_b64_tr_b16 a[216:217], v17 offset:33536
v_mfma_f32_16x16x32_bf16 v[112:115], a[184:187], a[100:103], v[112:115]
ds_read_b64_tr_b16 a[218:219], v17 offset:33616
v_mfma_f32_16x16x32_bf16 v[104:107], a[188:191], a[96:99], v[104:107]
ds_read_b64_tr_b16 a[220:221], v17 offset:33568
v_mfma_f32_16x16x32_bf16 v[116:119], a[188:191], a[100:103], v[116:119]
buffer_store_dword v84, v63, s[28:31], s47 offen offset:0 sc1
ds_read_b64_tr_b16 a[222:223], v17 offset:33648
v_mfma_f32_16x16x32_bf16 v[108:111], a[192:195], a[96:99], v[108:111]
ds_read_b64_tr_b16 a[224:225], v23 offset:33536
v_mfma_f32_16x16x32_bf16 v[120:123], a[192:195], a[100:103], v[120:123]
s_waitcnt lgkmcnt(7)
ds_read_b64_tr_b16 a[226:227], v23 offset:33616
v_mfma_f32_16x16x32_bf16 v[208:211], a[144:147], a[196:199], v[208:211]
ds_read_b64_tr_b16 a[180:181], v26 offset:33536
ds_read_b64_tr_b16 a[182:183], v26 offset:33616
v_mfma_f32_16x16x32_bf16 v[100:103], a[200:203], a[104:107], v[100:103]
ds_read_b64_tr_b16 a[184:185], v18 offset:33536
v_mfma_f32_16x16x32_bf16 v[112:115], a[200:203], a[108:111], v[112:115]
ds_read_b64_tr_b16 a[186:187], v18 offset:33616
v_mfma_f32_16x16x32_bf16 v[104:107], a[204:207], a[104:107], v[104:107]
ds_read_b64_tr_b16 a[188:189], v18 offset:33568
v_mfma_f32_16x16x32_bf16 v[116:119], a[204:207], a[108:111], v[116:119]
ds_read_b64_tr_b16 a[190:191], v18 offset:33648
v_mfma_f32_16x16x32_bf16 v[108:111], a[208:211], a[104:107], v[108:111]
ds_read_b64_tr_b16 a[192:193], v24 offset:33536
v_mfma_f32_16x16x32_bf16 v[120:123], a[208:211], a[108:111], v[120:123]
s_waitcnt lgkmcnt(7)
ds_read_b64_tr_b16 a[194:195], v24 offset:33616
v_mfma_f32_16x16x32_bf16 v[208:211], a[144:147], a[212:215], v[208:211]
buffer_load_dword v51, v46, s[28:31], s78 offen sc1
ds_read_b64_tr_b16 a[196:197], v25 offset:34816
v_mfma_f32_16x16x32_bf16 v[100:103], a[216:219], a[112:115], v[100:103]
ds_read_b64_tr_b16 a[198:199], v25 offset:34896
ds_read_b64_tr_b16 a[200:201], v17 offset:34816
v_mfma_f32_16x16x32_bf16 v[112:115], a[216:219], a[116:119], v[112:115]
ds_read_b64_tr_b16 a[202:203], v17 offset:34896
v_mfma_f32_16x16x32_bf16 v[104:107], a[220:223], a[112:115], v[104:107]
ds_read_b64_tr_b16 a[204:205], v17 offset:34848
v_mfma_f32_16x16x32_bf16 v[116:119], a[220:223], a[116:119], v[116:119]
ds_read_b64_tr_b16 a[206:207], v17 offset:34928
v_mfma_f32_16x16x32_bf16 v[108:111], a[224:227], a[112:115], v[108:111]
ds_read_b64_tr_b16 a[208:209], v23 offset:34816
v_mfma_f32_16x16x32_bf16 v[120:123], a[224:227], a[116:119], v[120:123]
s_waitcnt lgkmcnt(7)
ds_read_b64_tr_b16 a[210:211], v23 offset:34896
v_mfma_f32_16x16x32_bf16 v[208:211], a[144:147], a[180:183], v[208:211]
ds_read_b64_tr_b16 a[212:213], v26 offset:34816
ds_read_b64_tr_b16 a[214:215], v26 offset:34896
v_mfma_f32_16x16x32_bf16 v[100:103], a[184:187], a[120:123], v[100:103]
ds_read_b64_tr_b16 a[216:217], v18 offset:34816
v_mfma_f32_16x16x32_bf16 v[112:115], a[184:187], a[124:127], v[112:115]
ds_read_b64_tr_b16 a[218:219], v18 offset:34896
v_mfma_f32_16x16x32_bf16 v[104:107], a[188:191], a[120:123], v[104:107]
ds_read_b64_tr_b16 a[220:221], v18 offset:34848
v_mfma_f32_16x16x32_bf16 v[116:119], a[188:191], a[124:127], v[116:119]
ds_read_b64_tr_b16 a[222:223], v18 offset:34928
v_mfma_f32_16x16x32_bf16 v[108:111], a[192:195], a[120:123], v[108:111]
ds_read_b64_tr_b16 a[224:225], v24 offset:34816
v_mfma_f32_16x16x32_bf16 v[120:123], a[192:195], a[124:127], v[120:123]
s_waitcnt lgkmcnt(7)
ds_read_b64_tr_b16 a[226:227], v24 offset:34896
v_mfma_f32_16x16x32_bf16 v[208:211], a[144:147], a[196:199], v[208:211]
v_mfma_f32_16x16x32_bf16 v[100:103], a[200:203], a[128:131], v[100:103]
v_mfma_f32_16x16x32_bf16 v[112:115], a[200:203], a[132:135], v[112:115]
v_mfma_f32_16x16x32_bf16 v[104:107], a[204:207], a[128:131], v[104:107]
v_mfma_f32_16x16x32_bf16 v[116:119], a[204:207], a[132:135], v[116:119]
v_mfma_f32_16x16x32_bf16 v[108:111], a[208:211], a[128:131], v[108:111]
v_mfma_f32_16x16x32_bf16 v[120:123], a[208:211], a[132:135], v[120:123]
s_waitcnt lgkmcnt(0)
v_mfma_f32_16x16x32_bf16 v[208:211], a[144:147], a[212:215], v[208:211]
v_mfma_f32_16x16x32_bf16 v[100:103], a[216:219], a[136:139], v[100:103]
v_mfma_f32_16x16x32_bf16 v[112:115], a[216:219], a[140:143], v[112:115]
v_mfma_f32_16x16x32_bf16 v[104:107], a[220:223], a[136:139], v[104:107]
v_mfma_f32_16x16x32_bf16 v[116:119], a[220:223], a[140:143], v[116:119]
v_mfma_f32_16x16x32_bf16 v[108:111], a[224:227], a[136:139], v[108:111]
s_nop 2
ds_write_b32 v33, v208 offset:256
v_mfma_f32_16x16x32_bf16 v[120:123], a[224:227], a[140:143], v[120:123]
s_waitcnt lgkmcnt(0)
s_barrier
ds_read_b128 v[212:215], v34 offset:256
ds_read_b128 v[216:219], v34 offset:320
ds_read_b128 v[220:223], v34 offset:384
s_waitcnt lgkmcnt(2)
v_pk_fma_f32 v[100:101], v[212:213], v[76:77], v[100:101] op_sel:[0,0,0] op_sel_hi:[1,0,1] neg_lo:[1,0,0] neg_hi:[1,0,0]
v_pk_fma_f32 v[102:103], v[214:215], v[76:77], v[102:103] op_sel:[0,0,0] op_sel_hi:[1,0,1] neg_lo:[1,0,0] neg_hi:[1,0,0]
v_cvt_pk_bf16_f32 v148, v100, v101
v_cvt_pk_bf16_f32 v149, v102, v103
v_pk_fma_f32 v[112:113], v[212:213], v[76:77], v[112:113] op_sel:[0,1,0] op_sel_hi:[1,1,1] neg_lo:[1,0,0] neg_hi:[1,0,0]
v_pk_fma_f32 v[114:115], v[214:215], v[76:77], v[114:115] op_sel:[0,1,0] op_sel_hi:[1,1,1] neg_lo:[1,0,0] neg_hi:[1,0,0]
v_cvt_pk_bf16_f32 v156, v112, v113
v_cvt_pk_bf16_f32 v157, v114, v115
s_waitcnt lgkmcnt(1)
v_pk_fma_f32 v[104:105], v[216:217], v[76:77], v[104:105] op_sel:[0,0,0] op_sel_hi:[1,0,1] neg_lo:[1,0,0] neg_hi:[1,0,0]
v_pk_fma_f32 v[106:107], v[218:219], v[76:77], v[106:107] op_sel:[0,0,0] op_sel_hi:[1,0,1] neg_lo:[1,0,0] neg_hi:[1,0,0]
v_cvt_pk_bf16_f32 v150, v104, v105
v_cvt_pk_bf16_f32 v151, v106, v107
v_pk_fma_f32 v[116:117], v[216:217], v[76:77], v[116:117] op_sel:[0,1,0] op_sel_hi:[1,1,1] neg_lo:[1,0,0] neg_hi:[1,0,0]
v_pk_fma_f32 v[118:119], v[218:219], v[76:77], v[118:119] op_sel:[0,1,0] op_sel_hi:[1,1,1] neg_lo:[1,0,0] neg_hi:[1,0,0]
v_cvt_pk_bf16_f32 v158, v116, v117
v_cvt_pk_bf16_f32 v159, v118, v119
s_waitcnt lgkmcnt(0)
v_pk_fma_f32 v[108:109], v[220:221], v[76:77], v[108:109] op_sel:[0,0,0] op_sel_hi:[1,0,1] neg_lo:[1,0,0] neg_hi:[1,0,0]
v_pk_fma_f32 v[110:111], v[222:223], v[76:77], v[110:111] op_sel:[0,0,0] op_sel_hi:[1,0,1] neg_lo:[1,0,0] neg_hi:[1,0,0]
v_cvt_pk_bf16_f32 v152, v108, v109
v_cvt_pk_bf16_f32 v153, v110, v111
v_pk_fma_f32 v[120:121], v[220:221], v[76:77], v[120:121] op_sel:[0,1,0] op_sel_hi:[1,1,1] neg_lo:[1,0,0] neg_hi:[1,0,0]
v_pk_fma_f32 v[122:123], v[222:223], v[76:77], v[122:123] op_sel:[0,1,0] op_sel_hi:[1,1,1] neg_lo:[1,0,0] neg_hi:[1,0,0]
v_cvt_pk_bf16_f32 v160, v120, v121
v_cvt_pk_bf16_f32 v161, v122, v123
s_waitcnt vmcnt(0)
v_cmp_eq_u32 vcc, 1, v51
s_mov_b32 s53, s50
s_cmp_eq_u64 vcc, exec
s_cselect_b32 s50, s50, 1073741824
v_mfma_f32_16x16x32_bf16 v[100:103], a[148:151], v[148:151], 0
buffer_load_dwordx4 v[188:191], v59, s[28:31], s50 offen sc1
v_mfma_f32_16x16x32_bf16 v[100:103], a[152:155], v[152:155], v[100:103]
v_accvgpr_write_b32 a215, 0
v_mfma_f32_16x16x32_bf16 v[104:107], a[156:159], v[148:151], 0
buffer_load_dwordx4 v[192:195], v59, s[28:31], s50 offen offset:3200 sc1
v_mfma_f32_16x16x32_bf16 v[104:107], a[160:163], v[152:155], v[104:107]
v_accvgpr_write_b32 a214, 0
v_mfma_f32_16x16x32_bf16 v[108:111], a[164:167], v[148:151], 0
s_add_u32 s50, s50, 6400
buffer_load_dwordx4 v[196:199], v59, s[28:31], s50 offen sc1
v_mfma_f32_16x16x32_bf16 v[108:111], a[168:171], v[152:155], v[108:111]
v_accvgpr_write_b32 a203, 0
v_mfma_f32_16x16x32_bf16 v[112:115], a[148:151], v[156:159], 0
buffer_load_dwordx4 v[200:203], v59, s[28:31], s50 offen offset:3200 sc1
v_mfma_f32_16x16x32_bf16 v[112:115], a[152:155], v[160:163], v[112:115]
v_accvgpr_write_b32 a202, 0
v_mfma_f32_16x16x32_bf16 v[116:119], a[156:159], v[156:159], 0
s_add_u32 s50, s50, 6400
buffer_load_dwordx4 v[204:207], v59, s[28:31], s50 offen sc1
v_mfma_f32_16x16x32_bf16 v[116:119], a[160:163], v[160:163], v[116:119]
v_accvgpr_write_b32 a191, 0
v_mfma_f32_16x16x32_bf16 v[120:123], a[164:167], v[156:159], 0
buffer_load_dwordx4 v[208:211], v59, s[28:31], s50 offen offset:3200 sc1
v_mfma_f32_16x16x32_bf16 v[120:123], a[168:171], v[160:163], v[120:123]
v_accvgpr_write_b32 a190, 0
s_add_u32 s50, s50, 6400
v_max3_f32 v84, v100, v101, v102
v_min3_f32 v86, v100, v101, v102
v_max3_f32 v85, v112, v113, v114
v_min3_f32 v87, v112, v113, v114
v_max3_f32 v84, v84, v103, v104
v_min3_f32 v86, v86, v103, v104
v_max3_f32 v85, v85, v115, v116
v_min3_f32 v87, v87, v115, v116
v_max3_f32 v84, v84, v105, v106
v_min3_f32 v86, v86, v105, v106
v_max3_f32 v85, v85, v117, v118
v_min3_f32 v87, v87, v117, v118
v_max3_f32 v84, v84, v107, v108
v_min3_f32 v86, v86, v107, v108
v_max3_f32 v85, v85, v119, v120
v_min3_f32 v87, v87, v119, v120
v_pk_mov_b32 v[88:89], v[84:85], v[84:85] op_sel:[0,1]
v_pk_mov_b32 v[90:91], v[86:87], v[86:87] op_sel:[0,1]
s_nop 0
v_permlane16_swap_b32 v88, v84
v_permlane16_swap_b32 v89, v85
v_permlane16_swap_b32 v90, v86
v_permlane16_swap_b32 v91, v87
v_max_f32 v84, v84, v88
v_max_f32 v85, v85, v89
v_min_f32 v86, v86, v90
v_min_f32 v87, v87, v91
v_pk_mul_f32 v[84:85], v[84:85], v[72:73]
v_pk_mul_f32 v[86:87], v[86:87], v[72:73]
v_pk_fma_f32 v[124:125], v[100:101], v[72:73], v[86:87] op_sel:[0,0,0] op_sel_hi:[1,0,0] neg_lo:[1,0,0] neg_hi:[1,0,0]
v_pk_fma_f32 v[100:101], v[100:101], v[72:73], v[84:85] op_sel:[0,0,0] op_sel_hi:[1,0,0] neg_lo:[0,0,1] neg_hi:[0,0,1]
v_pk_fma_f32 v[126:127], v[102:103], v[72:73], v[86:87] op_sel:[0,0,0] op_sel_hi:[1,0,0] neg_lo:[1,0,0] neg_hi:[1,0,0]
v_pk_fma_f32 v[102:103], v[102:103], v[72:73], v[84:85] op_sel:[0,0,0] op_sel_hi:[1,0,0] neg_lo:[0,0,1] neg_hi:[0,0,1]
buffer_load_dwordx4 v[212:215], v59, s[28:31], s50 offen sc1
v_pk_fma_f32 v[128:129], v[104:105], v[72:73], v[86:87] op_sel:[0,0,0] op_sel_hi:[1,0,0] neg_lo:[1,0,0] neg_hi:[1,0,0]
v_pk_fma_f32 v[104:105], v[104:105], v[72:73], v[84:85] op_sel:[0,0,0] op_sel_hi:[1,0,0] neg_lo:[0,0,1] neg_hi:[0,0,1]
v_pk_fma_f32 v[130:131], v[106:107], v[72:73], v[86:87] op_sel:[0,0,0] op_sel_hi:[1,0,0] neg_lo:[1,0,0] neg_hi:[1,0,0]
v_pk_fma_f32 v[106:107], v[106:107], v[72:73], v[84:85] op_sel:[0,0,0] op_sel_hi:[1,0,0] neg_lo:[0,0,1] neg_hi:[0,0,1]
buffer_load_dwordx4 v[216:219], v59, s[28:31], s50 offen offset:3200 sc1
v_pk_fma_f32 v[132:133], v[108:109], v[72:73], v[86:87] op_sel:[0,0,0] op_sel_hi:[1,0,0] neg_lo:[1,0,0] neg_hi:[1,0,0]
v_pk_fma_f32 v[108:109], v[108:109], v[72:73], v[84:85] op_sel:[0,0,0] op_sel_hi:[1,0,0] neg_lo:[0,0,1] neg_hi:[0,0,1]
v_pk_fma_f32 v[136:137], v[112:113], v[72:73], v[86:87] op_sel:[0,1,1] op_sel_hi:[1,1,1] neg_lo:[1,0,0] neg_hi:[1,0,0]
v_pk_fma_f32 v[112:113], v[112:113], v[72:73], v[84:85] op_sel:[0,1,1] op_sel_hi:[1,1,1] neg_lo:[0,0,1] neg_hi:[0,0,1]
s_add_u32 s50, s50, 6400
v_pk_fma_f32 v[138:139], v[114:115], v[72:73], v[86:87] op_sel:[0,1,1] op_sel_hi:[1,1,1] neg_lo:[1,0,0] neg_hi:[1,0,0]
v_pk_fma_f32 v[114:115], v[114:115], v[72:73], v[84:85] op_sel:[0,1,1] op_sel_hi:[1,1,1] neg_lo:[0,0,1] neg_hi:[0,0,1]
v_pk_fma_f32 v[140:141], v[116:117], v[72:73], v[86:87] op_sel:[0,1,1] op_sel_hi:[1,1,1] neg_lo:[1,0,0] neg_hi:[1,0,0]
s_branch iskip3
.p2align 12
ipad3:
s_branch iret0
s_nop 0
iskip3:
v_pk_fma_f32 v[116:117], v[116:117], v[72:73], v[84:85] op_sel:[0,1,1] op_sel_hi:[1,1,1] neg_lo:[0,0,1] neg_hi:[0,0,1]
buffer_load_dwordx4 v[220:223], v59, s[28:31], s50 offen sc1
v_pk_fma_f32 v[142:143], v[118:119], v[72:73], v[86:87] op_sel:[0,1,1] op_sel_hi:[1,1,1] neg_lo:[1,0,0] neg_hi:[1,0,0]
v_pk_fma_f32 v[118:119], v[118:119], v[72:73], v[84:85] op_sel:[0,1,1] op_sel_hi:[1,1,1] neg_lo:[0,0,1] neg_hi:[0,0,1]
v_pk_fma_f32 v[144:145], v[120:121], v[72:73], v[86:87] op_sel:[0,1,1] op_sel_hi:[1,1,1] neg_lo:[1,0,0] neg_hi:[1,0,0]
v_pk_fma_f32 v[120:121], v[120:121], v[72:73], v[84:85] op_sel:[0,1,1] op_sel_hi:[1,1,1] neg_lo:[0,0,1] neg_hi:[0,0,1]
buffer_load_dwordx4 v[224:227], v59, s[28:31], s50 offen offset:3200 sc1
v_exp_f32 v100, v100
v_exp_f32 v101, v101
v_exp_f32 v102, v102
v_exp_f32 v103, v103
s_add_u32 s50, s50, 6400
v_exp_f32 v104, v104
v_exp_f32 v105, v105
v_exp_f32 v106, v106
v_exp_f32 v107, v107
buffer_load_dwordx4 v[228:231], v59, s[28:31], s50 offen sc1
v_exp_f32 v108, v108
v_exp_f32 v112, v112
v_exp_f32 v113, v113
v_exp_f32 v114, v114
buffer_load_dwordx4 v[232:235], v59, s[28:31], s50 offen offset:3200 sc1
v_exp_f32 v115, v115
v_exp_f32 v116, v116
v_exp_f32 v117, v117
v_exp_f32 v118, v118
s_add_u32 s50, s50, 6400
v_exp_f32 v119, v119
v_exp_f32 v120, v120
v_exp_f32 v124, v124
v_exp_f32 v125, v125
buffer_load_dwordx4 v[236:239], v59, s[28:31], s50 offen sc1
v_exp_f32 v126, v126
v_exp_f32 v127, v127
v_exp_f32 v128, v128
v_exp_f32 v129, v129
buffer_load_dwordx4 v[240:243], v59, s[28:31], s50 offen offset:3200 sc1
v_exp_f32 v130, v130
v_exp_f32 v131, v131
v_exp_f32 v132, v132
v_exp_f32 v136, v136
s_add_u32 s50, s50, 6400
v_exp_f32 v137, v137
v_exp_f32 v138, v138
v_exp_f32 v139, v139
v_exp_f32 v140, v140
buffer_load_dwordx4 v[244:247], v59, s[28:31], s50 offen sc1
v_exp_f32 v141, v141
v_exp_f32 v142, v142
v_exp_f32 v143, v143
v_exp_f32 v144, v144
buffer_load_dwordx4 v[248:251], v59, s[28:31], s50 offen offset:3200 sc1
v_pk_add_f32 v[110:111], v[100:101], v[102:103]
v_pk_add_f32 v[122:123], v[112:113], v[114:115]
v_pk_add_f32 v[134:135], v[124:125], v[126:127]
v_pk_add_f32 v[146:147], v[136:137], v[138:139]
v_pk_add_f32 v[110:111], v[110:111], v[104:105]
v_pk_add_f32 v[122:123], v[122:123], v[116:117]
v_pk_add_f32 v[134:135], v[134:135], v[128:129]
v_pk_add_f32 v[146:147], v[146:147], v[140:141]
v_pk_add_f32 v[110:111], v[110:111], v[106:107]
v_pk_add_f32 v[122:123], v[122:123], v[118:119]
v_pk_add_f32 v[134:135], v[134:135], v[130:131]
v_pk_add_f32 v[146:147], v[146:147], v[142:143]
v_add_f32 v84, v110, v108
v_add_f32 v85, v122, v120
v_add_f32 v86, v134, v132
v_add_f32 v87, v146, v144
v_add_f32 v84, v84, v111
v_add_f32 v85, v85, v123
v_add_f32 v86, v86, v135
v_add_f32 v87, v87, v147
v_pk_mov_b32 v[88:89], v[84:85], v[84:85] op_sel:[0,1]
v_pk_mov_b32 v[90:91], v[86:87], v[86:87] op_sel:[0,1]
s_nop 0
v_permlane16_swap_b32 v88, v84
v_permlane16_swap_b32 v89, v85
v_permlane16_swap_b32 v90, v86
v_permlane16_swap_b32 v91, v87
v_pk_add_f32 v[84:85], v[84:85], v[88:89]
v_pk_add_f32 v[86:87], v[86:87], v[90:91]
v_rcp_f32 v86, v86
v_rcp_f32 v87, v87
v_cvt_pk_bf16_f32 v164, v100, v101
v_cvt_pk_bf16_f32 v165, v102, v103
v_cvt_pk_bf16_f32 v166, v104, v105
v_cvt_pk_bf16_f32 v167, v106, v107
v_cvt_pk_bf16_f32 v168, v108, 0
v_cvt_pk_bf16_f32 v176, v112, v113
v_cvt_pk_bf16_f32 v177, v114, v115
v_cvt_pk_bf16_f32 v178, v116, v117
v_cvt_pk_bf16_f32 v179, v118, v119
v_cvt_pk_bf16_f32 v180, v120, 0
v_pk_mul_f32 v[86:87], v[86:87], v[84:85]
v_pk_mul_f32 v[124:125], v[124:125], v[86:87] op_sel:[0,0] op_sel_hi:[1,0]
v_pk_mul_f32 v[126:127], v[126:127], v[86:87] op_sel:[0,0] op_sel_hi:[1,0]
v_pk_mul_f32 v[128:129], v[128:129], v[86:87] op_sel:[0,0] op_sel_hi:[1,0]
v_pk_mul_f32 v[130:131], v[130:131], v[86:87] op_sel:[0,0] op_sel_hi:[1,0]
v_mul_f32 v132, v132, v86
v_cvt_pk_bf16_f32 v169, v124, v125
v_cvt_pk_bf16_f32 v170, v126, v127
v_cvt_pk_bf16_f32 v171, v128, v129
v_cvt_pk_bf16_f32 v172, v130, v131
v_cvt_pk_bf16_f32 v173, v132, 0
v_pk_mul_f32 v[136:137], v[136:137], v[86:87] op_sel:[0,1] op_sel_hi:[1,1]
v_pk_mul_f32 v[138:139], v[138:139], v[86:87] op_sel:[0,1] op_sel_hi:[1,1]
v_pk_mul_f32 v[140:141], v[140:141], v[86:87] op_sel:[0,1] op_sel_hi:[1,1]
v_pk_mul_f32 v[142:143], v[142:143], v[86:87] op_sel:[0,1] op_sel_hi:[1,1]
v_mul_f32 v144, v144, v87
v_cvt_pk_bf16_f32 v181, v136, v137
v_cvt_pk_bf16_f32 v182, v138, v139
v_cvt_pk_bf16_f32 v183, v140, v141
v_cvt_pk_bf16_f32 v184, v142, v143
v_cvt_pk_bf16_f32 v185, v144, 0
s_cmp_eq_u64 vcc, exec
s_cbranch_scc0 sequential_preLN__linear_kernel_hedgehog__glu_gated_bilinear__prompt_kernel_slow1
sequential_preLN__linear_kernel_hedgehog__glu_gated_bilinear__prompt_kernel_back1b:
s_waitcnt vmcnt(12)
v_lshlrev_b32 v100, 16, v188
v_and_b32 v101, 0xffff0000, v188
v_lshlrev_b32 v102, 16, v189
v_and_b32 v103, 0xffff0000, v189
v_lshlrev_b32 v104, 16, v190
v_and_b32 v105, 0xffff0000, v190
v_lshlrev_b32 v106, 16, v191
v_and_b32 v107, 0xffff0000, v191
v_dot2c_f32_bf16 v100, s90, v192
v_dot2c_f32_bf16 v101, s91, v192
v_dot2c_f32_bf16 v102, s90, v193
v_dot2c_f32_bf16 v103, s91, v193
v_dot2c_f32_bf16 v104, s90, v194
v_dot2c_f32_bf16 v105, s91, v194
v_dot2c_f32_bf16 v106, s90, v195
v_dot2c_f32_bf16 v107, s91, v195
v_dot2c_f32_bf16 v100, s90, v196
v_dot2c_f32_bf16 v101, s91, v196
v_dot2c_f32_bf16 v102, s90, v197
v_dot2c_f32_bf16 v103, s91, v197
v_dot2c_f32_bf16 v104, s90, v198
v_dot2c_f32_bf16 v105, s91, v198
v_dot2c_f32_bf16 v106, s90, v199
v_dot2c_f32_bf16 v107, s91, v199
v_dot2c_f32_bf16 v100, s90, v200
v_dot2c_f32_bf16 v101, s91, v200
v_dot2c_f32_bf16 v102, s90, v201
v_dot2c_f32_bf16 v103, s91, v201
v_dot2c_f32_bf16 v104, s90, v202
v_dot2c_f32_bf16 v105, s91, v202
v_dot2c_f32_bf16 v106, s90, v203
v_dot2c_f32_bf16 v107, s91, v203
s_waitcnt vmcnt(8)
v_dot2c_f32_bf16 v100, s90, v204
v_dot2c_f32_bf16 v101, s91, v204
v_dot2c_f32_bf16 v102, s90, v205
v_dot2c_f32_bf16 v103, s91, v205
v_dot2c_f32_bf16 v104, s90, v206
v_dot2c_f32_bf16 v105, s91, v206
v_dot2c_f32_bf16 v106, s90, v207
v_dot2c_f32_bf16 v107, s91, v207
v_dot2c_f32_bf16 v100, s90, v208
v_dot2c_f32_bf16 v101, s91, v208
v_dot2c_f32_bf16 v102, s90, v209
v_dot2c_f32_bf16 v103, s91, v209
v_dot2c_f32_bf16 v104, s90, v210
v_dot2c_f32_bf16 v105, s91, v210
v_dot2c_f32_bf16 v106, s90, v211
v_dot2c_f32_bf16 v107, s91, v211
v_dot2c_f32_bf16 v100, s90, v212
v_dot2c_f32_bf16 v101, s91, v212
v_dot2c_f32_bf16 v102, s90, v213
v_dot2c_f32_bf16 v103, s91, v213
v_dot2c_f32_bf16 v104, s90, v214
v_dot2c_f32_bf16 v105, s91, v214
v_dot2c_f32_bf16 v106, s90, v215
v_dot2c_f32_bf16 v107, s91, v215
v_dot2c_f32_bf16 v100, s90, v216
v_dot2c_f32_bf16 v101, s91, v216
v_dot2c_f32_bf16 v102, s90, v217
v_dot2c_f32_bf16 v103, s91, v217
v_dot2c_f32_bf16 v104, s90, v218
v_dot2c_f32_bf16 v105, s91, v218
v_dot2c_f32_bf16 v106, s90, v219
v_dot2c_f32_bf16 v107, s91, v219
s_waitcnt vmcnt(4)
v_dot2c_f32_bf16 v100, s90, v220
v_dot2c_f32_bf16 v101, s91, v220
v_dot2c_f32_bf16 v102, s90, v221
v_dot2c_f32_bf16 v103, s91, v221
v_dot2c_f32_bf16 v104, s90, v222
v_dot2c_f32_bf16 v105, s91, v222
v_dot2c_f32_bf16 v106, s90, v223
v_dot2c_f32_bf16 v107, s91, v223
v_dot2c_f32_bf16 v100, s90, v224
v_dot2c_f32_bf16 v101, s91, v224
v_dot2c_f32_bf16 v102, s90, v225
v_dot2c_f32_bf16 v103, s91, v225
v_dot2c_f32_bf16 v104, s90, v226
v_dot2c_f32_bf16 v105, s91, v226
v_dot2c_f32_bf16 v106, s90, v227
v_dot2c_f32_bf16 v107, s91, v227
v_dot2c_f32_bf16 v100, s90, v228
v_dot2c_f32_bf16 v101, s91, v228
v_dot2c_f32_bf16 v102, s90, v229
v_dot2c_f32_bf16 v103, s91, v229
v_dot2c_f32_bf16 v104, s90, v230
v_dot2c_f32_bf16 v105, s91, v230
v_dot2c_f32_bf16 v106, s90, v231
v_dot2c_f32_bf16 v107, s91, v231
v_dot2c_f32_bf16 v100, s90, v232
v_dot2c_f32_bf16 v101, s91, v232
v_dot2c_f32_bf16 v102, s90, v233
v_dot2c_f32_bf16 v103, s91, v233
v_dot2c_f32_bf16 v104, s90, v234
v_dot2c_f32_bf16 v105, s91, v234
v_dot2c_f32_bf16 v106, s90, v235
v_dot2c_f32_bf16 v107, s91, v235
s_waitcnt vmcnt(0)
v_dot2c_f32_bf16 v100, s90, v236
v_dot2c_f32_bf16 v101, s91, v236
v_dot2c_f32_bf16 v102, s90, v237
v_dot2c_f32_bf16 v103, s91, v237
v_dot2c_f32_bf16 v104, s90, v238
v_dot2c_f32_bf16 v105, s91, v238
v_dot2c_f32_bf16 v106, s90, v239
v_dot2c_f32_bf16 v107, s91, v239
v_dot2c_f32_bf16 v100, s90, v240
v_dot2c_f32_bf16 v101, s91, v240
v_dot2c_f32_bf16 v102, s90, v241
v_dot2c_f32_bf16 v103, s91, v241
v_dot2c_f32_bf16 v104, s90, v242
v_dot2c_f32_bf16 v105, s91, v242
v_dot2c_f32_bf16 v106, s90, v243
v_dot2c_f32_bf16 v107, s91, v243
v_dot2c_f32_bf16 v100, s90, v244
v_dot2c_f32_bf16 v101, s91, v244
v_dot2c_f32_bf16 v102, s90, v245
v_dot2c_f32_bf16 v103, s91, v245
v_dot2c_f32_bf16 v104, s90, v246
v_dot2c_f32_bf16 v105, s91, v246
v_dot2c_f32_bf16 v106, s90, v247
v_dot2c_f32_bf16 v107, s91, v247
v_dot2c_f32_bf16 v100, s90, v248
v_dot2c_f32_bf16 v101, s91, v248
v_dot2c_f32_bf16 v102, s90, v249
v_dot2c_f32_bf16 v103, s91, v249
v_dot2c_f32_bf16 v104, s90, v250
v_dot2c_f32_bf16 v105, s91, v250
v_dot2c_f32_bf16 v106, s90, v251
v_dot2c_f32_bf16 v107, s91, v251
v_cvt_pk_bf16_f32 v100, v100, v101
v_cvt_pk_bf16_f32 v101, v102, v103
v_cvt_pk_bf16_f32 v102, v104, v105
v_cvt_pk_bf16_f32 v103, v106, v107
ds_write2_b64 v60, v[100:101], v[102:103] offset1:5
s_waitcnt lgkmcnt(0)
s_barrier
ds_read_b64_tr_b16 a[204:205], v62 offset:32
ds_read_b64_tr_b16 a[206:207], v62 offset:192
ds_read_b64_tr_b16 a[208:209], v62 offset:352
ds_read_b64_tr_b16 a[210:211], v62 offset:512
ds_read_b64_tr_b16 a[212:213], v62 offset:672
ds_read_b64_tr_b16 a[180:181], v61 offset:0
ds_read_b64_tr_b16 a[182:183], v61 offset:160
ds_read_b64_tr_b16 a[184:185], v61 offset:320
ds_read_b64_tr_b16 a[186:187], v61 offset:480
ds_read_b64_tr_b16 a[188:189], v61 offset:640
ds_read_b64_tr_b16 a[192:193], v61 offset:8
ds_read_b64_tr_b16 a[194:195], v61 offset:168
ds_read_b64_tr_b16 a[196:197], v61 offset:328
ds_read_b64_tr_b16 a[198:199], v61 offset:488
ds_read_b64_tr_b16 a[200:201], v61 offset:648
s_mov_b32 s92, 0x358637bd
v_and_b32 v90, 1, v3
v_cmp_eq_u32 vcc, 1, v90
s_waitcnt lgkmcnt(10)
v_mfma_f32_16x16x32_bf16 v[108:111], a[204:207], v[164:167], 0
v_mfma_f32_16x16x32_bf16 v[108:111], a[208:211], v[168:171], v[108:111]
v_mfma_f32_16x16x32_bf16 v[108:111], a[212:215], v[172:175], v[108:111]
v_mfma_f32_16x16x32_bf16 v[120:123], a[204:207], v[176:179], 0
v_mfma_f32_16x16x32_bf16 v[120:123], a[208:211], v[180:183], v[120:123]
v_mfma_f32_16x16x32_bf16 v[120:123], a[212:215], v[184:187], v[120:123]
s_waitcnt lgkmcnt(5)
v_mfma_f32_16x16x32_bf16 v[100:103], a[180:183], v[164:167], 0
v_mfma_f32_16x16x32_bf16 v[100:103], a[184:187], v[168:171], v[100:103]
v_mfma_f32_16x16x32_bf16 v[100:103], a[188:191], v[172:175], v[100:103]
s_waitcnt lgkmcnt(0)
v_mfma_f32_16x16x32_bf16 v[104:107], a[192:195], v[164:167], 0
v_fma_f32 v88, v84, s92, v110
v_mfma_f32_16x16x32_bf16 v[104:107], a[196:199], v[168:171], v[104:107]
v_rcp_f32 v88, v88
v_mfma_f32_16x16x32_bf16 v[104:107], a[200:203], v[172:175], v[104:107]
v_fma_f32 v89, v85, s92, v122
v_mul_f32 v108, v108, v88
v_mfma_f32_16x16x32_bf16 v[112:115], a[180:183], v[176:179], 0
v_rcp_f32 v89, v89
v_mfma_f32_16x16x32_bf16 v[112:115], a[184:187], v[180:183], v[112:115]
v_mul_f32 v109, v109, v88
v_mul_f32 v100, v100, v88
v_mfma_f32_16x16x32_bf16 v[112:115], a[188:191], v[184:187], v[112:115]
v_mul_f32 v101, v101, v88
v_mul_f32 v102, v102, v88
v_mfma_f32_16x16x32_bf16 v[116:119], a[192:195], v[176:179], 0
v_mul_f32 v103, v103, v88
v_mul_f32 v120, v120, v89
v_mfma_f32_16x16x32_bf16 v[116:119], a[196:199], v[180:183], v[116:119]
v_mul_f32 v121, v121, v89
v_mul_f32 v104, v104, v88
v_mfma_f32_16x16x32_bf16 v[116:119], a[200:203], v[184:187], v[116:119]
v_mul_f32 v105, v105, v88
v_mul_f32 v106, v106, v88
v_mul_f32 v107, v107, v88
v_cvt_pk_bf16_f32 v124, v100, v101
v_cvt_pk_bf16_f32 v125, v102, v103
v_cvt_pk_bf16_f32 v126, v104, v105
v_cvt_pk_bf16_f32 v127, v106, v107
buffer_store_dwordx4 v[124:127], v5, s[28:31], s46 offen sc1
v_pk_mul_f32 v[112:113], v[112:113], v[88:89] op_sel:[0,1] op_sel_hi:[1,1]
v_pk_mul_f32 v[114:115], v[114:115], v[88:89] op_sel:[0,1] op_sel_hi:[1,1]
v_pk_mul_f32 v[116:117], v[116:117], v[88:89] op_sel:[0,1] op_sel_hi:[1,1]
v_pk_mul_f32 v[118:119], v[118:119], v[88:89] op_sel:[0,1] op_sel_hi:[1,1]
v_cvt_pk_bf16_f32 v136, v112, v113
v_cvt_pk_bf16_f32 v137, v114, v115
v_cvt_pk_bf16_f32 v138, v116, v117
v_cvt_pk_bf16_f32 v139, v118, v119
buffer_store_dwordx4 v[136:139], v5, s[28:31], s46 offen offset:1024 sc1
v_cvt_pk_bf16_f32 v128, v108, v109
v_cvt_pk_bf16_f32 v140, v120, v121
v_cndmask_b32 v90, v128, v140, vcc
buffer_store_dword v90, v63, s[28:31], s47 offen sc1
s_barrier
buffer_store_dword v48, v47, s[28:31], s40 offen sc1
v_mul_u32_u24 v65, 80, v2
s_xor_b32 s37, s36, 8
s_add_u32 s37, s37, s35
v_add_u32 v65, s37, v65
v_lshl_add_u32 v66, v3, 3, v65
v_lshlrev_b32 v63, 1, v67
s_and_b32 s37, s55, 7
s_lshl_b32 s37, s37, 8
s_add_u32 s43, s43, s37
s_add_u32 s43, s43, 0
s_lshl_b32 s37, s55, 7
s_lshl_b32 s38, s15, 10
s_add_u32 s44, s37, s38
s_add_u32 s44, s44, 4194304
s_lshl_b32 s48, s15, 6
s_add_u32 s48, s48, 12582912
s_cmp_eq_u32 s13, 0
s_cselect_b32 s48, s48, 1073741824
s_lshl_b32 s39, s12, 11
s_min_u32 s39, s39, 4096
s_mov_b32 s37, 0x40000
s_mov_b32 s38, 0xffff0000
s_add_u32 m0, s35, 14592
s_nop 0
buffer_load_dwordx4 v52, s[60:63], s32 offen offset:0 sc1 lds
buffer_load_dwordx4 v53, s[60:63], s32 offen offset:1024 sc1 lds
s_add_u32 s32, s32, 82944
s_add_u32 m0, s35, 15872
s_nop 0
buffer_load_dwordx4 v52, s[60:63], s32 offen offset:0 sc1 lds
buffer_load_dwordx4 v53, s[60:63], s32 offen offset:1024 sc1 lds
s_add_u32 s32, s32, 82944
s_add_u32 m0, s35, 17152
s_nop 0
buffer_load_dwordx4 v52, s[60:63], s32 offen offset:0 sc1 lds
buffer_load_dwordx4 v53, s[60:63], s32 offen offset:1024 sc1 lds
s_add_u32 m0, s35, 18432
s_nop 0
buffer_load_dwordx4 v54, s[60:63], s100 offen offset:0 sc1 lds
buffer_load_dwordx4 v55, s[60:63], s100 offen offset:1024 sc1 lds
s_add_u32 m0, s39, 156928
s_add_u32 s39, s39, 12648448
ds_read_b64 v[148:149], v66 offset:20480
ds_read_b64 v[150:151], v66 offset:20512
ds_read_b64 v[152:153], v65 offset:20544
ds_read_b64 v[154:155], v66 offset:21760
ds_read_b64 v[156:157], v66 offset:21792
ds_read_b64 v[158:159], v65 offset:21824
s_waitcnt lgkmcnt(0)
v_lshlrev_b32 v164, 16, v148
v_and_b32 v165, s38, v148
v_lshlrev_b32 v166, 16, v149
v_and_b32 v167, s38, v149
v_lshlrev_b32 v168, 16, v150
v_and_b32 v169, s38, v150
v_lshlrev_b32 v170, 16, v151
v_and_b32 v171, s38, v151
v_lshlrev_b32 v172, 16, v152
v_and_b32 v173, s38, v152
v_lshlrev_b32 v174, 16, v153
v_and_b32 v175, s38, v153
v_lshlrev_b32 v176, 16, v154
v_and_b32 v177, s38, v154
v_lshlrev_b32 v178, 16, v155
v_and_b32 v179, s38, v155
v_lshlrev_b32 v180, 16, v156
v_and_b32 v181, s38, v156
v_lshlrev_b32 v182, 16, v157
v_and_b32 v183, s38, v157
v_lshlrev_b32 v184, 16, v158
v_and_b32 v185, s38, v158
v_lshlrev_b32 v186, 16, v159
v_and_b32 v187, s38, v159
v_cmp_gt_u32 s[94:95], 16, v1
v_and_b32 v84, 3, v1
v_cmp_eq_u32 vcc, 0, v84
v_bfe_u32 v84, v1, 2, 3
v_lshrrev_b32 v85, 5, v1
v_mul_u32_u24 v85, 160, v85
v_lshl_add_u32 v84, v84, 3, v85
v_add_u32 v85, 156928, v84
v_add_u32 v29, 8192, v29
v_cndmask_b32 v29, v85, v29, vcc
v_add_u32 v85, 157248, v84
v_add_u32 v30, 8192, v30
v_cndmask_b32 v30, v85, v30, vcc
v_mov_b32 v84, 640
v_mov_b32 v85, 1280
v_cndmask_b32 v78, v84, v85, vcc
v_cndmask_b32 v172, v76, v172, s[94:95]
v_cndmask_b32 v173, 0, v173, s[94:95]
v_cndmask_b32 v184, v77, v184, s[94:95]
v_cndmask_b32 v185, 0, v185, s[94:95]
s_cmp_eq_u32 s12, 0
s_cbranch_scc1 ipad4
s_cmp_eq_u32 s12, 1
s_cbranch_scc1 ipad5
s_cmp_eq_u32 s12, 2
s_cbranch_scc1 ipad6
s_branch ipad7
s_nop 0
iret1:
sequential_preLN__linear_kernel_hedgehog__glu_gated_bilinear__prompt_kernel_spin2:
buffer_load_dword v51, v46, s[28:31], s41 offen sc1
s_waitcnt vmcnt(0)
v_cmp_eq_u32 vcc, 1, v51
s_sub_u32 s37, s37, 1
s_cmp_eq_u64 vcc, exec
s_cbranch_scc1 sequential_preLN__linear_kernel_hedgehog__glu_gated_bilinear__prompt_kernel_back2
s_cmp_lg_u32 s37, 0
s_cbranch_scc1 sequential_preLN__linear_kernel_hedgehog__glu_gated_bilinear__prompt_kernel_spin2
sequential_preLN__linear_kernel_hedgehog__glu_gated_bilinear__prompt_kernel_back2:
buffer_load_dwordx4 v5, s[28:31], s39 offen offset:0 sc1 lds
buffer_load_dwordx4 v5, s[28:31], s39 offen offset:1024 sc1 lds
buffer_load_dwordx4 a[0:3], v5, s[28:31], s45 offen offset:0 sc1
buffer_load_dwordx4 a[4:7], v5, s[28:31], s45 offen offset:1024 sc1
s_add_u32 s45, s45, 4096
buffer_load_dwordx4 a[8:11], v5, s[28:31], s45 offen offset:0 sc1
buffer_load_dwordx4 a[12:15], v5, s[28:31], s45 offen offset:1024 sc1
s_add_u32 s45, s45, 4096
buffer_load_dwordx4 a[16:19], v5, s[28:31], s45 offen offset:0 sc1
buffer_load_dwordx4 a[20:23], v5, s[28:31], s45 offen offset:1024 sc1
s_add_u32 s45, s45, 4096
buffer_load_dwordx4 a[24:27], v5, s[28:31], s45 offen offset:0 sc1
buffer_load_dwordx4 a[28:31], v5, s[28:31], s45 offen offset:1024 sc1
s_add_u32 s45, s45, 4096
buffer_load_dwordx4 a[32:35], v5, s[28:31], s45 offen offset:0 sc1
buffer_load_dwordx4 a[36:39], v5, s[28:31], s45 offen offset:1024 sc1
s_add_u32 s45, s45, 4096
buffer_load_dwordx4 a[40:43], v5, s[28:31], s45 offen offset:0 sc1
buffer_load_dwordx4 a[44:47], v5, s[28:31], s45 offen offset:1024 sc1
s_add_u32 s45, s45, 4096
buffer_load_dwordx4 a[48:51], v5, s[28:31], s45 offen offset:0 sc1
buffer_load_dwordx4 a[52:55], v5, s[28:31], s45 offen offset:1024 sc1
s_add_u32 s45, s45, 4096
s_waitcnt vmcnt(14)
s_barrier
sequential_preLN__linear_kernel_hedgehog__glu_gated_bilinear__prompt_kernel_redo2:
ds_read_b64_tr_b16 a[180:181], v29 offset:0
ds_read_b64_tr_b16 a[182:183], v29 offset:80
ds_read_b64_tr_b16 a[184:185], v27 offset:8192
ds_read_b64_tr_b16 a[186:187], v27 offset:8272
ds_read_b64_tr_b16 a[188:189], v27 offset:8224
ds_read_b64_tr_b16 a[190:191], v27 offset:8304
ds_read_b64_tr_b16 a[192:193], v30 offset:0
ds_read_b64_tr_b16 a[194:195], v30 offset:80
ds_read_b64_tr_b16 a[196:197], v28 offset:8192
ds_read_b64_tr_b16 a[198:199], v28 offset:8272
ds_read_b64_tr_b16 a[200:201], v28 offset:8224
ds_read_b64_tr_b16 a[202:203], v28 offset:8304
v_add_u32 v29, v78, v29
s_waitcnt vmcnt(12) lgkmcnt(6)
v_mfma_f32_16x16x32_bf16 v[108:111], a[180:183], a[0:3], v[172:175]
ds_read_b64_tr_b16 a[204:205], v29 offset:0
v_add_u32 v30, v78, v30
v_mfma_f32_16x16x32_bf16 v[120:123], a[180:183], a[4:7], v[184:187]
buffer_load_dwordx4 a[56:59], v5, s[28:31], s45 offen offset:0 sc1
ds_read_b64_tr_b16 a[206:207], v29 offset:80
v_mfma_f32_16x16x32_bf16 v[112:115], a[184:187], a[4:7], v[176:179]
ds_read_b64_tr_b16 a[208:209], v27 offset:9472
v_mfma_f32_16x16x32_bf16 v[100:103], a[184:187], a[0:3], v[164:167]
buffer_load_dwordx4 a[60:63], v5, s[28:31], s45 offen offset:1024 sc1
ds_read_b64_tr_b16 a[210:211], v27 offset:9552
v_mfma_f32_16x16x32_bf16 v[104:107], a[188:191], a[0:3], v[168:171]
s_add_u32 s45, s45, 4096
ds_read_b64_tr_b16 a[212:213], v27 offset:9504
v_mfma_f32_16x16x32_bf16 v[116:119], a[188:191], a[4:7], v[180:183]
s_waitcnt vmcnt(12) lgkmcnt(5)
ds_read_b64_tr_b16 a[214:215], v27 offset:9584
v_mfma_f32_16x16x32_bf16 v[108:111], a[192:195], a[8:11], v[108:111]
ds_read_b64_tr_b16 a[180:181], v30 offset:0
v_add_u32 v29, v78, v29
v_mfma_f32_16x16x32_bf16 v[120:123], a[192:195], a[12:15], v[120:123]
buffer_load_dwordx4 a[64:67], v5, s[28:31], s45 offen offset:0 sc1
ds_read_b64_tr_b16 a[182:183], v30 offset:80
v_mfma_f32_16x16x32_bf16 v[112:115], a[196:199], a[12:15], v[112:115]
ds_read_b64_tr_b16 a[184:185], v28 offset:9472
v_mfma_f32_16x16x32_bf16 v[100:103], a[196:199], a[8:11], v[100:103]
buffer_load_dwordx4 a[68:71], v5, s[28:31], s45 offen offset:1024 sc1
ds_read_b64_tr_b16 a[186:187], v28 offset:9552
v_mfma_f32_16x16x32_bf16 v[104:107], a[200:203], a[8:11], v[104:107]
s_add_u32 s45, s45, 4096
ds_read_b64_tr_b16 a[188:189], v28 offset:9504
v_mfma_f32_16x16x32_bf16 v[116:119], a[200:203], a[12:15], v[116:119]
s_waitcnt vmcnt(12) lgkmcnt(5)
ds_read_b64_tr_b16 a[190:191], v28 offset:9584
v_mfma_f32_16x16x32_bf16 v[108:111], a[204:207], a[16:19], v[108:111]
ds_read_b64_tr_b16 a[192:193], v29 offset:0
v_add_u32 v30, v78, v30
v_mfma_f32_16x16x32_bf16 v[120:123], a[204:207], a[20:23], v[120:123]
buffer_load_dwordx4 a[72:75], v5, s[28:31], s45 offen offset:0 sc1
ds_read_b64_tr_b16 a[194:195], v29 offset:80
v_mfma_f32_16x16x32_bf16 v[112:115], a[208:211], a[20:23], v[112:115]
ds_read_b64_tr_b16 a[196:197], v27 offset:10752
v_mfma_f32_16x16x32_bf16 v[100:103], a[208:211], a[16:19], v[100:103]
buffer_load_dwordx4 a[76:79], v5, s[28:31], s45 offen offset:1024 sc1
ds_read_b64_tr_b16 a[198:199], v27 offset:10832
v_mfma_f32_16x16x32_bf16 v[104:107], a[212:215], a[16:19], v[104:107]
s_add_u32 s45, s45, 4096
ds_read_b64_tr_b16 a[200:201], v27 offset:10784
v_mfma_f32_16x16x32_bf16 v[116:119], a[212:215], a[20:23], v[116:119]
s_waitcnt vmcnt(12) lgkmcnt(5)
ds_read_b64_tr_b16 a[202:203], v27 offset:10864
v_mfma_f32_16x16x32_bf16 v[108:111], a[180:183], a[24:27], v[108:111]
ds_read_b64_tr_b16 a[204:205], v30 offset:0
v_add_u32 v29, v78, v29
v_mfma_f32_16x16x32_bf16 v[120:123], a[180:183], a[28:31], v[120:123]
buffer_load_dwordx4 a[80:83], v5, s[28:31], s45 offen offset:0 sc1
ds_read_b64_tr_b16 a[206:207], v30 offset:80
v_mfma_f32_16x16x32_bf16 v[112:115], a[184:187], a[28:31], v[112:115]
ds_read_b64_tr_b16 a[208:209], v28 offset:10752
v_mfma_f32_16x16x32_bf16 v[100:103], a[184:187], a[24:27], v[100:103]
buffer_load_dwordx4 a[84:87], v5, s[28:31], s45 offen offset:1024 sc1
ds_read_b64_tr_b16 a[210:211], v28 offset:10832
v_mfma_f32_16x16x32_bf16 v[104:107], a[188:191], a[24:27], v[104:107]
s_add_u32 s45, s45, 4096
ds_read_b64_tr_b16 a[212:213], v28 offset:10784
v_mfma_f32_16x16x32_bf16 v[116:119], a[188:191], a[28:31], v[116:119]
s_waitcnt vmcnt(12) lgkmcnt(5)
ds_read_b64_tr_b16 a[214:215], v28 offset:10864
v_mfma_f32_16x16x32_bf16 v[108:111], a[192:195], a[32:35], v[108:111]
ds_read_b64_tr_b16 a[180:181], v29 offset:0
v_add_u32 v30, v78, v30
v_mfma_f32_16x16x32_bf16 v[120:123], a[192:195], a[36:39], v[120:123]
buffer_load_dwordx4 a[88:91], v5, s[28:31], s45 offen offset:0 sc1
ds_read_b64_tr_b16 a[182:183], v29 offset:80
v_mfma_f32_16x16x32_bf16 v[112:115], a[196:199], a[36:39], v[112:115]
ds_read_b64_tr_b16 a[184:185], v27 offset:12032
v_mfma_f32_16x16x32_bf16 v[100:103], a[196:199], a[32:35], v[100:103]
buffer_load_dwordx4 a[92:95], v5, s[28:31], s45 offen offset:1024 sc1
ds_read_b64_tr_b16 a[186:187], v27 offset:12112
v_mfma_f32_16x16x32_bf16 v[104:107], a[200:203], a[32:35], v[104:107]
s_add_u32 s45, s45, 4096
ds_read_b64_tr_b16 a[188:189], v27 offset:12064
v_mfma_f32_16x16x32_bf16 v[116:119], a[200:203], a[36:39], v[116:119]
s_waitcnt vmcnt(12) lgkmcnt(5)
ds_read_b64_tr_b16 a[190:191], v27 offset:12144
v_mfma_f32_16x16x32_bf16 v[108:111], a[204:207], a[40:43], v[108:111]
ds_read_b64_tr_b16 a[192:193], v30 offset:0
v_add_u32 v29, v78, v29
v_mfma_f32_16x16x32_bf16 v[120:123], a[204:207], a[44:47], v[120:123]
buffer_load_dwordx4 a[96:99], v5, s[28:31], s45 offen offset:0 sc1
ds_read_b64_tr_b16 a[194:195], v30 offset:80
v_mfma_f32_16x16x32_bf16 v[112:115], a[208:211], a[44:47], v[112:115]
ds_read_b64_tr_b16 a[196:197], v28 offset:12032
v_mfma_f32_16x16x32_bf16 v[100:103], a[208:211], a[40:43], v[100:103]
buffer_load_dwordx4 a[100:103], v5, s[28:31], s45 offen offset:1024 sc1
ds_read_b64_tr_b16 a[198:199], v28 offset:12112
v_mfma_f32_16x16x32_bf16 v[104:107], a[212:215], a[40:43], v[104:107]
s_add_u32 s45, s45, 4096
ds_read_b64_tr_b16 a[200:201], v28 offset:12064
v_mfma_f32_16x16x32_bf16 v[116:119], a[212:215], a[44:47], v[116:119]
s_waitcnt vmcnt(12) lgkmcnt(5)
ds_read_b64_tr_b16 a[202:203], v28 offset:12144
v_mfma_f32_16x16x32_bf16 v[108:111], a[180:183], a[48:51], v[108:111]
ds_read_b64_tr_b16 a[204:205], v29 offset:0
v_add_u32 v30, v78, v30
v_mfma_f32_16x16x32_bf16 v[120:123], a[180:183], a[52:55], v[120:123]
buffer_load_dwordx4 a[104:107], v5, s[28:31], s45 offen offset:0 sc1
ds_read_b64_tr_b16 a[206:207], v29 offset:80
v_mfma_f32_16x16x32_bf16 v[112:115], a[184:187], a[52:55], v[112:115]
ds_read_b64_tr_b16 a[208:209], v27 offset:13312
v_mfma_f32_16x16x32_bf16 v[100:103], a[184:187], a[48:51], v[100:103]
buffer_load_dwordx4 a[108:111], v5, s[28:31], s45 offen offset:1024 sc1
ds_read_b64_tr_b16 a[210:211], v27 offset:13392
v_mfma_f32_16x16x32_bf16 v[104:107], a[188:191], a[48:51], v[104:107]
s_add_u32 s45, s45, 4096
ds_read_b64_tr_b16 a[212:213], v27 offset:13344
v_mfma_f32_16x16x32_bf16 v[116:119], a[188:191], a[52:55], v[116:119]
s_waitcnt vmcnt(12) lgkmcnt(5)
ds_read_b64_tr_b16 a[214:215], v27 offset:13424
v_mfma_f32_16x16x32_bf16 v[108:111], a[192:195], a[56:59], v[108:111]
ds_read_b64_tr_b16 a[180:181], v30 offset:0
v_add_u32 v29, v78, v29
v_mfma_f32_16x16x32_bf16 v[120:123], a[192:195], a[60:63], v[120:123]
buffer_load_dwordx4 a[112:115], v5, s[28:31], s45 offen offset:0 sc1
ds_read_b64_tr_b16 a[182:183], v30 offset:80
v_mfma_f32_16x16x32_bf16 v[112:115], a[196:199], a[60:63], v[112:115]
ds_read_b64_tr_b16 a[184:185], v28 offset:13312
v_mfma_f32_16x16x32_bf16 v[100:103], a[196:199], a[56:59], v[100:103]
buffer_load_dwordx4 a[116:119], v5, s[28:31], s45 offen offset:1024 sc1
ds_read_b64_tr_b16 a[186:187], v28 offset:13392
v_mfma_f32_16x16x32_bf16 v[104:107], a[200:203], a[56:59], v[104:107]
s_add_u32 s45, s45, 4096
ds_read_b64_tr_b16 a[188:189], v28 offset:13344
v_mfma_f32_16x16x32_bf16 v[116:119], a[200:203], a[60:63], v[116:119]
s_waitcnt vmcnt(12) lgkmcnt(5)
ds_read_b64_tr_b16 a[190:191], v28 offset:13424
v_mfma_f32_16x16x32_bf16 v[108:111], a[204:207], a[64:67], v[108:111]
ds_read_b64_tr_b16 a[192:193], v29 offset:0
v_add_u32 v30, v78, v30
v_mfma_f32_16x16x32_bf16 v[120:123], a[204:207], a[68:71], v[120:123]
buffer_load_dwordx4 a[120:123], v5, s[28:31], s45 offen offset:0 sc1
ds_read_b64_tr_b16 a[194:195], v29 offset:80
v_mfma_f32_16x16x32_bf16 v[112:115], a[208:211], a[68:71], v[112:115]
ds_read_b64_tr_b16 a[196:197], v27 offset:14592
v_mfma_f32_16x16x32_bf16 v[100:103], a[208:211], a[64:67], v[100:103]
buffer_load_dwordx4 a[124:127], v5, s[28:31], s45 offen offset:1024 sc1
ds_read_b64_tr_b16 a[198:199], v27 offset:14672
v_mfma_f32_16x16x32_bf16 v[104:107], a[212:215], a[64:67], v[104:107]
s_add_u32 s45, s45, 4096
ds_read_b64_tr_b16 a[200:201], v27 offset:14624
v_mfma_f32_16x16x32_bf16 v[116:119], a[212:215], a[68:71], v[116:119]
s_waitcnt vmcnt(12) lgkmcnt(5)
ds_read_b64_tr_b16 a[202:203], v27 offset:14704
v_mfma_f32_16x16x32_bf16 v[108:111], a[180:183], a[72:75], v[108:111]
ds_read_b64_tr_b16 a[204:205], v30 offset:0
v_add_u32 v29, v78, v29
v_mfma_f32_16x16x32_bf16 v[120:123], a[180:183], a[76:79], v[120:123]
buffer_load_dwordx4 v[188:191], v68, s[28:31], s45 offen offset:0 sc1
ds_read_b64_tr_b16 a[206:207], v30 offset:80
v_mfma_f32_16x16x32_bf16 v[112:115], a[184:187], a[76:79], v[112:115]
ds_read_b64_tr_b16 a[208:209], v28 offset:14592
v_mfma_f32_16x16x32_bf16 v[100:103], a[184:187], a[72:75], v[100:103]
buffer_load_dwordx4 v[192:195], v68, s[28:31], s45 offen offset:256 sc1
ds_read_b64_tr_b16 a[210:211], v28 offset:14672
v_mfma_f32_16x16x32_bf16 v[104:107], a[188:191], a[72:75], v[104:107]
s_add_u32 s45, s45, 4096
ds_read_b64_tr_b16 a[212:213], v28 offset:14624
v_mfma_f32_16x16x32_bf16 v[116:119], a[188:191], a[76:79], v[116:119]
s_waitcnt vmcnt(12) lgkmcnt(5)
ds_read_b64_tr_b16 a[214:215], v28 offset:14704
v_mfma_f32_16x16x32_bf16 v[108:111], a[192:195], a[80:83], v[108:111]
ds_read_b64_tr_b16 a[180:181], v29 offset:0
v_add_u32 v30, v78, v30
v_mfma_f32_16x16x32_bf16 v[120:123], a[192:195], a[84:87], v[120:123]
buffer_load_dwordx4 v[196:199], v68, s[28:31], s45 offen offset:0 sc1
ds_read_b64_tr_b16 a[182:183], v29 offset:80
v_mfma_f32_16x16x32_bf16 v[112:115], a[196:199], a[84:87], v[112:115]
s_branch iskip4
.p2align 12
ipad4:
s_branch ipad8
s_nop 0
iskip4:
ds_read_b64_tr_b16 a[184:185], v27 offset:15872
v_mfma_f32_16x16x32_bf16 v[100:103], a[196:199], a[80:83], v[100:103]
buffer_load_dwordx4 v[200:203], v68, s[28:31], s45 offen offset:256 sc1
ds_read_b64_tr_b16 a[186:187], v27 offset:15952
v_mfma_f32_16x16x32_bf16 v[104:107], a[200:203], a[80:83], v[104:107]
s_add_u32 s45, s45, 4096
ds_read_b64_tr_b16 a[188:189], v27 offset:15904
v_mfma_f32_16x16x32_bf16 v[116:119], a[200:203], a[84:87], v[116:119]
s_waitcnt vmcnt(12) lgkmcnt(5)
ds_read_b64_tr_b16 a[190:191], v27 offset:15984
v_mfma_f32_16x16x32_bf16 v[108:111], a[204:207], a[88:91], v[108:111]
ds_read_b64_tr_b16 a[192:193], v30 offset:0
v_add_u32 v29, v78, v29
v_mfma_f32_16x16x32_bf16 v[120:123], a[204:207], a[92:95], v[120:123]
ds_read_b64_tr_b16 a[194:195], v30 offset:80
v_mfma_f32_16x16x32_bf16 v[112:115], a[208:211], a[92:95], v[112:115]
ds_read_b64_tr_b16 a[196:197], v28 offset:15872
v_mfma_f32_16x16x32_bf16 v[100:103], a[208:211], a[88:91], v[100:103]
ds_read_b64_tr_b16 a[198:199], v28 offset:15952
v_mfma_f32_16x16x32_bf16 v[104:107], a[212:215], a[88:91], v[104:107]
ds_read_b64_tr_b16 a[200:201], v28 offset:15904
v_mfma_f32_16x16x32_bf16 v[116:119], a[212:215], a[92:95], v[116:119]
s_waitcnt vmcnt(10) lgkmcnt(5)
ds_read_b64_tr_b16 a[202:203], v28 offset:15984
v_mfma_f32_16x16x32_bf16 v[108:111], a[180:183], a[96:99], v[108:111]
ds_read_b64_tr_b16 a[204:205], v29 offset:0
v_add_u32 v30, v78, v30
v_mfma_f32_16x16x32_bf16 v[120:123], a[180:183], a[100:103], v[120:123]
buffer_store_dword v48, v64, s[28:31], s3 offen offset:132 sc1
ds_read_b64_tr_b16 a[206:207], v29 offset:80
v_mfma_f32_16x16x32_bf16 v[112:115], a[184:187], a[100:103], v[112:115]
ds_read_b64_tr_b16 a[208:209], v27 offset:17152
v_mfma_f32_16x16x32_bf16 v[100:103], a[184:187], a[96:99], v[100:103]
ds_read_b64_tr_b16 a[210:211], v27 offset:17232
v_mfma_f32_16x16x32_bf16 v[104:107], a[188:191], a[96:99], v[104:107]
ds_read_b64_tr_b16 a[212:213], v27 offset:17184
v_mfma_f32_16x16x32_bf16 v[116:119], a[188:191], a[100:103], v[116:119]
s_waitcnt vmcnt(9) lgkmcnt(5)
ds_read_b64_tr_b16 a[214:215], v27 offset:17264
v_mfma_f32_16x16x32_bf16 v[108:111], a[192:195], a[104:107], v[108:111]
ds_read_b64_tr_b16 a[180:181], v30 offset:0
v_add_u32 v29, v78, v29
v_mfma_f32_16x16x32_bf16 v[120:123], a[192:195], a[108:111], v[120:123]
ds_read_b64_tr_b16 a[182:183], v30 offset:80
v_mul_u32_u24 v70, 55296, v3
v_mfma_f32_16x16x32_bf16 v[112:115], a[196:199], a[108:111], v[112:115]
ds_read_b64_tr_b16 a[184:185], v28 offset:17152
v_lshl_add_u32 v70, v2, 4, v70
v_mfma_f32_16x16x32_bf16 v[100:103], a[196:199], a[104:107], v[100:103]
s_mov_b32 s101, s10
ds_read_b64_tr_b16 a[186:187], v28 offset:17232
v_mfma_f32_16x16x32_bf16 v[104:107], a[200:203], a[104:107], v[104:107]
ds_read_b64_tr_b16 a[188:189], v28 offset:17184
v_mfma_f32_16x16x32_bf16 v[116:119], a[200:203], a[108:111], v[116:119]
s_waitcnt vmcnt(7) lgkmcnt(5)
ds_read_b64_tr_b16 a[190:191], v28 offset:17264
v_mfma_f32_16x16x32_bf16 v[108:111], a[204:207], a[112:115], v[108:111]
ds_read_b64_tr_b16 a[192:193], v29 offset:0
v_add_u32 v30, v78, v30
v_mfma_f32_16x16x32_bf16 v[120:123], a[204:207], a[116:119], v[120:123]
ds_read_b64_tr_b16 a[194:195], v29 offset:80
v_mfma_f32_16x16x32_bf16 v[112:115], a[208:211], a[116:119], v[112:115]
ds_read_b64_tr_b16 a[196:197], v27 offset:18432
v_mfma_f32_16x16x32_bf16 v[100:103], a[208:211], a[112:115], v[100:103]
ds_read_b64_tr_b16 a[198:199], v27 offset:18512
v_mfma_f32_16x16x32_bf16 v[104:107], a[212:215], a[112:115], v[104:107]
ds_read_b64_tr_b16 a[200:201], v27 offset:18464
v_mfma_f32_16x16x32_bf16 v[116:119], a[212:215], a[116:119], v[116:119]
s_waitcnt vmcnt(5) lgkmcnt(5)
ds_read_b64_tr_b16 a[202:203], v27 offset:18544
v_mfma_f32_16x16x32_bf16 v[108:111], a[180:183], a[120:123], v[108:111]
ds_read_b64_tr_b16 a[204:205], v30 offset:0
v_mfma_f32_16x16x32_bf16 v[120:123], a[180:183], a[124:127], v[120:123]
ds_read_b64_tr_b16 a[206:207], v30 offset:80
v_mfma_f32_16x16x32_bf16 v[112:115], a[184:187], a[124:127], v[112:115]
ds_read_b64_tr_b16 a[208:209], v28 offset:18432
v_mfma_f32_16x16x32_bf16 v[100:103], a[184:187], a[120:123], v[100:103]
ds_read_b64_tr_b16 a[210:211], v28 offset:18512
v_mfma_f32_16x16x32_bf16 v[104:107], a[188:191], a[120:123], v[104:107]
ds_read_b64_tr_b16 a[212:213], v28 offset:18464
v_mfma_f32_16x16x32_bf16 v[116:119], a[188:191], a[124:127], v[116:119]
s_waitcnt vmcnt(3) lgkmcnt(5)
v_swap_b32 v190, v192
v_swap_b32 v191, v193
ds_read_b64_tr_b16 a[214:215], v28 offset:18544
s_nop 0
v_mfma_f32_16x16x32_bf16 v[108:111], a[192:195], v[188:191], v[108:111]
v_mfma_f32_16x16x32_bf16 v[120:123], a[192:195], v[192:195], v[120:123]
v_mfma_f32_16x16x32_bf16 v[112:115], a[196:199], v[192:195], v[112:115]
v_mfma_f32_16x16x32_bf16 v[100:103], a[196:199], v[188:191], v[100:103]
v_mfma_f32_16x16x32_bf16 v[104:107], a[200:203], v[188:191], v[104:107]
v_mfma_f32_16x16x32_bf16 v[116:119], a[200:203], v[192:195], v[116:119]
s_waitcnt vmcnt(1) lgkmcnt(0)
v_swap_b32 v198, v200
v_swap_b32 v199, v201
s_nop 1
v_mfma_f32_16x16x32_bf16 v[108:111], a[204:207], v[196:199], v[108:111]
v_mfma_f32_16x16x32_bf16 v[120:123], a[204:207], v[200:203], v[120:123]
v_mfma_f32_16x16x32_bf16 v[112:115], a[208:211], v[200:203], v[112:115]
v_mfma_f32_16x16x32_bf16 v[100:103], a[208:211], v[196:199], v[100:103]
v_mfma_f32_16x16x32_bf16 v[104:107], a[212:215], v[196:199], v[104:107]
v_mfma_f32_16x16x32_bf16 v[116:119], a[212:215], v[200:203], v[116:119]
s_nop 2
v_add_f32 v84, v108, v109
v_add_f32 v76, v108, v109
v_add_f32 v85, v120, v121
v_add_f32 v77, v120, v121
v_cmp_u_f32 vcc, v100, v112
v_permlane32_swap_b32 v84, v76
v_permlane32_swap_b32 v85, v77
s_and_b64 vcc, vcc, s[76:77]
s_cbranch_scc1 sequential_preLN__linear_kernel_hedgehog__glu_gated_bilinear__prompt_kernel_slow2
v_pk_add_f32 v[100:101], v[100:101], v[76:77] op_sel:[0,0] op_sel_hi:[1,0] neg_lo:[0,1] neg_hi:[0,1]
v_pk_add_f32 v[102:103], v[102:103], v[76:77] op_sel:[0,0] op_sel_hi:[1,0] neg_lo:[0,1] neg_hi:[0,1]
v_pk_add_f32 v[104:105], v[104:105], v[76:77] op_sel:[0,0] op_sel_hi:[1,0] neg_lo:[0,1] neg_hi:[0,1]
v_pk_add_f32 v[106:107], v[106:107], v[76:77] op_sel:[0,0] op_sel_hi:[1,0] neg_lo:[0,1] neg_hi:[0,1]
v_pk_add_f32 v[108:109], v[108:109], v[76:77] op_sel:[0,0] op_sel_hi:[1,0] neg_lo:[0,1] neg_hi:[0,1]
v_pk_add_f32 v[110:111], v[110:111], v[76:77] op_sel:[0,0] op_sel_hi:[1,0] neg_lo:[0,1] neg_hi:[0,1]
v_cvt_pk_bf16_f32 v128, v100, v101
v_cvt_pk_bf16_f32 v129, v102, v103
v_cvt_pk_bf16_f32 v130, v104, v105
v_cvt_pk_bf16_f32 v131, v106, v107
v_cvt_pk_bf16_f32 v132, v108, v109
v_cvt_pk_bf16_f32 v133, v110, v111
buffer_store_dwordx4 v[128:131], v5, s[28:31], s42 offen offset:0 sc1
v_pk_add_f32 v[112:113], v[112:113], v[76:77] op_sel:[0,1] op_sel_hi:[1,1] neg_lo:[0,1] neg_hi:[0,1]
v_pk_add_f32 v[114:115], v[114:115], v[76:77] op_sel:[0,1] op_sel_hi:[1,1] neg_lo:[0,1] neg_hi:[0,1]
v_pk_add_f32 v[116:117], v[116:117], v[76:77] op_sel:[0,1] op_sel_hi:[1,1] neg_lo:[0,1] neg_hi:[0,1]
v_pk_add_f32 v[118:119], v[118:119], v[76:77] op_sel:[0,1] op_sel_hi:[1,1] neg_lo:[0,1] neg_hi:[0,1]
v_pk_add_f32 v[120:121], v[120:121], v[76:77] op_sel:[0,1] op_sel_hi:[1,1] neg_lo:[0,1] neg_hi:[0,1]
v_pk_add_f32 v[122:123], v[122:123], v[76:77] op_sel:[0,1] op_sel_hi:[1,1] neg_lo:[0,1] neg_hi:[0,1]
v_cvt_pk_bf16_f32 v140, v112, v113
v_cvt_pk_bf16_f32 v141, v114, v115
v_cvt_pk_bf16_f32 v142, v116, v117
v_cvt_pk_bf16_f32 v143, v118, v119
v_cvt_pk_bf16_f32 v134, v120, v121
v_cvt_pk_bf16_f32 v135, v122, v123
buffer_store_dwordx4 v[140:143], v5, s[28:31], s42 offen offset:1024 sc1
buffer_store_dwordx4 v[132:135], v63, s[28:31], s43 offen sc1
v_pk_mul_f32 v[100:101], v[100:101], v[100:101]
v_pk_mul_f32 v[108:109], v[108:109], v[108:109]
v_pk_fma_f32 v[100:101], v[102:103], v[102:103], v[100:101]
v_pk_fma_f32 v[100:101], v[104:105], v[104:105], v[100:101]
v_pk_fma_f32 v[100:101], v[106:107], v[106:107], v[100:101]
v_pk_fma_f32 v[108:109], v[110:111], v[110:111], v[108:109]
v_add_f32 v84, v100, v101
v_add_f32 v88, v108, v109
v_cndmask_b32 v88, 0, v88, s[94:95]
v_add_f32 v84, v84, v88
v_pk_mul_f32 v[112:113], v[112:113], v[112:113]
v_pk_mul_f32 v[120:121], v[120:121], v[120:121]
v_pk_fma_f32 v[112:113], v[114:115], v[114:115], v[112:113]
v_pk_fma_f32 v[112:113], v[116:117], v[116:117], v[112:113]
v_pk_fma_f32 v[112:113], v[118:119], v[118:119], v[112:113]
v_pk_fma_f32 v[120:121], v[122:123], v[122:123], v[120:121]
v_add_f32 v85, v112, v113
v_add_f32 v89, v120, v121
v_cndmask_b32 v89, 0, v89, s[94:95]
v_add_f32 v85, v85, v89
buffer_store_dwordx2 v[76:77], v67, s[28:31], s48 offen sc1
v_pk_mov_b32 v[86:87], v[84:85], v[84:85] op_sel:[0,1]
s_nop 1
v_permlane16_swap_b32 v86, v84
v_permlane16_swap_b32 v87, v85
v_pk_add_f32 v[84:85], v[84:85], v[86:87]
v_pk_mov_b32 v[86:87], v[84:85], v[84:85] op_sel:[0,1]
s_nop 1
v_permlane32_swap_b32 v86, v84
v_permlane32_swap_b32 v87, v85
v_pk_add_f32 v[84:85], v[84:85], v[86:87]
buffer_store_dwordx2 v[84:85], v67, s[28:31], s44 offen sc1
s_barrier
s_cmp_lt_u32 s12, 2
s_cselect_b32 s4, s68, s70
s_cselect_b32 s5, s69, s71
s_mov_b64 s[76:77], s[72:73]
s_mov_b64 s[78:79], s[64:65]
v_and_b32 v245, 63, v0
v_lshlrev_b32 v1, 4, v245
v_lshrrev_b32 v246, 3, v245
v_and_b32 v247, 7, v245
v_and_b32 v248, 6, v246
v_xor_b32 v247, v247, v248
v_lshlrev_b32 v247, 4, v247
v_mul_u32_u24 v3, 9216, v246
v_add_u32 v3, v3, v247
v_add_u32 v4, 72704, v3
v_add_u32 v5, 145408, v3
v_add_u32 v6, 218112, v3
s_and_b32 s13, s2, 7
s_bfe_u32 s14, s2, 0x20003
s_lshr_b32 s15, s2, 5
s_mov_b32 s36, s15
s_lshl_b32 s15, s15, 2
s_add_u32 s15, s15, s12
s_and_b32 s32, s12, 1
s_lshr_b32 s33, s12, 1
s_lshl_b32 s34, s12, 12
s_mul_i32 s41, s13, 1152
s_lshl_b32 s37, s14, 7
s_add_u32 s41, s41, s37
s_mul_i32 s37, s32, 331776
s_add_u32 s40, s41, s37
s_add_u32 s71, s40, 5308416
s_mul_i32 s37, s36, 663552
s_add_u32 s40, s40, s37
s_mul_i32 s42, s15, 73728
s_add_u32 s42, s42, 0
s_add_u32 s72, s42, 65536
s_lshl_b32 s37, s36, 13
s_add_u32 s42, s42, s37
s_and_b32 s59, s13, 1
s_lshl_b32 s37, s59, 11
v_add_u32 v252, s37, v1
v_xor_b32 v251, 2048, v252
s_mov_b32 s51, s3
s_mov_b32 s16, s4
s_and_b32 s17, s5, 0xffff
s_mov_b32 s18, 5308416
s_mov_b32 s19, 0x20000
s_add_u32 m0, s34, 0
s_nop 0
buffer_load_dwordx4 v3, s[16:19], s40 offen offset:0 sc1 lds
buffer_load_dwordx4 v4, s[16:19], s40 offen offset:1024 sc1 lds
buffer_load_dwordx4 v5, s[16:19], s40 offen offset:2048 sc1 lds
buffer_load_dwordx4 v6, s[16:19], s40 offen offset:3072 sc1 lds
s_add_u32 s40, s40, 663552
s_cmp_ge_u32 s40, s71
s_cselect_b32 s37, 5308416, 0
s_sub_u32 s40, s40, s37
v_bfe_u32 v244, v245, 2, 1
v_lshrrev_b32 v249, 3, v245
v_lshl_add_u32 v244, v249, 3, v244
v_lshlrev_b32 v244, 12, v244
s_lshr_b32 s98, s15, 3
s_lshl_b32 s98, s98, 13
s_bfe_u32 s37, s15, 0x20001
s_lshl_b32 s37, s37, 18
s_add_u32 s98, s98, s37
s_add_u32 s98, s98, 10485760
s_mov_b32 s54, 0x40000
s_lshl_b32 s99, s13, 12
s_add_u32 s99, s99, 10486784
s_cmp_eq_u32 s12, 0
s_cselect_b32 s100, s51, 0x40000000
v_mov_b32 v24, 1
v_min_u32 v25, 1, v245
v_lshlrev_b32 v25, 30, v25
s_waitcnt vmcnt(6)
s_barrier
buffer_store_dword v24, v25, s[28:31], s100 offen sc1
v_mov_b32 v27, v70
s_add_u32 m0, s34, 16384
s_nop 0
buffer_load_dwordx4 v3, s[16:19], s40 offen offset:0 sc1 lds
buffer_load_dwordx4 v4, s[16:19], s40 offen offset:1024 sc1 lds
buffer_load_dwordx4 v5, s[16:19], s40 offen offset:2048 sc1 lds
buffer_load_dwordx4 v6, s[16:19], s40 offen offset:3072 sc1 lds
s_add_u32 s40, s40, 663552
s_cmp_ge_u32 s40, s71
s_cselect_b32 s37, 5308416, 0
s_sub_u32 s40, s40, s37
s_add_u32 m0, s34, 32768
s_nop 0
buffer_load_dwordx4 v3, s[16:19], s40 offen offset:0 sc1 lds
buffer_load_dwordx4 v4, s[16:19], s40 offen offset:1024 sc1 lds
buffer_load_dwordx4 v5, s[16:19], s40 offen offset:2048 sc1 lds
buffer_load_dwordx4 v6, s[16:19], s40 offen offset:3072 sc1 lds
s_add_u32 s40, s40, 663552
s_cmp_ge_u32 s40, s71
s_cselect_b32 s37, 5308416, 0
s_sub_u32 s40, s40, s37
s_add_u32 m0, s34, 49152
s_nop 0
buffer_load_dwordx4 v3, s[16:19], s40 offen offset:0 sc1 lds
buffer_load_dwordx4 v4, s[16:19], s40 offen offset:1024 sc1 lds
buffer_load_dwordx4 v5, s[16:19], s40 offen offset:2048 sc1 lds
buffer_load_dwordx4 v6, s[16:19], s40 offen offset:3072 sc1 lds
s_add_u32 s40, s40, 663552
s_cmp_ge_u32 s40, s71
s_cselect_b32 s37, 5308416, 0
s_sub_u32 s40, s40, s37
s_mov_b32 s20, s76
s_and_b32 s21, s77, 0xffff
s_mov_b32 s22, 5308416
s_mov_b32 s23, 0x20000
v_lshrrev_b32 v248, 2, v246
v_mul_u32_u24 v248, 294912, v248
v_add_u32 v7, v3, v248
s_mul_i32 s37, s32, 2654208
s_add_u32 s41, s41, s37
s_add_u32 s41, s41, 294912
v_mul_u32_u24 v8, 1152, v246
v_add_u32 v8, v8, v247
s_lshr_b32 s58, s13, 1
s_xor_b32 s75, s58, 3
s_and_b32 s37, s75, 1
s_lshl_b32 s37, s37, 6
v_xor_b32 v8, s37, v8
v_add_u32 v9, 8192, v8
v_add_u32 v10, 16384, v8
v_add_u32 v11, 24576, v8
v_lshlrev_b32 v2, 3, v245
v_lshrrev_b32 v246, 2, v245
v_and_b32 v247, 3, v245
v_lshlrev_b32 v247, 3, v247
v_bfe_u32 v248, v245, 3, 2
v_lshl_add_u32 v21, v246, 5, v247
v_add_u32 v21, 98304, v21
v_lshl_add_u32 v246, v246, 7, v247
v_xor_b32 v247, 0, v248
v_lshl_add_u32 v13, v247, 5, v246
v_add_u32 v17, 65536, v13
v_xor_b32 v247, 1, v248
v_lshl_add_u32 v14, v247, 5, v246
v_add_u32 v18, 65536, v14
v_xor_b32 v247, 2, v248
v_lshl_add_u32 v15, v247, 5, v246
v_add_u32 v19, 65536, v15
v_xor_b32 v247, 3, v248
v_lshl_add_u32 v16, v247, 5, v246
v_add_u32 v20, 65536, v16
v_lshrrev_b32 v22, 4, v245
v_lshlrev_b32 v22, 15, v22
v_mov_b32 v24, 1
v_min_u32 v25, 1, v245
v_lshlrev_b32 v25, 30, v25
s_lshl_b32 s56, s13, 2
s_add_u32 s56, s56, s14
s_mul_i32 s56, s56, 55296
s_add_u32 s56, s56, 14680064
s_lshl_b32 s37, s32, 10
s_add_u32 s57, s56, s37
s_mul_i32 s37, s33, 18432
s_add_u32 s43, s57, s37
s_add_u32 s73, s43, 16384
s_lshl_b32 s37, s36, 11
s_add_u32 s43, s43, s37
s_lshr_b32 s37, s2, 3
s_mul_i32 s37, s37, 18
s_add_u32 s37, s37, s12
s_mul_i32 s38, s13, 576
s_add_u32 s37, s37, s38
s_mul_i32 s74, s37, 1152
s_lshl_b32 s50, s13, 5
s_add_u32 s50, s50, s15
s_mul_i32 s44, s50, 73728
s_mul_i32 s37, s14, 18432
s_add_u32 s52, s44, s37
s_add_u32 s52, s52, 41943040
s_add_u32 s53, s52, 9216
s_add_u32 s44, s44, 16777216
s_lshl_b32 s37, s14, 13
s_add_u32 s45, s44, s37
s_lshl_b32 s37, s14, 11
s_add_u32 s46, s44, s37
s_add_u32 s46, s46, 65536
s_mov_b32 s47, s44
s_mul_i32 s49, s13, 663552
s_mul_i32 s37, s32, 36864
s_add_u32 s55, s49, s37
s_lshl_b32 s37, s14, 8
s_add_u32 s48, s55, s37
s_lshr_b32 s37, s75, 1
s_xor_b32 s37, s37, s33
s_lshl_b32 s37, s37, 7
s_add_u32 s48, s48, s37
s_add_u32 s37, s14, 0
s_and_b32 s37, s37, 3
s_mul_i32 s38, s37, 73728
s_add_u32 s60, s48, s38
s_lshl_b32 s37, s37, 13
s_add_u32 s64, s44, s37
s_add_u32 s37, s14, 1
s_and_b32 s37, s37, 3
s_mul_i32 s38, s37, 73728
s_add_u32 s61, s48, s38
s_lshl_b32 s37, s37, 13
s_add_u32 s65, s44, s37
s_add_u32 s37, s14, 2
s_and_b32 s37, s37, 3
s_mul_i32 s38, s37, 73728
s_add_u32 s62, s48, s38
s_lshl_b32 s37, s37, 13
s_add_u32 s66, s44, s37
s_add_u32 s37, s14, 3
s_and_b32 s37, s37, 3
s_mul_i32 s38, s37, 73728
s_add_u32 s63, s48, s38
s_lshl_b32 s37, s37, 13
s_add_u32 s67, s44, s37
s_add_u32 s57, s57, 36864
s_add_u32 s37, s14, s33
s_add_u32 s37, s37, 0
s_and_b32 s37, s37, 3
s_lshl_b32 s38, s37, 11
s_add_u32 s68, s57, s38
s_add_u32 s37, s14, s33
s_add_u32 s37, s37, 2
s_and_b32 s37, s37, 3
s_lshl_b32 s38, s37, 11
s_add_u32 s69, s57, s38
s_add_u32 s70, s57, 16384
s_add_u32 s48, s48, 589824
s_add_u32 s47, s44, 65536
v_lshrrev_b32 v26, 3, v245
v_lshlrev_b32 v26, 7, v26
s_lshl_b32 s37, s14, 15
s_sub_u32 s50, s51, s37
s_lshl_b32 s35, s12, 10
s_add_u32 s35, s35, 98304
sequential_preLN__linear_kernel_hedgehog__glu_gated_bilinear__prompt_kernel_f_s3:
buffer_load_dword v23, v244, s[28:31], s98 offen sc1
s_waitcnt vmcnt(0)
sequential_preLN__linear_kernel_hedgehog__glu_gated_bilinear__prompt_kernel_f_s3c:
v_cmp_eq_u32 vcc, 1, v23
s_sub_u32 s54, s54, 1
s_cmp_eq_u64 vcc, exec
s_cbranch_scc1 sequential_preLN__linear_kernel_hedgehog__glu_gated_bilinear__prompt_kernel_f_s3d
s_cmp_lg_u32 s54, 0
s_cbranch_scc1 sequential_preLN__linear_kernel_hedgehog__glu_gated_bilinear__prompt_kernel_f_s3
sequential_preLN__linear_kernel_hedgehog__glu_gated_bilinear__prompt_kernel_f_s3d:
s_add_u32 s8, s42, 4096
buffer_load_dwordx4 a[0:3], v251, s[28:31], s42 offen offset:0 sc1
buffer_load_dwordx4 a[16:19], v251, s[28:31], s8 offen offset:0 sc1
buffer_load_dwordx4 a[4:7], v251, s[28:31], s42 offen offset:1024 sc1
buffer_load_dwordx4 a[20:23], v251, s[28:31], s8 offen offset:1024 sc1
buffer_load_dwordx4 a[8:11], v252, s[28:31], s42 offen offset:0 sc1
buffer_load_dwordx4 a[24:27], v252, s[28:31], s8 offen offset:0 sc1
buffer_load_dwordx4 a[12:15], v252, s[28:31], s42 offen offset:1024 sc1
buffer_load_dwordx4 a[28:31], v252, s[28:31], s8 offen offset:1024 sc1
s_add_u32 s42, s42, 8192
s_cmp_ge_u32 s42, s72
s_cselect_b32 s37, 65536, 0
s_sub_u32 s42, s42, s37
buffer_load_dwordx4 a[32:35], v251, s[28:31], s42 offen offset:0 sc1
buffer_load_dwordx4 a[36:39], v251, s[28:31], s42 offen offset:1024 sc1
buffer_load_dwordx4 a[40:43], v252, s[28:31], s42 offen offset:0 sc1
buffer_load_dwordx4 a[44:47], v252, s[28:31], s42 offen offset:1024 sc1
s_add_u32 s42, s42, 4096
buffer_load_dwordx4 a[48:51], v251, s[28:31], s42 offen offset:0 sc1
buffer_load_dwordx4 a[52:55], v251, s[28:31], s42 offen offset:1024 sc1
buffer_load_dwordx4 a[56:59], v252, s[28:31], s42 offen offset:0 sc1
v_mov_b32 v12, v244
v_lshrrev_b32 v244, 1, v245
v_lshlrev_b32 v244, 15, v244
s_barrier
ds_read_b64_tr_b16 v[28:29], v13 offset:0
ds_read_b64_tr_b16 v[30:31], v13 offset:2048
ds_read_b64_tr_b16 v[32:33], v13 offset:4096
ds_read_b64_tr_b16 v[34:35], v13 offset:6144
ds_read_b64_tr_b16 v[36:37], v13 offset:8192
ds_read_b64_tr_b16 v[38:39], v13 offset:10240
ds_read_b64_tr_b16 v[40:41], v13 offset:12288
ds_read_b64_tr_b16 v[42:43], v13 offset:14336
s_waitcnt lgkmcnt(4)
s_waitcnt vmcnt(13)
v_mfma_f32_16x16x32_bf16 v[52:55], v[28:31], a[0:3], 0
ds_read_b64_tr_b16 v[44:45], v14 offset:0
v_mfma_f32_16x16x32_bf16 v[52:55], v[32:35], a[16:19], v[52:55]
buffer_load_dwordx4 a[60:63], v252, s[28:31], s42 offen offset:1024 sc1
s_waitcnt vmcnt(12)
v_mfma_f32_16x16x32_bf16 v[56:59], v[32:35], a[20:23], 0
s_add_u32 s42, s42, 4096
ds_read_b64_tr_b16 v[46:47], v14 offset:2048
v_mfma_f32_16x16x32_bf16 v[56:59], v[28:31], a[4:7], v[56:59]
s_cmp_ge_u32 s42, s72
s_cselect_b32 s37, 65536, 0
s_sub_u32 s42, s42, s37
s_waitcnt vmcnt(10)
v_mfma_f32_16x16x32_bf16 v[60:63], v[28:31], a[8:11], 0
ds_read_b64_tr_b16 v[48:49], v14 offset:4096
v_mfma_f32_16x16x32_bf16 v[60:63], v[32:35], a[24:27], v[60:63]
buffer_load_dwordx4 a[64:67], v251, s[28:31], s42 offen offset:0 sc1
s_waitcnt vmcnt(9)
v_mfma_f32_16x16x32_bf16 v[64:67], v[32:35], a[28:31], 0
ds_read_b64_tr_b16 v[50:51], v14 offset:6144
v_mfma_f32_16x16x32_bf16 v[64:67], v[28:31], a[12:15], v[64:67]
s_waitcnt lgkmcnt(4)
v_mfma_f32_16x16x32_bf16 v[80:83], v[36:39], a[12:15], 0
ds_read_b64_tr_b16 v[28:29], v14 offset:8192
v_mfma_f32_16x16x32_bf16 v[80:83], v[40:43], a[28:31], v[80:83]
buffer_load_dwordx4 a[68:71], v251, s[28:31], s42 offen offset:1024 sc1
v_mfma_f32_16x16x32_bf16 v[76:79], v[40:43], a[24:27], 0
ds_read_b64_tr_b16 v[30:31], v14 offset:10240
v_mfma_f32_16x16x32_bf16 v[76:79], v[36:39], a[8:11], v[76:79]
v_mfma_f32_16x16x32_bf16 v[72:75], v[36:39], a[4:7], 0
ds_read_b64_tr_b16 v[32:33], v14 offset:12288
v_mfma_f32_16x16x32_bf16 v[72:75], v[40:43], a[20:23], v[72:75]
buffer_load_dwordx4 a[72:75], v252, s[28:31], s42 offen offset:0 sc1
v_mfma_f32_16x16x32_bf16 v[68:71], v[40:43], a[16:19], 0
ds_read_b64_tr_b16 v[34:35], v14 offset:14336
v_mfma_f32_16x16x32_bf16 v[68:71], v[36:39], a[0:3], v[68:71]
s_waitcnt lgkmcnt(4)
v_mfma_f32_16x16x32_bf16 v[84:87], v[44:47], a[0:3], 0
ds_read_b64_tr_b16 v[36:37], v15 offset:0
v_mfma_f32_16x16x32_bf16 v[84:87], v[48:51], a[16:19], v[84:87]
buffer_load_dwordx4 a[76:79], v252, s[28:31], s42 offen offset:1024 sc1
v_mfma_f32_16x16x32_bf16 v[88:91], v[48:51], a[20:23], 0
s_add_u32 s42, s42, 4096
ds_read_b64_tr_b16 v[38:39], v15 offset:2048
v_mfma_f32_16x16x32_bf16 v[88:91], v[44:47], a[4:7], v[88:91]
v_mfma_f32_16x16x32_bf16 v[92:95], v[44:47], a[8:11], 0
ds_read_b64_tr_b16 v[40:41], v15 offset:4096
v_mfma_f32_16x16x32_bf16 v[92:95], v[48:51], a[24:27], v[92:95]
buffer_load_dwordx4 a[80:83], v251, s[28:31], s42 offen offset:0 sc1
v_mfma_f32_16x16x32_bf16 v[96:99], v[48:51], a[28:31], 0
ds_read_b64_tr_b16 v[42:43], v15 offset:6144
v_mfma_f32_16x16x32_bf16 v[96:99], v[44:47], a[12:15], v[96:99]
s_waitcnt lgkmcnt(4)
v_mfma_f32_16x16x32_bf16 v[112:115], v[28:31], a[12:15], 0
ds_read_b64_tr_b16 v[44:45], v15 offset:8192
v_mfma_f32_16x16x32_bf16 v[112:115], v[32:35], a[28:31], v[112:115]
buffer_load_dwordx4 a[84:87], v251, s[28:31], s42 offen offset:1024 sc1
v_mfma_f32_16x16x32_bf16 v[108:111], v[32:35], a[24:27], 0
ds_read_b64_tr_b16 v[46:47], v15 offset:10240
v_mfma_f32_16x16x32_bf16 v[108:111], v[28:31], a[8:11], v[108:111]
v_mfma_f32_16x16x32_bf16 v[104:107], v[28:31], a[4:7], 0
ds_read_b64_tr_b16 v[48:49], v15 offset:12288
v_mfma_f32_16x16x32_bf16 v[104:107], v[32:35], a[20:23], v[104:107]
buffer_load_dwordx4 a[88:91], v252, s[28:31], s42 offen offset:0 sc1
v_mfma_f32_16x16x32_bf16 v[100:103], v[32:35], a[16:19], 0
ds_read_b64_tr_b16 v[50:51], v15 offset:14336
v_mfma_f32_16x16x32_bf16 v[100:103], v[28:31], a[0:3], v[100:103]
s_waitcnt lgkmcnt(4)
v_mfma_f32_16x16x32_bf16 v[116:119], v[36:39], a[0:3], 0
ds_read_b64_tr_b16 v[28:29], v16 offset:0
v_mfma_f32_16x16x32_bf16 v[116:119], v[40:43], a[16:19], v[116:119]
buffer_load_dwordx4 a[92:95], v252, s[28:31], s42 offen offset:1024 sc1
v_mfma_f32_16x16x32_bf16 v[120:123], v[40:43], a[20:23], 0
s_add_u32 s42, s42, 4096
ds_read_b64_tr_b16 v[30:31], v16 offset:2048
v_mfma_f32_16x16x32_bf16 v[120:123], v[36:39], a[4:7], v[120:123]
s_cmp_ge_u32 s42, s72
s_cselect_b32 s37, 65536, 0
s_sub_u32 s42, s42, s37
v_mfma_f32_16x16x32_bf16 v[124:127], v[36:39], a[8:11], 0
ds_read_b64_tr_b16 v[32:33], v16 offset:4096
v_mfma_f32_16x16x32_bf16 v[124:127], v[40:43], a[24:27], v[124:127]
v_mfma_f32_16x16x32_bf16 v[128:131], v[40:43], a[28:31], 0
ds_read_b64_tr_b16 v[34:35], v16 offset:6144
v_mfma_f32_16x16x32_bf16 v[128:131], v[36:39], a[12:15], v[128:131]
s_waitcnt lgkmcnt(4)
v_mfma_f32_16x16x32_bf16 v[144:147], v[44:47], a[12:15], 0
ds_read_b64_tr_b16 v[36:37], v16 offset:8192
v_mfma_f32_16x16x32_bf16 v[144:147], v[48:51], a[28:31], v[144:147]
buffer_store_dwordx4 a[172:175], v27, s[28:31], s101 offen offset:0 sc1
v_mfma_f32_16x16x32_bf16 v[140:143], v[48:51], a[24:27], 0
ds_read_b64_tr_b16 v[38:39], v16 offset:10240
v_mfma_f32_16x16x32_bf16 v[140:143], v[44:47], a[8:11], v[140:143]
v_mfma_f32_16x16x32_bf16 v[136:139], v[44:47], a[4:7], 0
ds_read_b64_tr_b16 v[40:41], v16 offset:12288
v_mfma_f32_16x16x32_bf16 v[136:139], v[48:51], a[20:23], v[136:139]
v_mfma_f32_16x16x32_bf16 v[132:135], v[48:51], a[16:19], 0
ds_read_b64_tr_b16 v[42:43], v16 offset:14336
v_mfma_f32_16x16x32_bf16 v[132:135], v[44:47], a[0:3], v[132:135]
s_waitcnt lgkmcnt(4)
buffer_store_dwordx4 a[176:179], v27, s[28:31], s101 offen offset:256 sc1
v_mfma_f32_16x16x32_bf16 v[148:151], v[28:31], a[0:3], 0
ds_read_b64_tr_b16 v[44:45], v13 offset:16384
v_mfma_f32_16x16x32_bf16 v[148:151], v[32:35], a[16:19], v[148:151]
v_mfma_f32_16x16x32_bf16 v[152:155], v[32:35], a[20:23], 0
ds_read_b64_tr_b16 v[46:47], v13 offset:18432
v_mfma_f32_16x16x32_bf16 v[152:155], v[28:31], a[4:7], v[152:155]
v_mfma_f32_16x16x32_bf16 v[156:159], v[28:31], a[8:11], 0
ds_read_b64_tr_b16 v[48:49], v13 offset:20480
v_mfma_f32_16x16x32_bf16 v[156:159], v[32:35], a[24:27], v[156:159]
v_mfma_f32_16x16x32_bf16 v[160:163], v[32:35], a[28:31], 0
ds_read_b64_tr_b16 v[50:51], v13 offset:22528
v_mfma_f32_16x16x32_bf16 v[160:163], v[28:31], a[12:15], v[160:163]
s_waitcnt lgkmcnt(4)
v_mfma_f32_16x16x32_bf16 v[176:179], v[36:39], a[12:15], 0
ds_read_b64_tr_b16 v[28:29], v13 offset:24576
v_mfma_f32_16x16x32_bf16 v[176:179], v[40:43], a[28:31], v[176:179]
v_mfma_f32_16x16x32_bf16 v[172:175], v[40:43], a[24:27], 0
ds_read_b64_tr_b16 v[30:31], v13 offset:26624
v_mfma_f32_16x16x32_bf16 v[172:175], v[36:39], a[8:11], v[172:175]
v_mfma_f32_16x16x32_bf16 v[168:171], v[36:39], a[4:7], 0
ds_read_b64_tr_b16 v[32:33], v13 offset:28672
v_mfma_f32_16x16x32_bf16 v[168:171], v[40:43], a[20:23], v[168:171]
v_mfma_f32_16x16x32_bf16 v[164:167], v[40:43], a[16:19], 0
ds_read_b64_tr_b16 v[34:35], v13 offset:30720
v_mfma_f32_16x16x32_bf16 v[164:167], v[36:39], a[0:3], v[164:167]
s_waitcnt vmcnt(10) lgkmcnt(4)
v_mfma_f32_16x16x32_bf16 v[52:55], v[44:47], a[32:35], v[52:55]
s_add_u32 m0, s34, 65536
ds_read_b64_tr_b16 v[36:37], v14 offset:16384
v_mfma_f32_16x16x32_bf16 v[52:55], v[48:51], a[48:51], v[52:55]
buffer_load_dwordx4 v3, s[16:19], s40 offen offset:0 sc1 lds
v_mfma_f32_16x16x32_bf16 v[56:59], v[48:51], a[52:55], v[56:59]
ds_read_b64_tr_b16 v[38:39], v14 offset:18432
v_mfma_f32_16x16x32_bf16 v[56:59], v[44:47], a[36:39], v[56:59]
v_mfma_f32_16x16x32_bf16 v[60:63], v[44:47], a[40:43], v[60:63]
ds_read_b64_tr_b16 v[40:41], v14 offset:20480
v_mfma_f32_16x16x32_bf16 v[60:63], v[48:51], a[56:59], v[60:63]
buffer_load_dwordx4 v4, s[16:19], s40 offen offset:1024 sc1 lds
v_mfma_f32_16x16x32_bf16 v[64:67], v[48:51], a[60:63], v[64:67]
ds_read_b64_tr_b16 v[42:43], v14 offset:22528
v_mfma_f32_16x16x32_bf16 v[64:67], v[44:47], a[44:47], v[64:67]
s_waitcnt lgkmcnt(4)
v_mfma_f32_16x16x32_bf16 v[80:83], v[28:31], a[44:47], v[80:83]
ds_read_b64_tr_b16 v[44:45], v14 offset:24576
v_mfma_f32_16x16x32_bf16 v[80:83], v[32:35], a[60:63], v[80:83]
buffer_load_dwordx4 v5, s[16:19], s40 offen offset:2048 sc1 lds
v_mfma_f32_16x16x32_bf16 v[76:79], v[32:35], a[56:59], v[76:79]
ds_read_b64_tr_b16 v[46:47], v14 offset:26624
v_mfma_f32_16x16x32_bf16 v[76:79], v[28:31], a[40:43], v[76:79]
v_mfma_f32_16x16x32_bf16 v[72:75], v[28:31], a[36:39], v[72:75]
ds_read_b64_tr_b16 v[48:49], v14 offset:28672
v_mfma_f32_16x16x32_bf16 v[72:75], v[32:35], a[52:55], v[72:75]
buffer_load_dwordx4 v6, s[16:19], s40 offen offset:3072 sc1 lds
v_mfma_f32_16x16x32_bf16 v[68:71], v[32:35], a[48:51], v[68:71]
s_add_u32 s40, s40, 663552
ds_read_b64_tr_b16 v[50:51], v14 offset:30720
v_mfma_f32_16x16x32_bf16 v[68:71], v[28:31], a[32:35], v[68:71]
s_waitcnt lgkmcnt(4)
s_cmp_ge_u32 s40, s71
s_cselect_b32 s37, 5308416, 0
v_mfma_f32_16x16x32_bf16 v[84:87], v[36:39], a[32:35], v[84:87]
s_sub_u32 s40, s40, s37
ds_read_b64_tr_b16 v[28:29], v15 offset:16384
v_mfma_f32_16x16x32_bf16 v[84:87], v[40:43], a[48:51], v[84:87]
s_branch iskip5
.p2align 12
ipad5:
s_branch ipad9
s_nop 0
iskip5:
buffer_load_dwordx4 a[96:99], v251, s[28:31], s42 offen offset:0 sc1
v_mfma_f32_16x16x32_bf16 v[88:91], v[40:43], a[52:55], v[88:91]
ds_read_b64_tr_b16 v[30:31], v15 offset:18432
v_mfma_f32_16x16x32_bf16 v[88:91], v[36:39], a[36:39], v[88:91]
v_mfma_f32_16x16x32_bf16 v[92:95], v[36:39], a[40:43], v[92:95]
ds_read_b64_tr_b16 v[32:33], v15 offset:20480
v_mfma_f32_16x16x32_bf16 v[92:95], v[40:43], a[56:59], v[92:95]
buffer_load_dwordx4 a[100:103], v251, s[28:31], s42 offen offset:1024 sc1
v_mfma_f32_16x16x32_bf16 v[96:99], v[40:43], a[60:63], v[96:99]
ds_read_b64_tr_b16 v[34:35], v15 offset:22528
v_mfma_f32_16x16x32_bf16 v[96:99], v[36:39], a[44:47], v[96:99]
s_waitcnt lgkmcnt(4)
v_mfma_f32_16x16x32_bf16 v[112:115], v[44:47], a[44:47], v[112:115]
ds_read_b64_tr_b16 v[36:37], v15 offset:24576
v_mfma_f32_16x16x32_bf16 v[112:115], v[48:51], a[60:63], v[112:115]
buffer_load_dwordx4 a[104:107], v252, s[28:31], s42 offen offset:0 sc1
v_mfma_f32_16x16x32_bf16 v[108:111], v[48:51], a[56:59], v[108:111]
ds_read_b64_tr_b16 v[38:39], v15 offset:26624
v_mfma_f32_16x16x32_bf16 v[108:111], v[44:47], a[40:43], v[108:111]
v_mfma_f32_16x16x32_bf16 v[104:107], v[44:47], a[36:39], v[104:107]
ds_read_b64_tr_b16 v[40:41], v15 offset:28672
v_mfma_f32_16x16x32_bf16 v[104:107], v[48:51], a[52:55], v[104:107]
buffer_load_dwordx4 a[108:111], v252, s[28:31], s42 offen offset:1024 sc1
v_mfma_f32_16x16x32_bf16 v[100:103], v[48:51], a[48:51], v[100:103]
s_add_u32 s42, s42, 4096
ds_read_b64_tr_b16 v[42:43], v15 offset:30720
v_mfma_f32_16x16x32_bf16 v[100:103], v[44:47], a[32:35], v[100:103]
s_waitcnt lgkmcnt(4)
v_mfma_f32_16x16x32_bf16 v[116:119], v[28:31], a[32:35], v[116:119]
ds_read_b64_tr_b16 v[44:45], v16 offset:16384
v_mfma_f32_16x16x32_bf16 v[116:119], v[32:35], a[48:51], v[116:119]
buffer_load_dwordx4 a[112:115], v251, s[28:31], s42 offen offset:0 sc1
v_mfma_f32_16x16x32_bf16 v[120:123], v[32:35], a[52:55], v[120:123]
ds_read_b64_tr_b16 v[46:47], v16 offset:18432
v_mfma_f32_16x16x32_bf16 v[120:123], v[28:31], a[36:39], v[120:123]
v_mfma_f32_16x16x32_bf16 v[124:127], v[28:31], a[40:43], v[124:127]
ds_read_b64_tr_b16 v[48:49], v16 offset:20480
v_mfma_f32_16x16x32_bf16 v[124:127], v[32:35], a[56:59], v[124:127]
buffer_load_dwordx4 a[116:119], v251, s[28:31], s42 offen offset:1024 sc1
v_mfma_f32_16x16x32_bf16 v[128:131], v[32:35], a[60:63], v[128:131]
ds_read_b64_tr_b16 v[50:51], v16 offset:22528
v_mfma_f32_16x16x32_bf16 v[128:131], v[28:31], a[44:47], v[128:131]
s_waitcnt lgkmcnt(4)
v_mfma_f32_16x16x32_bf16 v[144:147], v[36:39], a[44:47], v[144:147]
ds_read_b64_tr_b16 v[28:29], v16 offset:24576
v_mfma_f32_16x16x32_bf16 v[144:147], v[40:43], a[60:63], v[144:147]
buffer_load_dwordx4 a[120:123], v252, s[28:31], s42 offen offset:0 sc1
v_mfma_f32_16x16x32_bf16 v[140:143], v[40:43], a[56:59], v[140:143]
ds_read_b64_tr_b16 v[30:31], v16 offset:26624
v_mfma_f32_16x16x32_bf16 v[140:143], v[36:39], a[40:43], v[140:143]
v_mfma_f32_16x16x32_bf16 v[136:139], v[36:39], a[36:39], v[136:139]
ds_read_b64_tr_b16 v[32:33], v16 offset:28672
v_mfma_f32_16x16x32_bf16 v[136:139], v[40:43], a[52:55], v[136:139]
buffer_load_dwordx4 a[124:127], v252, s[28:31], s42 offen offset:1024 sc1
v_mfma_f32_16x16x32_bf16 v[132:135], v[40:43], a[48:51], v[132:135]
s_add_u32 s42, s42, 4096
ds_read_b64_tr_b16 v[34:35], v16 offset:30720
v_mfma_f32_16x16x32_bf16 v[132:135], v[36:39], a[32:35], v[132:135]
s_waitcnt lgkmcnt(4)
s_cmp_ge_u32 s42, s72
s_cselect_b32 s37, 65536, 0
v_mfma_f32_16x16x32_bf16 v[148:151], v[44:47], a[32:35], v[148:151]
s_sub_u32 s42, s42, s37
ds_read_b64_tr_b16 v[36:37], v13 offset:32768
v_mfma_f32_16x16x32_bf16 v[148:151], v[48:51], a[48:51], v[148:151]
v_mfma_f32_16x16x32_bf16 v[152:155], v[48:51], a[52:55], v[152:155]
ds_read_b64_tr_b16 v[38:39], v13 offset:34816
v_mfma_f32_16x16x32_bf16 v[152:155], v[44:47], a[36:39], v[152:155]
v_mfma_f32_16x16x32_bf16 v[156:159], v[44:47], a[40:43], v[156:159]
ds_read_b64_tr_b16 v[40:41], v13 offset:36864
v_mfma_f32_16x16x32_bf16 v[156:159], v[48:51], a[56:59], v[156:159]
v_mfma_f32_16x16x32_bf16 v[160:163], v[48:51], a[60:63], v[160:163]
ds_read_b64_tr_b16 v[42:43], v13 offset:38912
v_mfma_f32_16x16x32_bf16 v[160:163], v[44:47], a[44:47], v[160:163]
s_waitcnt lgkmcnt(4)
v_mfma_f32_16x16x32_bf16 v[176:179], v[28:31], a[44:47], v[176:179]
ds_read_b64_tr_b16 v[44:45], v13 offset:40960
v_mfma_f32_16x16x32_bf16 v[176:179], v[32:35], a[60:63], v[176:179]
v_mfma_f32_16x16x32_bf16 v[172:175], v[32:35], a[56:59], v[172:175]
ds_read_b64_tr_b16 v[46:47], v13 offset:43008
v_mfma_f32_16x16x32_bf16 v[172:175], v[28:31], a[40:43], v[172:175]
v_mfma_f32_16x16x32_bf16 v[168:171], v[28:31], a[36:39], v[168:171]
ds_read_b64_tr_b16 v[48:49], v13 offset:45056
v_mfma_f32_16x16x32_bf16 v[168:171], v[32:35], a[52:55], v[168:171]
v_mfma_f32_16x16x32_bf16 v[164:167], v[32:35], a[48:51], v[164:167]
ds_read_b64_tr_b16 v[50:51], v13 offset:47104
v_mfma_f32_16x16x32_bf16 v[164:167], v[28:31], a[32:35], v[164:167]
s_waitcnt vmcnt(14) lgkmcnt(4)
v_mfma_f32_16x16x32_bf16 v[52:55], v[36:39], a[64:67], v[52:55]
s_add_u32 m0, s34, 81920
ds_read_b64_tr_b16 v[28:29], v14 offset:32768
v_mfma_f32_16x16x32_bf16 v[52:55], v[40:43], a[80:83], v[52:55]
buffer_load_dwordx4 v3, s[16:19], s40 offen offset:0 sc1 lds
v_mfma_f32_16x16x32_bf16 v[56:59], v[40:43], a[84:87], v[56:59]
ds_read_b64_tr_b16 v[30:31], v14 offset:34816
v_mfma_f32_16x16x32_bf16 v[56:59], v[36:39], a[68:71], v[56:59]
v_mfma_f32_16x16x32_bf16 v[60:63], v[36:39], a[72:75], v[60:63]
ds_read_b64_tr_b16 v[32:33], v14 offset:36864
v_mfma_f32_16x16x32_bf16 v[60:63], v[40:43], a[88:91], v[60:63]
buffer_load_dwordx4 v4, s[16:19], s40 offen offset:1024 sc1 lds
v_mfma_f32_16x16x32_bf16 v[64:67], v[40:43], a[92:95], v[64:67]
ds_read_b64_tr_b16 v[34:35], v14 offset:38912
v_mfma_f32_16x16x32_bf16 v[64:67], v[36:39], a[76:79], v[64:67]
s_waitcnt lgkmcnt(4)
v_mfma_f32_16x16x32_bf16 v[80:83], v[44:47], a[76:79], v[80:83]
ds_read_b64_tr_b16 v[36:37], v14 offset:40960
v_mfma_f32_16x16x32_bf16 v[80:83], v[48:51], a[92:95], v[80:83]
buffer_load_dwordx4 v5, s[16:19], s40 offen offset:2048 sc1 lds
v_mfma_f32_16x16x32_bf16 v[76:79], v[48:51], a[88:91], v[76:79]
ds_read_b64_tr_b16 v[38:39], v14 offset:43008
v_mfma_f32_16x16x32_bf16 v[76:79], v[44:47], a[72:75], v[76:79]
v_mfma_f32_16x16x32_bf16 v[72:75], v[44:47], a[68:71], v[72:75]
ds_read_b64_tr_b16 v[40:41], v14 offset:45056
v_mfma_f32_16x16x32_bf16 v[72:75], v[48:51], a[84:87], v[72:75]
buffer_load_dwordx4 v6, s[16:19], s40 offen offset:3072 sc1 lds
v_mfma_f32_16x16x32_bf16 v[68:71], v[48:51], a[80:83], v[68:71]
s_add_u32 s40, s40, 663552
ds_read_b64_tr_b16 v[42:43], v14 offset:47104
v_mfma_f32_16x16x32_bf16 v[68:71], v[44:47], a[64:67], v[68:71]
s_waitcnt lgkmcnt(4)
s_cmp_ge_u32 s40, s71
s_cselect_b32 s37, 5308416, 0
v_mfma_f32_16x16x32_bf16 v[84:87], v[28:31], a[64:67], v[84:87]
s_sub_u32 s40, s40, s37
ds_read_b64_tr_b16 v[44:45], v15 offset:32768
v_mfma_f32_16x16x32_bf16 v[84:87], v[32:35], a[80:83], v[84:87]
buffer_load_dwordx4 a[128:131], v251, s[28:31], s42 offen offset:0 sc1
v_mfma_f32_16x16x32_bf16 v[88:91], v[32:35], a[84:87], v[88:91]
ds_read_b64_tr_b16 v[46:47], v15 offset:34816
v_mfma_f32_16x16x32_bf16 v[88:91], v[28:31], a[68:71], v[88:91]
v_mfma_f32_16x16x32_bf16 v[92:95], v[28:31], a[72:75], v[92:95]
ds_read_b64_tr_b16 v[48:49], v15 offset:36864
v_mfma_f32_16x16x32_bf16 v[92:95], v[32:35], a[88:91], v[92:95]
buffer_load_dwordx4 a[132:135], v251, s[28:31], s42 offen offset:1024 sc1
v_mfma_f32_16x16x32_bf16 v[96:99], v[32:35], a[92:95], v[96:99]
ds_read_b64_tr_b16 v[50:51], v15 offset:38912
v_mfma_f32_16x16x32_bf16 v[96:99], v[28:31], a[76:79], v[96:99]
s_waitcnt lgkmcnt(4)
v_mfma_f32_16x16x32_bf16 v[112:115], v[36:39], a[76:79], v[112:115]
ds_read_b64_tr_b16 v[28:29], v15 offset:40960
v_mfma_f32_16x16x32_bf16 v[112:115], v[40:43], a[92:95], v[112:115]
buffer_load_dwordx4 a[136:139], v252, s[28:31], s42 offen offset:0 sc1
v_mfma_f32_16x16x32_bf16 v[108:111], v[40:43], a[88:91], v[108:111]
ds_read_b64_tr_b16 v[30:31], v15 offset:43008
v_mfma_f32_16x16x32_bf16 v[108:111], v[36:39], a[72:75], v[108:111]
v_mfma_f32_16x16x32_bf16 v[104:107], v[36:39], a[68:71], v[104:107]
ds_read_b64_tr_b16 v[32:33], v15 offset:45056
v_mfma_f32_16x16x32_bf16 v[104:107], v[40:43], a[84:87], v[104:107]
buffer_load_dwordx4 a[140:143], v252, s[28:31], s42 offen offset:1024 sc1
v_mfma_f32_16x16x32_bf16 v[100:103], v[40:43], a[80:83], v[100:103]
s_add_u32 s42, s42, 4096
ds_read_b64_tr_b16 v[34:35], v15 offset:47104
v_mfma_f32_16x16x32_bf16 v[100:103], v[36:39], a[64:67], v[100:103]
s_waitcnt lgkmcnt(4)
v_mfma_f32_16x16x32_bf16 v[116:119], v[44:47], a[64:67], v[116:119]
ds_read_b64_tr_b16 v[36:37], v16 offset:32768
v_mfma_f32_16x16x32_bf16 v[116:119], v[48:51], a[80:83], v[116:119]
buffer_load_dwordx4 a[144:147], v251, s[28:31], s42 offen offset:0 sc1
v_mfma_f32_16x16x32_bf16 v[120:123], v[48:51], a[84:87], v[120:123]
ds_read_b64_tr_b16 v[38:39], v16 offset:34816
v_mfma_f32_16x16x32_bf16 v[120:123], v[44:47], a[68:71], v[120:123]
v_mfma_f32_16x16x32_bf16 v[124:127], v[44:47], a[72:75], v[124:127]
ds_read_b64_tr_b16 v[40:41], v16 offset:36864
v_mfma_f32_16x16x32_bf16 v[124:127], v[48:51], a[88:91], v[124:127]
buffer_load_dwordx4 a[148:151], v251, s[28:31], s42 offen offset:1024 sc1
v_mfma_f32_16x16x32_bf16 v[128:131], v[48:51], a[92:95], v[128:131]
ds_read_b64_tr_b16 v[42:43], v16 offset:38912
v_mfma_f32_16x16x32_bf16 v[128:131], v[44:47], a[76:79], v[128:131]
s_waitcnt lgkmcnt(4)
v_mfma_f32_16x16x32_bf16 v[144:147], v[28:31], a[76:79], v[144:147]
ds_read_b64_tr_b16 v[44:45], v16 offset:40960
v_mfma_f32_16x16x32_bf16 v[144:147], v[32:35], a[92:95], v[144:147]
buffer_load_dwordx4 a[152:155], v252, s[28:31], s42 offen offset:0 sc1
v_mfma_f32_16x16x32_bf16 v[140:143], v[32:35], a[88:91], v[140:143]
ds_read_b64_tr_b16 v[46:47], v16 offset:43008
v_mfma_f32_16x16x32_bf16 v[140:143], v[28:31], a[72:75], v[140:143]
v_mfma_f32_16x16x32_bf16 v[136:139], v[28:31], a[68:71], v[136:139]
ds_read_b64_tr_b16 v[48:49], v16 offset:45056
v_mfma_f32_16x16x32_bf16 v[136:139], v[32:35], a[84:87], v[136:139]
buffer_load_dwordx4 a[156:159], v252, s[28:31], s42 offen offset:1024 sc1
v_mfma_f32_16x16x32_bf16 v[132:135], v[32:35], a[80:83], v[132:135]
s_add_u32 s42, s42, 4096
ds_read_b64_tr_b16 v[50:51], v16 offset:47104
v_mfma_f32_16x16x32_bf16 v[132:135], v[28:31], a[64:67], v[132:135]
s_waitcnt vmcnt(24) lgkmcnt(4)
s_barrier
v_mfma_f32_16x16x32_bf16 v[148:151], v[36:39], a[64:67], v[148:151]
s_cmp_ge_u32 s42, s72
s_cselect_b32 s37, 65536, 0
ds_read_b64_tr_b16 v[28:29], v13 offset:49152
v_mfma_f32_16x16x32_bf16 v[148:151], v[40:43], a[80:83], v[148:151]
s_sub_u32 s42, s42, s37
v_mfma_f32_16x16x32_bf16 v[152:155], v[40:43], a[84:87], v[152:155]
ds_read_b64_tr_b16 v[30:31], v13 offset:51200
v_mfma_f32_16x16x32_bf16 v[152:155], v[36:39], a[68:71], v[152:155]
buffer_store_dword v24, v25, s[28:31], s100 offen offset:1024 sc1
v_mfma_f32_16x16x32_bf16 v[156:159], v[36:39], a[72:75], v[156:159]
ds_read_b64_tr_b16 v[32:33], v13 offset:53248
v_mfma_f32_16x16x32_bf16 v[156:159], v[40:43], a[88:91], v[156:159]
v_mfma_f32_16x16x32_bf16 v[160:163], v[40:43], a[92:95], v[160:163]
ds_read_b64_tr_b16 v[34:35], v13 offset:55296
v_mfma_f32_16x16x32_bf16 v[160:163], v[36:39], a[76:79], v[160:163]
s_waitcnt lgkmcnt(4)
v_mfma_f32_16x16x32_bf16 v[176:179], v[44:47], a[76:79], v[176:179]
ds_read_b64_tr_b16 v[36:37], v13 offset:57344
v_mfma_f32_16x16x32_bf16 v[176:179], v[48:51], a[92:95], v[176:179]
v_mfma_f32_16x16x32_bf16 v[172:175], v[48:51], a[88:91], v[172:175]
ds_read_b64_tr_b16 v[38:39], v13 offset:59392
v_mfma_f32_16x16x32_bf16 v[172:175], v[44:47], a[72:75], v[172:175]
v_mfma_f32_16x16x32_bf16 v[168:171], v[44:47], a[68:71], v[168:171]
ds_read_b64_tr_b16 v[40:41], v13 offset:61440
v_mfma_f32_16x16x32_bf16 v[168:171], v[48:51], a[84:87], v[168:171]
v_mfma_f32_16x16x32_bf16 v[164:167], v[48:51], a[80:83], v[164:167]
ds_read_b64_tr_b16 v[42:43], v13 offset:63488
v_mfma_f32_16x16x32_bf16 v[164:167], v[44:47], a[64:67], v[164:167]
s_waitcnt vmcnt(13) lgkmcnt(4)
v_mfma_f32_16x16x32_bf16 v[52:55], v[28:31], a[96:99], v[52:55]
s_add_u32 m0, s34, 0
ds_read_b64_tr_b16 v[44:45], v14 offset:49152
v_mfma_f32_16x16x32_bf16 v[52:55], v[32:35], a[112:115], v[52:55]
buffer_load_dwordx4 v3, s[16:19], s40 offen offset:0 sc1 lds
v_mfma_f32_16x16x32_bf16 v[56:59], v[32:35], a[116:119], v[56:59]
ds_read_b64_tr_b16 v[46:47], v14 offset:51200
v_mfma_f32_16x16x32_bf16 v[56:59], v[28:31], a[100:103], v[56:59]
v_mfma_f32_16x16x32_bf16 v[60:63], v[28:31], a[104:107], v[60:63]
ds_read_b64_tr_b16 v[48:49], v14 offset:53248
v_mfma_f32_16x16x32_bf16 v[60:63], v[32:35], a[120:123], v[60:63]
buffer_load_dwordx4 v4, s[16:19], s40 offen offset:1024 sc1 lds
v_mfma_f32_16x16x32_bf16 v[64:67], v[32:35], a[124:127], v[64:67]
ds_read_b64_tr_b16 v[50:51], v14 offset:55296
v_mfma_f32_16x16x32_bf16 v[64:67], v[28:31], a[108:111], v[64:67]
s_waitcnt lgkmcnt(4)
v_mfma_f32_16x16x32_bf16 v[80:83], v[36:39], a[108:111], v[80:83]
ds_read_b64_tr_b16 v[28:29], v14 offset:57344
v_mfma_f32_16x16x32_bf16 v[80:83], v[40:43], a[124:127], v[80:83]
buffer_load_dwordx4 v5, s[16:19], s40 offen offset:2048 sc1 lds
v_mfma_f32_16x16x32_bf16 v[76:79], v[40:43], a[120:123], v[76:79]
ds_read_b64_tr_b16 v[30:31], v14 offset:59392
v_mfma_f32_16x16x32_bf16 v[76:79], v[36:39], a[104:107], v[76:79]
v_mfma_f32_16x16x32_bf16 v[72:75], v[36:39], a[100:103], v[72:75]
ds_read_b64_tr_b16 v[32:33], v14 offset:61440
v_mfma_f32_16x16x32_bf16 v[72:75], v[40:43], a[116:119], v[72:75]
buffer_load_dwordx4 v6, s[16:19], s40 offen offset:3072 sc1 lds
v_mfma_f32_16x16x32_bf16 v[68:71], v[40:43], a[112:115], v[68:71]
s_add_u32 s40, s40, 663552
ds_read_b64_tr_b16 v[34:35], v14 offset:63488
v_mfma_f32_16x16x32_bf16 v[68:71], v[36:39], a[96:99], v[68:71]
s_waitcnt lgkmcnt(4)
s_cmp_ge_u32 s40, s71
s_cselect_b32 s37, 5308416, 0
v_mfma_f32_16x16x32_bf16 v[84:87], v[44:47], a[96:99], v[84:87]
s_sub_u32 s40, s40, s37
ds_read_b64_tr_b16 v[36:37], v15 offset:49152
v_mfma_f32_16x16x32_bf16 v[84:87], v[48:51], a[112:115], v[84:87]
buffer_load_dwordx4 a[160:163], v251, s[28:31], s42 offen offset:0 sc1
v_mfma_f32_16x16x32_bf16 v[88:91], v[48:51], a[116:119], v[88:91]
ds_read_b64_tr_b16 v[38:39], v15 offset:51200
v_mfma_f32_16x16x32_bf16 v[88:91], v[44:47], a[100:103], v[88:91]
v_mfma_f32_16x16x32_bf16 v[92:95], v[44:47], a[104:107], v[92:95]
ds_read_b64_tr_b16 v[40:41], v15 offset:53248
v_mfma_f32_16x16x32_bf16 v[92:95], v[48:51], a[120:123], v[92:95]
buffer_load_dwordx4 a[164:167], v251, s[28:31], s42 offen offset:1024 sc1
v_mfma_f32_16x16x32_bf16 v[96:99], v[48:51], a[124:127], v[96:99]
ds_read_b64_tr_b16 v[42:43], v15 offset:55296
v_mfma_f32_16x16x32_bf16 v[96:99], v[44:47], a[108:111], v[96:99]
s_waitcnt lgkmcnt(4)
v_mfma_f32_16x16x32_bf16 v[112:115], v[28:31], a[108:111], v[112:115]
ds_read_b64_tr_b16 v[44:45], v15 offset:57344
v_mfma_f32_16x16x32_bf16 v[112:115], v[32:35], a[124:127], v[112:115]
buffer_load_dwordx4 a[168:171], v252, s[28:31], s42 offen offset:0 sc1
v_mfma_f32_16x16x32_bf16 v[108:111], v[32:35], a[120:123], v[108:111]
ds_read_b64_tr_b16 v[46:47], v15 offset:59392
v_mfma_f32_16x16x32_bf16 v[108:111], v[28:31], a[104:107], v[108:111]
v_mfma_f32_16x16x32_bf16 v[104:107], v[28:31], a[100:103], v[104:107]
ds_read_b64_tr_b16 v[48:49], v15 offset:61440
v_mfma_f32_16x16x32_bf16 v[104:107], v[32:35], a[116:119], v[104:107]
buffer_load_dwordx4 a[172:175], v252, s[28:31], s42 offen offset:1024 sc1
v_mfma_f32_16x16x32_bf16 v[100:103], v[32:35], a[112:115], v[100:103]
s_add_u32 s42, s42, 4096
ds_read_b64_tr_b16 v[50:51], v15 offset:63488
v_mfma_f32_16x16x32_bf16 v[100:103], v[28:31], a[96:99], v[100:103]
s_waitcnt lgkmcnt(4)
v_mfma_f32_16x16x32_bf16 v[116:119], v[36:39], a[96:99], v[116:119]
ds_read_b64_tr_b16 v[28:29], v16 offset:49152
v_mfma_f32_16x16x32_bf16 v[116:119], v[40:43], a[112:115], v[116:119]
buffer_load_dwordx4 a[176:179], v251, s[28:31], s42 offen offset:0 sc1
v_mfma_f32_16x16x32_bf16 v[120:123], v[40:43], a[116:119], v[120:123]
ds_read_b64_tr_b16 v[30:31], v16 offset:51200
v_mfma_f32_16x16x32_bf16 v[120:123], v[36:39], a[100:103], v[120:123]
v_mfma_f32_16x16x32_bf16 v[124:127], v[36:39], a[104:107], v[124:127]
ds_read_b64_tr_b16 v[32:33], v16 offset:53248
v_mfma_f32_16x16x32_bf16 v[124:127], v[40:43], a[120:123], v[124:127]
buffer_load_dwordx4 a[180:183], v251, s[28:31], s42 offen offset:1024 sc1
v_mfma_f32_16x16x32_bf16 v[128:131], v[40:43], a[124:127], v[128:131]
ds_read_b64_tr_b16 v[34:35], v16 offset:55296
v_mfma_f32_16x16x32_bf16 v[128:131], v[36:39], a[108:111], v[128:131]
s_waitcnt lgkmcnt(4)
v_mfma_f32_16x16x32_bf16 v[144:147], v[44:47], a[108:111], v[144:147]
ds_read_b64_tr_b16 v[36:37], v16 offset:57344
v_mfma_f32_16x16x32_bf16 v[144:147], v[48:51], a[124:127], v[144:147]
buffer_load_dwordx4 a[184:187], v252, s[28:31], s42 offen offset:0 sc1
v_mfma_f32_16x16x32_bf16 v[140:143], v[48:51], a[120:123], v[140:143]
ds_read_b64_tr_b16 v[38:39], v16 offset:59392
v_mfma_f32_16x16x32_bf16 v[140:143], v[44:47], a[104:107], v[140:143]
v_mfma_f32_16x16x32_bf16 v[136:139], v[44:47], a[100:103], v[136:139]
ds_read_b64_tr_b16 v[40:41], v16 offset:61440
v_mfma_f32_16x16x32_bf16 v[136:139], v[48:51], a[116:119], v[136:139]
buffer_load_dwordx4 a[188:191], v252, s[28:31], s42 offen offset:1024 sc1
v_mfma_f32_16x16x32_bf16 v[132:135], v[48:51], a[112:115], v[132:135]
s_add_u32 s42, s42, 4096
ds_read_b64_tr_b16 v[42:43], v16 offset:63488
v_mfma_f32_16x16x32_bf16 v[132:135], v[44:47], a[96:99], v[132:135]
s_waitcnt lgkmcnt(4)
s_barrier
v_mfma_f32_16x16x32_bf16 v[148:151], v[28:31], a[96:99], v[148:151]
s_cmp_ge_u32 s42, s72
s_cselect_b32 s37, 65536, 0
ds_read_b64_tr_b16 v[44:45], v17 offset:0
v_mfma_f32_16x16x32_bf16 v[148:151], v[32:35], a[112:115], v[148:151]
s_sub_u32 s42, s42, s37
v_mfma_f32_16x16x32_bf16 v[152:155], v[32:35], a[116:119], v[152:155]
ds_read_b64_tr_b16 v[46:47], v17 offset:2048
v_mfma_f32_16x16x32_bf16 v[152:155], v[28:31], a[100:103], v[152:155]
v_mfma_f32_16x16x32_bf16 v[156:159], v[28:31], a[104:107], v[156:159]
ds_read_b64_tr_b16 v[48:49], v17 offset:4096
v_mfma_f32_16x16x32_bf16 v[156:159], v[32:35], a[120:123], v[156:159]
v_mfma_f32_16x16x32_bf16 v[160:163], v[32:35], a[124:127], v[160:163]
ds_read_b64_tr_b16 v[50:51], v17 offset:6144
v_mfma_f32_16x16x32_bf16 v[160:163], v[28:31], a[108:111], v[160:163]
s_waitcnt lgkmcnt(4)
v_mfma_f32_16x16x32_bf16 v[176:179], v[36:39], a[108:111], v[176:179]
ds_read_b64_tr_b16 v[28:29], v17 offset:8192
v_mfma_f32_16x16x32_bf16 v[176:179], v[40:43], a[124:127], v[176:179]
v_mfma_f32_16x16x32_bf16 v[172:175], v[40:43], a[120:123], v[172:175]
ds_read_b64_tr_b16 v[30:31], v17 offset:10240
v_mfma_f32_16x16x32_bf16 v[172:175], v[36:39], a[104:107], v[172:175]
v_mfma_f32_16x16x32_bf16 v[168:171], v[36:39], a[100:103], v[168:171]
ds_read_b64_tr_b16 v[32:33], v17 offset:12288
v_mfma_f32_16x16x32_bf16 v[168:171], v[40:43], a[116:119], v[168:171]
v_mfma_f32_16x16x32_bf16 v[164:167], v[40:43], a[112:115], v[164:167]
ds_read_b64_tr_b16 v[34:35], v17 offset:14336
v_mfma_f32_16x16x32_bf16 v[164:167], v[36:39], a[96:99], v[164:167]
s_waitcnt vmcnt(13) lgkmcnt(4)
v_mfma_f32_16x16x32_bf16 v[52:55], v[44:47], a[128:131], v[52:55]
s_add_u32 m0, s34, 16384
ds_read_b64_tr_b16 v[36:37], v18 offset:0
v_mfma_f32_16x16x32_bf16 v[52:55], v[48:51], a[144:147], v[52:55]
buffer_load_dwordx4 v3, s[16:19], s40 offen offset:0 sc1 lds
v_mfma_f32_16x16x32_bf16 v[56:59], v[48:51], a[148:151], v[56:59]
ds_read_b64_tr_b16 v[38:39], v18 offset:2048
v_mfma_f32_16x16x32_bf16 v[56:59], v[44:47], a[132:135], v[56:59]
v_mfma_f32_16x16x32_bf16 v[60:63], v[44:47], a[136:139], v[60:63]
ds_read_b64_tr_b16 v[40:41], v18 offset:4096
v_mfma_f32_16x16x32_bf16 v[60:63], v[48:51], a[152:155], v[60:63]
buffer_load_dwordx4 v4, s[16:19], s40 offen offset:1024 sc1 lds
v_mfma_f32_16x16x32_bf16 v[64:67], v[48:51], a[156:159], v[64:67]
ds_read_b64_tr_b16 v[42:43], v18 offset:6144
v_mfma_f32_16x16x32_bf16 v[64:67], v[44:47], a[140:143], v[64:67]
s_waitcnt lgkmcnt(4)
v_mfma_f32_16x16x32_bf16 v[80:83], v[28:31], a[140:143], v[80:83]
ds_read_b64_tr_b16 v[44:45], v18 offset:8192
v_mfma_f32_16x16x32_bf16 v[80:83], v[32:35], a[156:159], v[80:83]
buffer_load_dwordx4 v5, s[16:19], s40 offen offset:2048 sc1 lds
v_mfma_f32_16x16x32_bf16 v[76:79], v[32:35], a[152:155], v[76:79]
ds_read_b64_tr_b16 v[46:47], v18 offset:10240
v_mfma_f32_16x16x32_bf16 v[76:79], v[28:31], a[136:139], v[76:79]
v_mfma_f32_16x16x32_bf16 v[72:75], v[28:31], a[132:135], v[72:75]
ds_read_b64_tr_b16 v[48:49], v18 offset:12288
v_mfma_f32_16x16x32_bf16 v[72:75], v[32:35], a[148:151], v[72:75]
buffer_load_dwordx4 v6, s[16:19], s40 offen offset:3072 sc1 lds
v_mfma_f32_16x16x32_bf16 v[68:71], v[32:35], a[144:147], v[68:71]
s_add_u32 s40, s40, 663552
ds_read_b64_tr_b16 v[50:51], v18 offset:14336
v_mfma_f32_16x16x32_bf16 v[68:71], v[28:31], a[128:131], v[68:71]
s_waitcnt lgkmcnt(4)
s_cmp_ge_u32 s40, s71
s_cselect_b32 s37, 5308416, 0
v_mfma_f32_16x16x32_bf16 v[84:87], v[36:39], a[128:131], v[84:87]
s_sub_u32 s40, s40, s37
ds_read_b64_tr_b16 v[28:29], v19 offset:0
v_mfma_f32_16x16x32_bf16 v[84:87], v[40:43], a[144:147], v[84:87]
buffer_load_dwordx4 a[192:195], v251, s[28:31], s42 offen offset:0 sc1
v_mfma_f32_16x16x32_bf16 v[88:91], v[40:43], a[148:151], v[88:91]
ds_read_b64_tr_b16 v[30:31], v19 offset:2048
v_mfma_f32_16x16x32_bf16 v[88:91], v[36:39], a[132:135], v[88:91]
v_mfma_f32_16x16x32_bf16 v[92:95], v[36:39], a[136:139], v[92:95]
ds_read_b64_tr_b16 v[32:33], v19 offset:4096
v_mfma_f32_16x16x32_bf16 v[92:95], v[40:43], a[152:155], v[92:95]
buffer_load_dwordx4 a[196:199], v251, s[28:31], s42 offen offset:1024 sc1
v_mfma_f32_16x16x32_bf16 v[96:99], v[40:43], a[156:159], v[96:99]
ds_read_b64_tr_b16 v[34:35], v19 offset:6144
v_mfma_f32_16x16x32_bf16 v[96:99], v[36:39], a[140:143], v[96:99]
s_waitcnt lgkmcnt(4)
v_mfma_f32_16x16x32_bf16 v[112:115], v[44:47], a[140:143], v[112:115]
ds_read_b64_tr_b16 v[36:37], v19 offset:8192
v_mfma_f32_16x16x32_bf16 v[112:115], v[48:51], a[156:159], v[112:115]
buffer_load_dwordx4 a[200:203], v252, s[28:31], s42 offen offset:0 sc1
v_mfma_f32_16x16x32_bf16 v[108:111], v[48:51], a[152:155], v[108:111]
ds_read_b64_tr_b16 v[38:39], v19 offset:10240
v_mfma_f32_16x16x32_bf16 v[108:111], v[44:47], a[136:139], v[108:111]
v_mfma_f32_16x16x32_bf16 v[104:107], v[44:47], a[132:135], v[104:107]
ds_read_b64_tr_b16 v[40:41], v19 offset:12288
v_mfma_f32_16x16x32_bf16 v[104:107], v[48:51], a[148:151], v[104:107]
buffer_load_dwordx4 a[204:207], v252, s[28:31], s42 offen offset:1024 sc1
v_mfma_f32_16x16x32_bf16 v[100:103], v[48:51], a[144:147], v[100:103]
s_add_u32 s42, s42, 4096
ds_read_b64_tr_b16 v[42:43], v19 offset:14336
v_mfma_f32_16x16x32_bf16 v[100:103], v[44:47], a[128:131], v[100:103]
s_waitcnt lgkmcnt(4)
v_mfma_f32_16x16x32_bf16 v[116:119], v[28:31], a[128:131], v[116:119]
ds_read_b64_tr_b16 v[44:45], v20 offset:0
v_mfma_f32_16x16x32_bf16 v[116:119], v[32:35], a[144:147], v[116:119]
buffer_load_dwordx4 a[208:211], v251, s[28:31], s42 offen offset:0 sc1
v_mfma_f32_16x16x32_bf16 v[120:123], v[32:35], a[148:151], v[120:123]
ds_read_b64_tr_b16 v[46:47], v20 offset:2048
v_mfma_f32_16x16x32_bf16 v[120:123], v[28:31], a[132:135], v[120:123]
v_mfma_f32_16x16x32_bf16 v[124:127], v[28:31], a[136:139], v[124:127]
ds_read_b64_tr_b16 v[48:49], v20 offset:4096
v_mfma_f32_16x16x32_bf16 v[124:127], v[32:35], a[152:155], v[124:127]
buffer_load_dwordx4 a[212:215], v251, s[28:31], s42 offen offset:1024 sc1
v_mfma_f32_16x16x32_bf16 v[128:131], v[32:35], a[156:159], v[128:131]
ds_read_b64_tr_b16 v[50:51], v20 offset:6144
v_mfma_f32_16x16x32_bf16 v[128:131], v[28:31], a[140:143], v[128:131]
s_waitcnt lgkmcnt(4)
v_mfma_f32_16x16x32_bf16 v[144:147], v[36:39], a[140:143], v[144:147]
ds_read_b64_tr_b16 v[28:29], v20 offset:8192
v_mfma_f32_16x16x32_bf16 v[144:147], v[40:43], a[156:159], v[144:147]
buffer_load_dwordx4 a[216:219], v252, s[28:31], s42 offen offset:0 sc1
v_mfma_f32_16x16x32_bf16 v[140:143], v[40:43], a[152:155], v[140:143]
ds_read_b64_tr_b16 v[30:31], v20 offset:10240
v_mfma_f32_16x16x32_bf16 v[140:143], v[36:39], a[136:139], v[140:143]
v_mfma_f32_16x16x32_bf16 v[136:139], v[36:39], a[132:135], v[136:139]
ds_read_b64_tr_b16 v[32:33], v20 offset:12288
v_mfma_f32_16x16x32_bf16 v[136:139], v[40:43], a[148:151], v[136:139]
buffer_load_dwordx4 a[220:223], v252, s[28:31], s42 offen offset:1024 sc1
v_mfma_f32_16x16x32_bf16 v[132:135], v[40:43], a[144:147], v[132:135]
s_add_u32 s42, s42, 4096
ds_read_b64_tr_b16 v[34:35], v20 offset:14336
v_mfma_f32_16x16x32_bf16 v[132:135], v[36:39], a[128:131], v[132:135]
s_waitcnt lgkmcnt(4)
s_barrier
v_mfma_f32_16x16x32_bf16 v[148:151], v[44:47], a[128:131], v[148:151]
s_cmp_ge_u32 s42, s72
s_cselect_b32 s37, 65536, 0
ds_read_b64_tr_b16 v[36:37], v17 offset:16384
v_mfma_f32_16x16x32_bf16 v[148:151], v[48:51], a[144:147], v[148:151]
s_sub_u32 s42, s42, s37
v_mfma_f32_16x16x32_bf16 v[152:155], v[48:51], a[148:151], v[152:155]
ds_read_b64_tr_b16 v[38:39], v17 offset:18432
v_mfma_f32_16x16x32_bf16 v[152:155], v[44:47], a[132:135], v[152:155]
v_mfma_f32_16x16x32_bf16 v[156:159], v[44:47], a[136:139], v[156:159]
ds_read_b64_tr_b16 v[40:41], v17 offset:20480
v_mfma_f32_16x16x32_bf16 v[156:159], v[48:51], a[152:155], v[156:159]
v_mfma_f32_16x16x32_bf16 v[160:163], v[48:51], a[156:159], v[160:163]
ds_read_b64_tr_b16 v[42:43], v17 offset:22528
v_mfma_f32_16x16x32_bf16 v[160:163], v[44:47], a[140:143], v[160:163]
s_waitcnt lgkmcnt(4)
v_mfma_f32_16x16x32_bf16 v[176:179], v[28:31], a[140:143], v[176:179]
ds_read_b64_tr_b16 v[44:45], v17 offset:24576
v_mfma_f32_16x16x32_bf16 v[176:179], v[32:35], a[156:159], v[176:179]
v_mfma_f32_16x16x32_bf16 v[172:175], v[32:35], a[152:155], v[172:175]
ds_read_b64_tr_b16 v[46:47], v17 offset:26624
v_mfma_f32_16x16x32_bf16 v[172:175], v[28:31], a[136:139], v[172:175]
v_mfma_f32_16x16x32_bf16 v[168:171], v[28:31], a[132:135], v[168:171]
ds_read_b64_tr_b16 v[48:49], v17 offset:28672
v_mfma_f32_16x16x32_bf16 v[168:171], v[32:35], a[148:151], v[168:171]
v_mfma_f32_16x16x32_bf16 v[164:167], v[32:35], a[144:147], v[164:167]
ds_read_b64_tr_b16 v[50:51], v17 offset:30720
v_mfma_f32_16x16x32_bf16 v[164:167], v[28:31], a[128:131], v[164:167]
s_waitcnt vmcnt(12) lgkmcnt(4)
v_mfma_f32_16x16x32_bf16 v[52:55], v[36:39], a[160:163], v[52:55]
s_add_u32 m0, s34, 32768
ds_read_b64_tr_b16 v[28:29], v18 offset:16384
v_mfma_f32_16x16x32_bf16 v[52:55], v[40:43], a[176:179], v[52:55]
buffer_load_dwordx4 v7, s[16:19], s41 offen offset:0 sc1 lds
v_mfma_f32_16x16x32_bf16 v[56:59], v[40:43], a[180:183], v[56:59]
s_add_u32 s41, s41, 662528
ds_read_b64_tr_b16 v[30:31], v18 offset:18432
v_mfma_f32_16x16x32_bf16 v[56:59], v[36:39], a[164:167], v[56:59]
v_mfma_f32_16x16x32_bf16 v[60:63], v[36:39], a[168:171], v[60:63]
ds_read_b64_tr_b16 v[32:33], v18 offset:20480
v_mfma_f32_16x16x32_bf16 v[60:63], v[40:43], a[184:187], v[60:63]
buffer_load_dwordx4 v7, s[16:19], s41 offen offset:1024 sc1 lds
v_mfma_f32_16x16x32_bf16 v[64:67], v[40:43], a[188:191], v[64:67]
s_add_u32 s41, s41, 662528
ds_read_b64_tr_b16 v[34:35], v18 offset:22528
v_mfma_f32_16x16x32_bf16 v[64:67], v[36:39], a[172:175], v[64:67]
s_waitcnt lgkmcnt(4)
v_mfma_f32_16x16x32_bf16 v[80:83], v[44:47], a[172:175], v[80:83]
ds_read_b64_tr_b16 v[36:37], v18 offset:24576
v_mfma_f32_16x16x32_bf16 v[80:83], v[48:51], a[188:191], v[80:83]
buffer_load_dwordx4 v7, s[16:19], s41 offen offset:2048 sc1 lds
v_mfma_f32_16x16x32_bf16 v[76:79], v[48:51], a[184:187], v[76:79]
s_add_u32 s41, s41, 662528
ds_read_b64_tr_b16 v[38:39], v18 offset:26624
v_mfma_f32_16x16x32_bf16 v[76:79], v[44:47], a[168:171], v[76:79]
v_mfma_f32_16x16x32_bf16 v[72:75], v[44:47], a[164:167], v[72:75]
ds_read_b64_tr_b16 v[40:41], v18 offset:28672
v_mfma_f32_16x16x32_bf16 v[72:75], v[48:51], a[180:183], v[72:75]
buffer_load_dwordx4 v7, s[16:19], s41 offen offset:3072 sc1 lds
v_mfma_f32_16x16x32_bf16 v[68:71], v[48:51], a[176:179], v[68:71]
s_sub_u32 s41, s41, 1987072
ds_read_b64_tr_b16 v[42:43], v18 offset:30720
s_add_u32 s40, s40, 512
v_mfma_f32_16x16x32_bf16 v[68:71], v[44:47], a[160:163], v[68:71]
s_waitcnt lgkmcnt(4)
s_add_u32 s71, s71, 512
v_mfma_f32_16x16x32_bf16 v[84:87], v[28:31], a[160:163], v[84:87]
ds_read_b64_tr_b16 v[44:45], v19 offset:16384
v_mfma_f32_16x16x32_bf16 v[84:87], v[32:35], a[176:179], v[84:87]
buffer_load_dwordx4 a[224:227], v251, s[28:31], s42 offen offset:0 sc1
v_mfma_f32_16x16x32_bf16 v[88:91], v[32:35], a[180:183], v[88:91]
ds_read_b64_tr_b16 v[46:47], v19 offset:18432
v_mfma_f32_16x16x32_bf16 v[88:91], v[28:31], a[164:167], v[88:91]
v_mfma_f32_16x16x32_bf16 v[92:95], v[28:31], a[168:171], v[92:95]
ds_read_b64_tr_b16 v[48:49], v19 offset:20480
v_mfma_f32_16x16x32_bf16 v[92:95], v[32:35], a[184:187], v[92:95]
buffer_load_dwordx4 a[228:231], v251, s[28:31], s42 offen offset:1024 sc1
v_mfma_f32_16x16x32_bf16 v[96:99], v[32:35], a[188:191], v[96:99]
ds_read_b64_tr_b16 v[50:51], v19 offset:22528
v_mfma_f32_16x16x32_bf16 v[96:99], v[28:31], a[172:175], v[96:99]
s_waitcnt lgkmcnt(4)
v_mfma_f32_16x16x32_bf16 v[112:115], v[36:39], a[172:175], v[112:115]
ds_read_b64_tr_b16 v[28:29], v19 offset:24576
v_mfma_f32_16x16x32_bf16 v[112:115], v[40:43], a[188:191], v[112:115]
buffer_load_dwordx4 a[232:235], v252, s[28:31], s42 offen offset:0 sc1
v_mfma_f32_16x16x32_bf16 v[108:111], v[40:43], a[184:187], v[108:111]
ds_read_b64_tr_b16 v[30:31], v19 offset:26624
v_mfma_f32_16x16x32_bf16 v[108:111], v[36:39], a[168:171], v[108:111]
v_mfma_f32_16x16x32_bf16 v[104:107], v[36:39], a[164:167], v[104:107]
ds_read_b64_tr_b16 v[32:33], v19 offset:28672
v_mfma_f32_16x16x32_bf16 v[104:107], v[40:43], a[180:183], v[104:107]
s_branch iskip6
.p2align 12
ipad6:
s_branch ipad10
iskip6:
buffer_load_dwordx4 a[236:239], v252, s[28:31], s42 offen offset:1024 sc1
v_mfma_f32_16x16x32_bf16 v[100:103], v[40:43], a[176:179], v[100:103]
s_add_u32 s42, s42, 4096
ds_read_b64_tr_b16 v[34:35], v19 offset:30720
v_mfma_f32_16x16x32_bf16 v[100:103], v[36:39], a[160:163], v[100:103]
s_waitcnt lgkmcnt(4)
v_mfma_f32_16x16x32_bf16 v[116:119], v[44:47], a[160:163], v[116:119]
ds_read_b64_tr_b16 v[36:37], v20 offset:16384
v_mfma_f32_16x16x32_bf16 v[116:119], v[48:51], a[176:179], v[116:119]
buffer_load_dwordx4 a[240:243], v251, s[28:31], s42 offen offset:0 sc1
v_mfma_f32_16x16x32_bf16 v[120:123], v[48:51], a[180:183], v[120:123]
ds_read_b64_tr_b16 v[38:39], v20 offset:18432
v_mfma_f32_16x16x32_bf16 v[120:123], v[44:47], a[164:167], v[120:123]
v_mfma_f32_16x16x32_bf16 v[124:127], v[44:47], a[168:171], v[124:127]
ds_read_b64_tr_b16 v[40:41], v20 offset:20480
v_mfma_f32_16x16x32_bf16 v[124:127], v[48:51], a[184:187], v[124:127]
buffer_load_dwordx4 a[244:247], v251, s[28:31], s42 offen offset:1024 sc1
v_mfma_f32_16x16x32_bf16 v[128:131], v[48:51], a[188:191], v[128:131]
ds_read_b64_tr_b16 v[42:43], v20 offset:22528
v_mfma_f32_16x16x32_bf16 v[128:131], v[44:47], a[172:175], v[128:131]
s_waitcnt lgkmcnt(4)
v_mfma_f32_16x16x32_bf16 v[144:147], v[28:31], a[172:175], v[144:147]
ds_read_b64_tr_b16 v[44:45], v20 offset:24576
v_mfma_f32_16x16x32_bf16 v[144:147], v[32:35], a[188:191], v[144:147]
buffer_load_dwordx4 a[248:251], v252, s[28:31], s42 offen offset:0 sc1
v_mfma_f32_16x16x32_bf16 v[140:143], v[32:35], a[184:187], v[140:143]
ds_read_b64_tr_b16 v[46:47], v20 offset:26624
v_mfma_f32_16x16x32_bf16 v[140:143], v[28:31], a[168:171], v[140:143]
v_mfma_f32_16x16x32_bf16 v[136:139], v[28:31], a[164:167], v[136:139]
ds_read_b64_tr_b16 v[48:49], v20 offset:28672
v_mfma_f32_16x16x32_bf16 v[136:139], v[32:35], a[180:183], v[136:139]
buffer_load_dwordx4 a[252:255], v252, s[28:31], s42 offen offset:1024 sc1
v_mfma_f32_16x16x32_bf16 v[132:135], v[32:35], a[176:179], v[132:135]
ds_read_b64_tr_b16 v[50:51], v20 offset:30720
v_mfma_f32_16x16x32_bf16 v[132:135], v[28:31], a[160:163], v[132:135]
s_waitcnt lgkmcnt(4)
s_barrier
v_mfma_f32_16x16x32_bf16 v[148:151], v[36:39], a[160:163], v[148:151]
ds_read_b64_tr_b16 v[28:29], v13 offset:0
v_mfma_f32_16x16x32_bf16 v[148:151], v[40:43], a[176:179], v[148:151]
v_mfma_f32_16x16x32_bf16 v[152:155], v[40:43], a[180:183], v[152:155]
ds_read_b64_tr_b16 v[30:31], v13 offset:2048
v_mfma_f32_16x16x32_bf16 v[152:155], v[36:39], a[164:167], v[152:155]
v_mfma_f32_16x16x32_bf16 v[156:159], v[36:39], a[168:171], v[156:159]
ds_read_b64_tr_b16 v[32:33], v13 offset:4096
v_mfma_f32_16x16x32_bf16 v[156:159], v[40:43], a[184:187], v[156:159]
v_mfma_f32_16x16x32_bf16 v[160:163], v[40:43], a[188:191], v[160:163]
ds_read_b64_tr_b16 v[34:35], v13 offset:6144
v_mfma_f32_16x16x32_bf16 v[160:163], v[36:39], a[172:175], v[160:163]
s_waitcnt lgkmcnt(4)
v_mfma_f32_16x16x32_bf16 v[176:179], v[44:47], a[172:175], v[176:179]
ds_read_b64_tr_b16 v[36:37], v13 offset:8192
v_mfma_f32_16x16x32_bf16 v[176:179], v[48:51], a[188:191], v[176:179]
v_mfma_f32_16x16x32_bf16 v[172:175], v[48:51], a[184:187], v[172:175]
ds_read_b64_tr_b16 v[38:39], v13 offset:10240
v_mfma_f32_16x16x32_bf16 v[172:175], v[44:47], a[168:171], v[172:175]
v_mfma_f32_16x16x32_bf16 v[168:171], v[44:47], a[164:167], v[168:171]
ds_read_b64_tr_b16 v[40:41], v13 offset:12288
v_mfma_f32_16x16x32_bf16 v[168:171], v[48:51], a[180:183], v[168:171]
v_mfma_f32_16x16x32_bf16 v[164:167], v[48:51], a[176:179], v[164:167]
ds_read_b64_tr_b16 v[42:43], v13 offset:14336
v_mfma_f32_16x16x32_bf16 v[164:167], v[44:47], a[160:163], v[164:167]
s_waitcnt vmcnt(12) lgkmcnt(4)
v_mfma_f32_16x16x32_bf16 v[52:55], v[28:31], a[192:195], v[52:55]
ds_read_b64_tr_b16 v[44:45], v14 offset:0
v_mfma_f32_16x16x32_bf16 v[52:55], v[32:35], a[208:211], v[52:55]
buffer_load_dwordx4 v[212:215], v251, s[28:31], s72 offen offset:0 sc1
v_mfma_f32_16x16x32_bf16 v[56:59], v[32:35], a[212:215], v[56:59]
ds_read_b64_tr_b16 v[46:47], v14 offset:2048
v_mfma_f32_16x16x32_bf16 v[56:59], v[28:31], a[196:199], v[56:59]
v_mfma_f32_16x16x32_bf16 v[60:63], v[28:31], a[200:203], v[60:63]
ds_read_b64_tr_b16 v[48:49], v14 offset:4096
v_mfma_f32_16x16x32_bf16 v[60:63], v[32:35], a[216:219], v[60:63]
buffer_load_dwordx4 v[216:219], v251, s[28:31], s72 offen offset:1024 sc1
v_mfma_f32_16x16x32_bf16 v[64:67], v[32:35], a[220:223], v[64:67]
ds_read_b64_tr_b16 v[50:51], v14 offset:6144
v_mfma_f32_16x16x32_bf16 v[64:67], v[28:31], a[204:207], v[64:67]
s_waitcnt lgkmcnt(4)
v_mfma_f32_16x16x32_bf16 v[80:83], v[36:39], a[204:207], v[80:83]
ds_read_b64_tr_b16 v[28:29], v14 offset:8192
v_mfma_f32_16x16x32_bf16 v[80:83], v[40:43], a[220:223], v[80:83]
buffer_load_dwordx4 v[220:223], v252, s[28:31], s72 offen offset:0 sc1
v_mfma_f32_16x16x32_bf16 v[76:79], v[40:43], a[216:219], v[76:79]
ds_read_b64_tr_b16 v[30:31], v14 offset:10240
v_mfma_f32_16x16x32_bf16 v[76:79], v[36:39], a[200:203], v[76:79]
v_mfma_f32_16x16x32_bf16 v[72:75], v[36:39], a[196:199], v[72:75]
ds_read_b64_tr_b16 v[32:33], v14 offset:12288
v_mfma_f32_16x16x32_bf16 v[72:75], v[40:43], a[212:215], v[72:75]
buffer_load_dwordx4 v[224:227], v252, s[28:31], s72 offen offset:1024 sc1
v_mfma_f32_16x16x32_bf16 v[68:71], v[40:43], a[208:211], v[68:71]
s_add_u32 s72, s72, 4096
ds_read_b64_tr_b16 v[34:35], v14 offset:14336
v_mfma_f32_16x16x32_bf16 v[68:71], v[36:39], a[192:195], v[68:71]
s_waitcnt lgkmcnt(4)
v_mfma_f32_16x16x32_bf16 v[84:87], v[44:47], a[192:195], v[84:87]
ds_read_b64_tr_b16 v[36:37], v15 offset:0
v_mfma_f32_16x16x32_bf16 v[84:87], v[48:51], a[208:211], v[84:87]
buffer_load_dwordx4 v[228:231], v251, s[28:31], s72 offen offset:0 sc1
v_mfma_f32_16x16x32_bf16 v[88:91], v[48:51], a[212:215], v[88:91]
ds_read_b64_tr_b16 v[38:39], v15 offset:2048
v_mfma_f32_16x16x32_bf16 v[88:91], v[44:47], a[196:199], v[88:91]
v_mfma_f32_16x16x32_bf16 v[92:95], v[44:47], a[200:203], v[92:95]
ds_read_b64_tr_b16 v[40:41], v15 offset:4096
v_mfma_f32_16x16x32_bf16 v[92:95], v[48:51], a[216:219], v[92:95]
buffer_load_dwordx4 v[232:235], v251, s[28:31], s72 offen offset:1024 sc1
v_mfma_f32_16x16x32_bf16 v[96:99], v[48:51], a[220:223], v[96:99]
ds_read_b64_tr_b16 v[42:43], v15 offset:6144
v_mfma_f32_16x16x32_bf16 v[96:99], v[44:47], a[204:207], v[96:99]
s_waitcnt lgkmcnt(4)
v_mfma_f32_16x16x32_bf16 v[112:115], v[28:31], a[204:207], v[112:115]
ds_read_b64_tr_b16 v[44:45], v15 offset:8192
v_mfma_f32_16x16x32_bf16 v[112:115], v[32:35], a[220:223], v[112:115]
buffer_load_dwordx4 v[236:239], v252, s[28:31], s72 offen offset:0 sc1
v_mfma_f32_16x16x32_bf16 v[108:111], v[32:35], a[216:219], v[108:111]
ds_read_b64_tr_b16 v[46:47], v15 offset:10240
v_mfma_f32_16x16x32_bf16 v[108:111], v[28:31], a[200:203], v[108:111]
v_mfma_f32_16x16x32_bf16 v[104:107], v[28:31], a[196:199], v[104:107]
ds_read_b64_tr_b16 v[48:49], v15 offset:12288
v_mfma_f32_16x16x32_bf16 v[104:107], v[32:35], a[212:215], v[104:107]
buffer_load_dwordx4 v[240:243], v252, s[28:31], s72 offen offset:1024 sc1
v_mfma_f32_16x16x32_bf16 v[100:103], v[32:35], a[208:211], v[100:103]
s_add_u32 m0, s34, 49152
ds_read_b64_tr_b16 v[50:51], v15 offset:14336
v_mfma_f32_16x16x32_bf16 v[100:103], v[28:31], a[192:195], v[100:103]
s_waitcnt lgkmcnt(4)
v_mfma_f32_16x16x32_bf16 v[116:119], v[36:39], a[192:195], v[116:119]
ds_read_b64_tr_b16 v[28:29], v16 offset:0
v_mfma_f32_16x16x32_bf16 v[116:119], v[40:43], a[208:211], v[116:119]
buffer_load_dwordx4 v3, s[16:19], s40 offen offset:0 sc1 lds
v_mfma_f32_16x16x32_bf16 v[120:123], v[40:43], a[212:215], v[120:123]
ds_read_b64_tr_b16 v[30:31], v16 offset:2048
v_mfma_f32_16x16x32_bf16 v[120:123], v[36:39], a[196:199], v[120:123]
v_mfma_f32_16x16x32_bf16 v[124:127], v[36:39], a[200:203], v[124:127]
ds_read_b64_tr_b16 v[32:33], v16 offset:4096
v_mfma_f32_16x16x32_bf16 v[124:127], v[40:43], a[216:219], v[124:127]
buffer_load_dwordx4 v4, s[16:19], s40 offen offset:1024 sc1 lds
v_mfma_f32_16x16x32_bf16 v[128:131], v[40:43], a[220:223], v[128:131]
ds_read_b64_tr_b16 v[34:35], v16 offset:6144
v_mfma_f32_16x16x32_bf16 v[128:131], v[36:39], a[204:207], v[128:131]
s_waitcnt lgkmcnt(4)
v_mfma_f32_16x16x32_bf16 v[144:147], v[44:47], a[204:207], v[144:147]
ds_read_b64_tr_b16 v[36:37], v16 offset:8192
v_mfma_f32_16x16x32_bf16 v[144:147], v[48:51], a[220:223], v[144:147]
buffer_load_dwordx4 v5, s[16:19], s40 offen offset:2048 sc1 lds
v_mfma_f32_16x16x32_bf16 v[140:143], v[48:51], a[216:219], v[140:143]
ds_read_b64_tr_b16 v[38:39], v16 offset:10240
v_mfma_f32_16x16x32_bf16 v[140:143], v[44:47], a[200:203], v[140:143]
v_mfma_f32_16x16x32_bf16 v[136:139], v[44:47], a[196:199], v[136:139]
ds_read_b64_tr_b16 v[40:41], v16 offset:12288
v_mfma_f32_16x16x32_bf16 v[136:139], v[48:51], a[212:215], v[136:139]
buffer_load_dwordx4 v6, s[16:19], s40 offen offset:3072 sc1 lds
v_mfma_f32_16x16x32_bf16 v[132:135], v[48:51], a[208:211], v[132:135]
s_add_u32 s40, s40, 663552
ds_read_b64_tr_b16 v[42:43], v16 offset:14336
v_mfma_f32_16x16x32_bf16 v[132:135], v[44:47], a[192:195], v[132:135]
s_waitcnt lgkmcnt(4)
s_barrier
v_mfma_f32_16x16x32_bf16 v[148:151], v[28:31], a[192:195], v[148:151]
s_cmp_ge_u32 s40, s71
s_cselect_b32 s37, 5308416, 0
ds_read_b64_tr_b16 v[44:45], v13 offset:16384
v_mfma_f32_16x16x32_bf16 v[148:151], v[32:35], a[208:211], v[148:151]
s_sub_u32 s40, s40, s37
v_mfma_f32_16x16x32_bf16 v[152:155], v[32:35], a[212:215], v[152:155]
ds_read_b64_tr_b16 v[46:47], v13 offset:18432
v_mfma_f32_16x16x32_bf16 v[152:155], v[28:31], a[196:199], v[152:155]
v_mfma_f32_16x16x32_bf16 v[156:159], v[28:31], a[200:203], v[156:159]
ds_read_b64_tr_b16 v[48:49], v13 offset:20480
v_mfma_f32_16x16x32_bf16 v[156:159], v[32:35], a[216:219], v[156:159]
v_mfma_f32_16x16x32_bf16 v[160:163], v[32:35], a[220:223], v[160:163]
ds_read_b64_tr_b16 v[50:51], v13 offset:22528
v_mfma_f32_16x16x32_bf16 v[160:163], v[28:31], a[204:207], v[160:163]
s_waitcnt lgkmcnt(4)
v_mfma_f32_16x16x32_bf16 v[176:179], v[36:39], a[204:207], v[176:179]
ds_read_b64_tr_b16 v[28:29], v13 offset:24576
v_mfma_f32_16x16x32_bf16 v[176:179], v[40:43], a[220:223], v[176:179]
v_mfma_f32_16x16x32_bf16 v[172:175], v[40:43], a[216:219], v[172:175]
ds_read_b64_tr_b16 v[30:31], v13 offset:26624
v_mfma_f32_16x16x32_bf16 v[172:175], v[36:39], a[200:203], v[172:175]
v_mfma_f32_16x16x32_bf16 v[168:171], v[36:39], a[196:199], v[168:171]
ds_read_b64_tr_b16 v[32:33], v13 offset:28672
v_mfma_f32_16x16x32_bf16 v[168:171], v[40:43], a[212:215], v[168:171]
v_mfma_f32_16x16x32_bf16 v[164:167], v[40:43], a[208:211], v[164:167]
ds_read_b64_tr_b16 v[34:35], v13 offset:30720
v_mfma_f32_16x16x32_bf16 v[164:167], v[36:39], a[192:195], v[164:167]
s_waitcnt vmcnt(12) lgkmcnt(4)
v_mfma_f32_16x16x32_bf16 v[52:55], v[44:47], a[224:227], v[52:55]
s_add_u32 m0, s34, 65536
ds_read_b64_tr_b16 v[36:37], v14 offset:16384
v_mfma_f32_16x16x32_bf16 v[52:55], v[48:51], a[240:243], v[52:55]
buffer_load_dwordx4 v3, s[16:19], s40 offen offset:0 sc1 lds
v_mfma_f32_16x16x32_bf16 v[56:59], v[48:51], a[244:247], v[56:59]
ds_read_b64_tr_b16 v[38:39], v14 offset:18432
v_mfma_f32_16x16x32_bf16 v[56:59], v[44:47], a[228:231], v[56:59]
v_mfma_f32_16x16x32_bf16 v[60:63], v[44:47], a[232:235], v[60:63]
ds_read_b64_tr_b16 v[40:41], v14 offset:20480
v_mfma_f32_16x16x32_bf16 v[60:63], v[48:51], a[248:251], v[60:63]
buffer_load_dwordx4 v4, s[16:19], s40 offen offset:1024 sc1 lds
v_mfma_f32_16x16x32_bf16 v[64:67], v[48:51], a[252:255], v[64:67]
ds_read_b64_tr_b16 v[42:43], v14 offset:22528
v_mfma_f32_16x16x32_bf16 v[64:67], v[44:47], a[236:239], v[64:67]
s_waitcnt lgkmcnt(4)
v_mfma_f32_16x16x32_bf16 v[80:83], v[28:31], a[236:239], v[80:83]
ds_read_b64_tr_b16 v[44:45], v14 offset:24576
v_mfma_f32_16x16x32_bf16 v[80:83], v[32:35], a[252:255], v[80:83]
buffer_load_dwordx4 v5, s[16:19], s40 offen offset:2048 sc1 lds
v_mfma_f32_16x16x32_bf16 v[76:79], v[32:35], a[248:251], v[76:79]
ds_read_b64_tr_b16 v[46:47], v14 offset:26624
v_mfma_f32_16x16x32_bf16 v[76:79], v[28:31], a[232:235], v[76:79]
v_mfma_f32_16x16x32_bf16 v[72:75], v[28:31], a[228:231], v[72:75]
ds_read_b64_tr_b16 v[48:49], v14 offset:28672
v_mfma_f32_16x16x32_bf16 v[72:75], v[32:35], a[244:247], v[72:75]
buffer_load_dwordx4 v6, s[16:19], s40 offen offset:3072 sc1 lds
v_mfma_f32_16x16x32_bf16 v[68:71], v[32:35], a[240:243], v[68:71]
s_add_u32 s40, s40, 663552
ds_read_b64_tr_b16 v[50:51], v14 offset:30720
v_mfma_f32_16x16x32_bf16 v[68:71], v[28:31], a[224:227], v[68:71]
s_waitcnt lgkmcnt(4)
s_cmp_ge_u32 s40, s71
s_cselect_b32 s37, 5308416, 0
v_mfma_f32_16x16x32_bf16 v[84:87], v[36:39], a[224:227], v[84:87]
s_sub_u32 s40, s40, s37
ds_read_b64_tr_b16 v[28:29], v15 offset:16384
s_add_u32 m0, s34, 81920
v_mfma_f32_16x16x32_bf16 v[84:87], v[40:43], a[240:243], v[84:87]
buffer_load_dwordx4 v3, s[16:19], s40 offen offset:0 sc1 lds
v_mfma_f32_16x16x32_bf16 v[88:91], v[40:43], a[244:247], v[88:91]
ds_read_b64_tr_b16 v[30:31], v15 offset:18432
v_mfma_f32_16x16x32_bf16 v[88:91], v[36:39], a[228:231], v[88:91]
v_mfma_f32_16x16x32_bf16 v[92:95], v[36:39], a[232:235], v[92:95]
ds_read_b64_tr_b16 v[32:33], v15 offset:20480
v_mfma_f32_16x16x32_bf16 v[92:95], v[40:43], a[248:251], v[92:95]
buffer_load_dwordx4 v4, s[16:19], s40 offen offset:1024 sc1 lds
v_mfma_f32_16x16x32_bf16 v[96:99], v[40:43], a[252:255], v[96:99]
ds_read_b64_tr_b16 v[34:35], v15 offset:22528
v_mfma_f32_16x16x32_bf16 v[96:99], v[36:39], a[236:239], v[96:99]
s_waitcnt lgkmcnt(4)
v_mfma_f32_16x16x32_bf16 v[112:115], v[44:47], a[236:239], v[112:115]
ds_read_b64_tr_b16 v[36:37], v15 offset:24576
v_mfma_f32_16x16x32_bf16 v[112:115], v[48:51], a[252:255], v[112:115]
buffer_load_dwordx4 v5, s[16:19], s40 offen offset:2048 sc1 lds
v_mfma_f32_16x16x32_bf16 v[108:111], v[48:51], a[248:251], v[108:111]
ds_read_b64_tr_b16 v[38:39], v15 offset:26624
v_mfma_f32_16x16x32_bf16 v[108:111], v[44:47], a[232:235], v[108:111]
v_mfma_f32_16x16x32_bf16 v[104:107], v[44:47], a[228:231], v[104:107]
ds_read_b64_tr_b16 v[40:41], v15 offset:28672
v_mfma_f32_16x16x32_bf16 v[104:107], v[48:51], a[244:247], v[104:107]
buffer_load_dwordx4 v6, s[16:19], s40 offen offset:3072 sc1 lds
v_mfma_f32_16x16x32_bf16 v[100:103], v[48:51], a[240:243], v[100:103]
s_add_u32 s40, s40, 663552
ds_read_b64_tr_b16 v[42:43], v15 offset:30720
v_mfma_f32_16x16x32_bf16 v[100:103], v[44:47], a[224:227], v[100:103]
s_waitcnt lgkmcnt(4)
s_cmp_ge_u32 s40, s71
s_cselect_b32 s37, 5308416, 0
v_mfma_f32_16x16x32_bf16 v[116:119], v[28:31], a[224:227], v[116:119]
s_sub_u32 s40, s40, s37
ds_read_b64_tr_b16 v[44:45], v16 offset:16384
v_mfma_f32_16x16x32_bf16 v[116:119], v[32:35], a[240:243], v[116:119]
v_mfma_f32_16x16x32_bf16 v[120:123], v[32:35], a[244:247], v[120:123]
ds_read_b64_tr_b16 v[46:47], v16 offset:18432
v_mfma_f32_16x16x32_bf16 v[120:123], v[28:31], a[228:231], v[120:123]
v_mfma_f32_16x16x32_bf16 v[124:127], v[28:31], a[232:235], v[124:127]
ds_read_b64_tr_b16 v[48:49], v16 offset:20480
v_mfma_f32_16x16x32_bf16 v[124:127], v[32:35], a[248:251], v[124:127]
v_mfma_f32_16x16x32_bf16 v[128:131], v[32:35], a[252:255], v[128:131]
ds_read_b64_tr_b16 v[50:51], v16 offset:22528
v_mfma_f32_16x16x32_bf16 v[128:131], v[28:31], a[236:239], v[128:131]
s_waitcnt lgkmcnt(4)
v_mfma_f32_16x16x32_bf16 v[144:147], v[36:39], a[236:239], v[144:147]
s_waitcnt vmcnt(12)
ds_read_b64_tr_b16 v[28:29], v16 offset:24576
v_mfma_f32_16x16x32_bf16 v[144:147], v[40:43], a[252:255], v[144:147]
v_swap_b32 v214, v216
v_mfma_f32_16x16x32_bf16 v[140:143], v[40:43], a[248:251], v[140:143]
ds_read_b64_tr_b16 v[30:31], v16 offset:26624
v_mfma_f32_16x16x32_bf16 v[140:143], v[36:39], a[232:235], v[140:143]
v_swap_b32 v215, v217
v_mfma_f32_16x16x32_bf16 v[136:139], v[36:39], a[228:231], v[136:139]
ds_read_b64_tr_b16 v[32:33], v16 offset:28672
v_mfma_f32_16x16x32_bf16 v[136:139], v[40:43], a[244:247], v[136:139]
v_swap_b32 v222, v224
v_mfma_f32_16x16x32_bf16 v[132:135], v[40:43], a[240:243], v[132:135]
ds_read_b64_tr_b16 v[34:35], v16 offset:30720
v_mfma_f32_16x16x32_bf16 v[132:135], v[36:39], a[224:227], v[132:135]
s_waitcnt lgkmcnt(4)
s_barrier
v_mfma_f32_16x16x32_bf16 v[148:151], v[44:47], a[224:227], v[148:151]
ds_read_b64_tr_b16 v[36:37], v13 offset:32768
v_mfma_f32_16x16x32_bf16 v[148:151], v[48:51], a[240:243], v[148:151]
v_swap_b32 v223, v225
v_mfma_f32_16x16x32_bf16 v[152:155], v[48:51], a[244:247], v[152:155]
ds_read_b64_tr_b16 v[38:39], v13 offset:34816
v_mfma_f32_16x16x32_bf16 v[152:155], v[44:47], a[228:231], v[152:155]
v_swap_b32 v230, v232
v_mfma_f32_16x16x32_bf16 v[156:159], v[44:47], a[232:235], v[156:159]
ds_read_b64_tr_b16 v[40:41], v13 offset:36864
v_mfma_f32_16x16x32_bf16 v[156:159], v[48:51], a[248:251], v[156:159]
v_swap_b32 v231, v233
v_mfma_f32_16x16x32_bf16 v[160:163], v[48:51], a[252:255], v[160:163]
ds_read_b64_tr_b16 v[42:43], v13 offset:38912
v_mfma_f32_16x16x32_bf16 v[160:163], v[44:47], a[236:239], v[160:163]
s_waitcnt lgkmcnt(4)
v_swap_b32 v238, v240
v_mfma_f32_16x16x32_bf16 v[176:179], v[28:31], a[236:239], v[176:179]
ds_read_b64_tr_b16 v[44:45], v13 offset:40960
v_mfma_f32_16x16x32_bf16 v[176:179], v[32:35], a[252:255], v[176:179]
v_swap_b32 v239, v241
v_mfma_f32_16x16x32_bf16 v[172:175], v[32:35], a[248:251], v[172:175]
ds_read_b64_tr_b16 v[46:47], v13 offset:43008
v_mfma_f32_16x16x32_bf16 v[172:175], v[28:31], a[232:235], v[172:175]
v_mfma_f32_16x16x32_bf16 v[168:171], v[28:31], a[228:231], v[168:171]
ds_read_b64_tr_b16 v[48:49], v13 offset:45056
v_mfma_f32_16x16x32_bf16 v[168:171], v[32:35], a[244:247], v[168:171]
v_mfma_f32_16x16x32_bf16 v[164:167], v[32:35], a[240:243], v[164:167]
ds_read_b64_tr_b16 v[50:51], v13 offset:47104
v_mfma_f32_16x16x32_bf16 v[164:167], v[28:31], a[224:227], v[164:167]
s_waitcnt lgkmcnt(4)
v_mfma_f32_16x16x32_bf16 v[52:55], v[36:39], v[212:215], v[52:55]
s_add_u32 m0, s34, 0
ds_read_b64_tr_b16 v[28:29], v14 offset:32768
v_mfma_f32_16x16x32_bf16 v[52:55], v[40:43], v[228:231], v[52:55]
buffer_load_dwordx4 v3, s[16:19], s40 offen offset:0 sc1 lds
v_mfma_f32_16x16x32_bf16 v[56:59], v[40:43], v[232:235], v[56:59]
ds_read_b64_tr_b16 v[30:31], v14 offset:34816
v_mfma_f32_16x16x32_bf16 v[56:59], v[36:39], v[216:219], v[56:59]
v_mfma_f32_16x16x32_bf16 v[60:63], v[36:39], v[220:223], v[60:63]
ds_read_b64_tr_b16 v[32:33], v14 offset:36864
v_mfma_f32_16x16x32_bf16 v[60:63], v[40:43], v[236:239], v[60:63]
buffer_load_dwordx4 v4, s[16:19], s40 offen offset:1024 sc1 lds
v_mfma_f32_16x16x32_bf16 v[64:67], v[40:43], v[240:243], v[64:67]
ds_read_b64_tr_b16 v[34:35], v14 offset:38912
v_mfma_f32_16x16x32_bf16 v[64:67], v[36:39], v[224:227], v[64:67]
s_waitcnt lgkmcnt(4)
v_mfma_f32_16x16x32_bf16 v[68:71], v[44:47], v[212:215], v[68:71]
ds_read_b64_tr_b16 v[36:37], v14 offset:40960
v_mfma_f32_16x16x32_bf16 v[68:71], v[48:51], v[228:231], v[68:71]
buffer_load_dwordx4 v5, s[16:19], s40 offen offset:2048 sc1 lds
v_mfma_f32_16x16x32_bf16 v[72:75], v[48:51], v[232:235], v[72:75]
ds_read_b64_tr_b16 v[38:39], v14 offset:43008
v_mfma_f32_16x16x32_bf16 v[72:75], v[44:47], v[216:219], v[72:75]
v_mfma_f32_16x16x32_bf16 v[76:79], v[44:47], v[220:223], v[76:79]
ds_read_b64_tr_b16 v[40:41], v14 offset:45056
v_mfma_f32_16x16x32_bf16 v[76:79], v[48:51], v[236:239], v[76:79]
buffer_load_dwordx4 v6, s[16:19], s40 offen offset:3072 sc1 lds
v_mfma_f32_16x16x32_bf16 v[80:83], v[48:51], v[240:243], v[80:83]
s_add_u32 s40, s40, 663552
ds_read_b64_tr_b16 v[42:43], v14 offset:47104
v_mfma_f32_16x16x32_bf16 v[80:83], v[44:47], v[224:227], v[80:83]
s_waitcnt lgkmcnt(4)
s_cmp_ge_u32 s40, s71
s_cselect_b32 s37, 5308416, 0
v_mfma_f32_16x16x32_bf16 v[84:87], v[28:31], v[212:215], v[84:87]
s_sub_u32 s40, s40, s37
ds_read_b64_tr_b16 v[44:45], v15 offset:32768
v_mul_f32 v52, v52, v68
v_mfma_f32_16x16x32_bf16 v[84:87], v[32:35], v[228:231], v[84:87]
v_mul_f32 v53, v53, v69
v_mul_f32 v54, v54, v70
v_mfma_f32_16x16x32_bf16 v[88:91], v[32:35], v[232:235], v[88:91]
ds_read_b64_tr_b16 v[46:47], v15 offset:34816
v_mul_f32 v55, v55, v71
v_mfma_f32_16x16x32_bf16 v[88:91], v[28:31], v[216:219], v[88:91]
v_cvt_pk_bf16_f32 v180, v52, v53
v_cvt_pk_bf16_f32 v181, v54, v55
v_mfma_f32_16x16x32_bf16 v[92:95], v[28:31], v[220:223], v[92:95]
ds_read_b64_tr_b16 v[48:49], v15 offset:36864
v_mul_f32 v56, v56, v72
v_mfma_f32_16x16x32_bf16 v[92:95], v[32:35], v[236:239], v[92:95]
v_mul_f32 v57, v57, v73
v_mul_f32 v58, v58, v74
v_mfma_f32_16x16x32_bf16 v[96:99], v[32:35], v[240:243], v[96:99]
ds_read_b64_tr_b16 v[50:51], v15 offset:38912
v_mul_f32 v59, v59, v75
v_mfma_f32_16x16x32_bf16 v[96:99], v[28:31], v[224:227], v[96:99]
s_waitcnt lgkmcnt(4)
v_cvt_pk_bf16_f32 v184, v56, v57
v_cvt_pk_bf16_f32 v185, v58, v59
v_mfma_f32_16x16x32_bf16 v[100:103], v[36:39], v[212:215], v[100:103]
ds_read_b64_tr_b16 v[28:29], v15 offset:40960
v_mul_f32 v60, v60, v76
v_mfma_f32_16x16x32_bf16 v[100:103], v[40:43], v[228:231], v[100:103]
v_mul_f32 v61, v61, v77
v_mul_f32 v62, v62, v78
v_mfma_f32_16x16x32_bf16 v[104:107], v[40:43], v[232:235], v[104:107]
ds_read_b64_tr_b16 v[30:31], v15 offset:43008
v_mul_f32 v63, v63, v79
v_mfma_f32_16x16x32_bf16 v[104:107], v[36:39], v[216:219], v[104:107]
v_cvt_pk_bf16_f32 v188, v60, v61
v_cvt_pk_bf16_f32 v189, v62, v63
v_mfma_f32_16x16x32_bf16 v[108:111], v[36:39], v[220:223], v[108:111]
ds_read_b64_tr_b16 v[32:33], v15 offset:45056
v_mul_f32 v64, v64, v80
v_mfma_f32_16x16x32_bf16 v[108:111], v[40:43], v[236:239], v[108:111]
v_mul_f32 v65, v65, v81
v_mul_f32 v66, v66, v82
v_mfma_f32_16x16x32_bf16 v[112:115], v[40:43], v[240:243], v[112:115]
ds_read_b64_tr_b16 v[34:35], v15 offset:47104
v_mul_f32 v67, v67, v83
v_mfma_f32_16x16x32_bf16 v[112:115], v[36:39], v[224:227], v[112:115]
s_waitcnt lgkmcnt(4)
v_cvt_pk_bf16_f32 v192, v64, v65
v_cvt_pk_bf16_f32 v193, v66, v67
v_mfma_f32_16x16x32_bf16 v[116:119], v[44:47], v[212:215], v[116:119]
ds_read_b64_tr_b16 v[36:37], v16 offset:32768
v_mul_f32 v84, v84, v100
v_mfma_f32_16x16x32_bf16 v[116:119], v[48:51], v[228:231], v[116:119]
v_mul_f32 v85, v85, v101
v_mul_f32 v86, v86, v102
v_mfma_f32_16x16x32_bf16 v[120:123], v[48:51], v[232:235], v[120:123]
ds_read_b64_tr_b16 v[38:39], v16 offset:34816
v_mul_f32 v87, v87, v103
v_mfma_f32_16x16x32_bf16 v[120:123], v[44:47], v[216:219], v[120:123]
v_cvt_pk_bf16_f32 v182, v84, v85
v_cvt_pk_bf16_f32 v183, v86, v87
v_mfma_f32_16x16x32_bf16 v[124:127], v[44:47], v[220:223], v[124:127]
ds_read_b64_tr_b16 v[40:41], v16 offset:36864
v_mul_f32 v88, v88, v104
v_mfma_f32_16x16x32_bf16 v[124:127], v[48:51], v[236:239], v[124:127]
buffer_store_dwordx4 v[180:183], v1, s[28:31], s45 offen offset:0 sc1
v_mul_f32 v89, v89, v105
v_mfma_f32_16x16x32_bf16 v[128:131], v[48:51], v[240:243], v[128:131]
ds_read_b64_tr_b16 v[42:43], v16 offset:38912
v_mul_f32 v90, v90, v106
v_mfma_f32_16x16x32_bf16 v[128:131], v[44:47], v[224:227], v[128:131]
s_waitcnt lgkmcnt(4)
v_mul_f32 v91, v91, v107
v_cvt_pk_bf16_f32 v186, v88, v89
v_mfma_f32_16x16x32_bf16 v[132:135], v[28:31], v[212:215], v[132:135]
ds_read_b64_tr_b16 v[44:45], v16 offset:40960
v_cvt_pk_bf16_f32 v187, v90, v91
v_mfma_f32_16x16x32_bf16 v[132:135], v[32:35], v[228:231], v[132:135]
v_mul_f32 v92, v92, v108
v_mul_f32 v93, v93, v109
v_mfma_f32_16x16x32_bf16 v[136:139], v[32:35], v[232:235], v[136:139]
ds_read_b64_tr_b16 v[46:47], v16 offset:43008
v_mul_f32 v94, v94, v110
v_mfma_f32_16x16x32_bf16 v[136:139], v[28:31], v[216:219], v[136:139]
v_mul_f32 v95, v95, v111
v_cvt_pk_bf16_f32 v190, v92, v93
v_mfma_f32_16x16x32_bf16 v[140:143], v[28:31], v[220:223], v[140:143]
ds_read_b64_tr_b16 v[48:49], v16 offset:45056
v_cvt_pk_bf16_f32 v191, v94, v95
v_mfma_f32_16x16x32_bf16 v[140:143], v[32:35], v[236:239], v[140:143]
v_mul_f32 v96, v96, v112
v_mul_f32 v97, v97, v113
v_mfma_f32_16x16x32_bf16 v[144:147], v[32:35], v[240:243], v[144:147]
ds_read_b64_tr_b16 v[50:51], v16 offset:47104
v_mul_f32 v98, v98, v114
v_mfma_f32_16x16x32_bf16 v[144:147], v[28:31], v[224:227], v[144:147]
s_waitcnt vmcnt(13) lgkmcnt(4)
v_mul_f32 v99, v99, v115
s_barrier
v_mfma_f32_16x16x32_bf16 v[148:151], v[36:39], v[212:215], v[148:151]
ds_read_b64_tr_b16 v[28:29], v13 offset:49152
v_cvt_pk_bf16_f32 v194, v96, v97
v_mfma_f32_16x16x32_bf16 v[148:151], v[40:43], v[228:231], v[148:151]
v_cvt_pk_bf16_f32 v195, v98, v99
v_mul_f32 v116, v116, v132
v_mfma_f32_16x16x32_bf16 v[152:155], v[40:43], v[232:235], v[152:155]
ds_read_b64_tr_b16 v[30:31], v13 offset:51200
v_mul_f32 v117, v117, v133
v_mfma_f32_16x16x32_bf16 v[152:155], v[36:39], v[216:219], v[152:155]
v_mul_f32 v118, v118, v134
v_mul_f32 v119, v119, v135
v_mfma_f32_16x16x32_bf16 v[156:159], v[36:39], v[220:223], v[156:159]
ds_read_b64_tr_b16 v[32:33], v13 offset:53248
v_cvt_pk_bf16_f32 v196, v116, v117
v_mfma_f32_16x16x32_bf16 v[156:159], v[40:43], v[236:239], v[156:159]
buffer_store_dwordx4 v[184:187], v1, s[28:31], s45 offen offset:1024 sc1
v_cvt_pk_bf16_f32 v197, v118, v119
v_mfma_f32_16x16x32_bf16 v[160:163], v[40:43], v[240:243], v[160:163]
ds_read_b64_tr_b16 v[34:35], v13 offset:55296
v_mul_f32 v120, v120, v136
v_mfma_f32_16x16x32_bf16 v[160:163], v[36:39], v[224:227], v[160:163]
s_waitcnt lgkmcnt(4)
v_mul_f32 v121, v121, v137
v_mul_f32 v122, v122, v138
v_mfma_f32_16x16x32_bf16 v[164:167], v[44:47], v[212:215], v[164:167]
ds_read_b64_tr_b16 v[36:37], v13 offset:57344
v_mul_f32 v123, v123, v139
v_mfma_f32_16x16x32_bf16 v[164:167], v[48:51], v[228:231], v[164:167]
v_cvt_pk_bf16_f32 v200, v120, v121
v_cvt_pk_bf16_f32 v201, v122, v123
v_mfma_f32_16x16x32_bf16 v[168:171], v[48:51], v[232:235], v[168:171]
ds_read_b64_tr_b16 v[38:39], v13 offset:59392
v_mul_f32 v124, v124, v140
v_mfma_f32_16x16x32_bf16 v[168:171], v[44:47], v[216:219], v[168:171]
v_mul_f32 v125, v125, v141
v_mul_f32 v126, v126, v142
v_mfma_f32_16x16x32_bf16 v[172:175], v[44:47], v[220:223], v[172:175]
ds_read_b64_tr_b16 v[40:41], v13 offset:61440
v_mul_f32 v127, v127, v143
v_mfma_f32_16x16x32_bf16 v[172:175], v[48:51], v[236:239], v[172:175]
v_cvt_pk_bf16_f32 v204, v124, v125
v_cvt_pk_bf16_f32 v205, v126, v127
v_mfma_f32_16x16x32_bf16 v[176:179], v[48:51], v[240:243], v[176:179]
ds_read_b64_tr_b16 v[42:43], v13 offset:63488
v_mul_f32 v128, v128, v144
v_mfma_f32_16x16x32_bf16 v[176:179], v[44:47], v[224:227], v[176:179]
s_waitcnt lgkmcnt(4)
v_mul_f32 v129, v129, v145
v_mul_f32 v130, v130, v146
v_mfma_f32_16x16x32_bf16 v[52:55], v[28:31], a[0:3], 0
s_add_u32 m0, s34, 16384
ds_read_b64_tr_b16 v[44:45], v14 offset:49152
v_mul_f32 v131, v131, v147
v_mfma_f32_16x16x32_bf16 v[52:55], v[32:35], a[16:19], v[52:55]
buffer_load_dwordx4 v3, s[16:19], s40 offen offset:0 sc1 lds
v_mfma_f32_16x16x32_bf16 v[56:59], v[32:35], a[20:23], 0
ds_read_b64_tr_b16 v[46:47], v14 offset:51200
v_cvt_pk_bf16_f32 v208, v128, v129
v_mfma_f32_16x16x32_bf16 v[56:59], v[28:31], a[4:7], v[56:59]
v_cvt_pk_bf16_f32 v209, v130, v131
v_mul_f32 v148, v148, v164
v_mfma_f32_16x16x32_bf16 v[60:63], v[28:31], a[8:11], 0
ds_read_b64_tr_b16 v[48:49], v14 offset:53248
v_mul_f32 v149, v149, v165
v_mfma_f32_16x16x32_bf16 v[60:63], v[32:35], a[24:27], v[60:63]
buffer_store_dwordx4 v[188:191], v1, s[28:31], s45 offen offset:2048 sc1
v_mul_f32 v150, v150, v166
v_mfma_f32_16x16x32_bf16 v[64:67], v[32:35], a[28:31], 0
ds_read_b64_tr_b16 v[50:51], v14 offset:55296
v_mul_f32 v151, v151, v167
v_mfma_f32_16x16x32_bf16 v[64:67], v[28:31], a[12:15], v[64:67]
s_waitcnt lgkmcnt(4)
v_cvt_pk_bf16_f32 v198, v148, v149
v_cvt_pk_bf16_f32 v199, v150, v151
v_mfma_f32_16x16x32_bf16 v[80:83], v[36:39], a[12:15], 0
ds_read_b64_tr_b16 v[28:29], v14 offset:57344
v_mul_f32 v152, v152, v168
v_mfma_f32_16x16x32_bf16 v[80:83], v[40:43], a[28:31], v[80:83]
buffer_load_dwordx4 v4, s[16:19], s40 offen offset:1024 sc1 lds
v_mfma_f32_16x16x32_bf16 v[76:79], v[40:43], a[24:27], 0
ds_read_b64_tr_b16 v[30:31], v14 offset:59392
v_mul_f32 v153, v153, v169
v_mfma_f32_16x16x32_bf16 v[76:79], v[36:39], a[8:11], v[76:79]
v_mul_f32 v154, v154, v170
v_mul_f32 v155, v155, v171
v_mfma_f32_16x16x32_bf16 v[72:75], v[36:39], a[4:7], 0
ds_read_b64_tr_b16 v[32:33], v14 offset:61440
v_cvt_pk_bf16_f32 v202, v152, v153
v_mfma_f32_16x16x32_bf16 v[72:75], v[40:43], a[20:23], v[72:75]
buffer_load_dwordx4 v5, s[16:19], s40 offen offset:2048 sc1 lds
v_mfma_f32_16x16x32_bf16 v[68:71], v[40:43], a[16:19], 0
ds_read_b64_tr_b16 v[34:35], v14 offset:63488
v_cvt_pk_bf16_f32 v203, v154, v155
v_mfma_f32_16x16x32_bf16 v[68:71], v[36:39], a[0:3], v[68:71]
s_waitcnt lgkmcnt(4)
v_mul_f32 v156, v156, v172
v_mul_f32 v157, v157, v173
v_mfma_f32_16x16x32_bf16 v[84:87], v[44:47], a[0:3], 0
ds_read_b64_tr_b16 v[36:37], v15 offset:49152
v_mul_f32 v158, v158, v174
v_mfma_f32_16x16x32_bf16 v[84:87], v[48:51], a[16:19], v[84:87]
s_branch iskip7
.p2align 12
ipad7:
s_branch ipad11
iskip7:
buffer_load_dwordx4 v6, s[16:19], s40 offen offset:3072 sc1 lds
v_mfma_f32_16x16x32_bf16 v[88:91], v[48:51], a[20:23], 0
s_add_u32 s40, s40, 663552
ds_read_b64_tr_b16 v[38:39], v15 offset:51200
v_mul_f32 v159, v159, v175
v_mfma_f32_16x16x32_bf16 v[88:91], v[44:47], a[4:7], v[88:91]
s_cmp_ge_u32 s40, s71
s_cselect_b32 s37, 5308416, 0
v_cvt_pk_bf16_f32 v206, v156, v157
v_mfma_f32_16x16x32_bf16 v[92:95], v[44:47], a[8:11], 0
s_sub_u32 s40, s40, s37
ds_read_b64_tr_b16 v[40:41], v15 offset:53248
v_cvt_pk_bf16_f32 v207, v158, v159
v_mfma_f32_16x16x32_bf16 v[92:95], v[48:51], a[24:27], v[92:95]
buffer_store_dwordx4 v[192:195], v1, s[28:31], s45 offen offset:3072 sc1
v_mul_f32 v160, v160, v176
v_mfma_f32_16x16x32_bf16 v[96:99], v[48:51], a[28:31], 0
s_add_u32 s45, s45, 4096
ds_read_b64_tr_b16 v[42:43], v15 offset:55296
v_mul_f32 v161, v161, v177
v_mfma_f32_16x16x32_bf16 v[96:99], v[44:47], a[12:15], v[96:99]
s_waitcnt lgkmcnt(4)
v_mul_f32 v162, v162, v178
v_mul_f32 v163, v163, v179
v_mfma_f32_16x16x32_bf16 v[112:115], v[28:31], a[12:15], 0
ds_read_b64_tr_b16 v[44:45], v15 offset:57344
v_cvt_pk_bf16_f32 v210, v160, v161
v_mfma_f32_16x16x32_bf16 v[112:115], v[32:35], a[28:31], v[112:115]
v_cvt_pk_bf16_f32 v211, v162, v163
v_mfma_f32_16x16x32_bf16 v[108:111], v[32:35], a[24:27], 0
ds_read_b64_tr_b16 v[46:47], v15 offset:59392
v_mfma_f32_16x16x32_bf16 v[108:111], v[28:31], a[8:11], v[108:111]
v_mfma_f32_16x16x32_bf16 v[104:107], v[28:31], a[4:7], 0
ds_read_b64_tr_b16 v[48:49], v15 offset:61440
v_mfma_f32_16x16x32_bf16 v[104:107], v[32:35], a[20:23], v[104:107]
v_mfma_f32_16x16x32_bf16 v[100:103], v[32:35], a[16:19], 0
ds_read_b64_tr_b16 v[50:51], v15 offset:63488
v_mfma_f32_16x16x32_bf16 v[100:103], v[28:31], a[0:3], v[100:103]
s_waitcnt lgkmcnt(4)
v_mfma_f32_16x16x32_bf16 v[116:119], v[36:39], a[0:3], 0
ds_read_b64_tr_b16 v[28:29], v16 offset:49152
v_mfma_f32_16x16x32_bf16 v[116:119], v[40:43], a[16:19], v[116:119]
v_mfma_f32_16x16x32_bf16 v[120:123], v[40:43], a[20:23], 0
ds_read_b64_tr_b16 v[30:31], v16 offset:51200
v_mfma_f32_16x16x32_bf16 v[120:123], v[36:39], a[4:7], v[120:123]
v_mfma_f32_16x16x32_bf16 v[124:127], v[36:39], a[8:11], 0
ds_read_b64_tr_b16 v[32:33], v16 offset:53248
v_mfma_f32_16x16x32_bf16 v[124:127], v[40:43], a[24:27], v[124:127]
buffer_store_dwordx4 v[196:199], v1, s[28:31], s45 offen offset:0 sc1
v_mfma_f32_16x16x32_bf16 v[128:131], v[40:43], a[28:31], 0
ds_read_b64_tr_b16 v[34:35], v16 offset:55296
v_mfma_f32_16x16x32_bf16 v[128:131], v[36:39], a[12:15], v[128:131]
s_waitcnt lgkmcnt(4)
v_mfma_f32_16x16x32_bf16 v[144:147], v[44:47], a[12:15], 0
ds_read_b64_tr_b16 v[36:37], v16 offset:57344
v_mfma_f32_16x16x32_bf16 v[144:147], v[48:51], a[28:31], v[144:147]
v_mfma_f32_16x16x32_bf16 v[140:143], v[48:51], a[24:27], 0
ds_read_b64_tr_b16 v[38:39], v16 offset:59392
v_mfma_f32_16x16x32_bf16 v[140:143], v[44:47], a[8:11], v[140:143]
v_mfma_f32_16x16x32_bf16 v[136:139], v[44:47], a[4:7], 0
ds_read_b64_tr_b16 v[40:41], v16 offset:61440
v_mfma_f32_16x16x32_bf16 v[136:139], v[48:51], a[20:23], v[136:139]
v_mfma_f32_16x16x32_bf16 v[132:135], v[48:51], a[16:19], 0
ds_read_b64_tr_b16 v[42:43], v16 offset:63488
v_mfma_f32_16x16x32_bf16 v[132:135], v[44:47], a[0:3], v[132:135]
s_waitcnt vmcnt(17) lgkmcnt(4)
s_barrier
v_mfma_f32_16x16x32_bf16 v[148:151], v[28:31], a[0:3], 0
ds_read_b64_tr_b16 v[44:45], v17 offset:0
v_mfma_f32_16x16x32_bf16 v[148:151], v[32:35], a[16:19], v[148:151]
v_mfma_f32_16x16x32_bf16 v[152:155], v[32:35], a[20:23], 0
ds_read_b64_tr_b16 v[46:47], v17 offset:2048
v_mfma_f32_16x16x32_bf16 v[152:155], v[28:31], a[4:7], v[152:155]
v_mfma_f32_16x16x32_bf16 v[156:159], v[28:31], a[8:11], 0
ds_read_b64_tr_b16 v[48:49], v17 offset:4096
v_mfma_f32_16x16x32_bf16 v[156:159], v[32:35], a[24:27], v[156:159]
buffer_store_dwordx4 v[200:203], v1, s[28:31], s45 offen offset:1024 sc1
v_mfma_f32_16x16x32_bf16 v[160:163], v[32:35], a[28:31], 0
ds_read_b64_tr_b16 v[50:51], v17 offset:6144
v_mfma_f32_16x16x32_bf16 v[160:163], v[28:31], a[12:15], v[160:163]
s_waitcnt lgkmcnt(4)
v_mfma_f32_16x16x32_bf16 v[176:179], v[36:39], a[12:15], 0
ds_read_b64_tr_b16 v[28:29], v17 offset:8192
v_mfma_f32_16x16x32_bf16 v[176:179], v[40:43], a[28:31], v[176:179]
v_mfma_f32_16x16x32_bf16 v[172:175], v[40:43], a[24:27], 0
ds_read_b64_tr_b16 v[30:31], v17 offset:10240
v_mfma_f32_16x16x32_bf16 v[172:175], v[36:39], a[8:11], v[172:175]
v_mfma_f32_16x16x32_bf16 v[168:171], v[36:39], a[4:7], 0
ds_read_b64_tr_b16 v[32:33], v17 offset:12288
v_mfma_f32_16x16x32_bf16 v[168:171], v[40:43], a[20:23], v[168:171]
v_mfma_f32_16x16x32_bf16 v[164:167], v[40:43], a[16:19], 0
ds_read_b64_tr_b16 v[34:35], v17 offset:14336
v_mfma_f32_16x16x32_bf16 v[164:167], v[36:39], a[0:3], v[164:167]
s_waitcnt lgkmcnt(4)
v_mfma_f32_16x16x32_bf16 v[52:55], v[44:47], a[32:35], v[52:55]
ds_read_b64_tr_b16 v[36:37], v18 offset:0
v_mfma_f32_16x16x32_bf16 v[52:55], v[48:51], a[48:51], v[52:55]
buffer_load_dword v23, v12, s[28:31], s98 offen offset:1024 sc1
v_mfma_f32_16x16x32_bf16 v[56:59], v[48:51], a[52:55], v[56:59]
s_add_u32 m0, s34, 32768
ds_read_b64_tr_b16 v[38:39], v18 offset:2048
v_mfma_f32_16x16x32_bf16 v[56:59], v[44:47], a[36:39], v[56:59]
v_mfma_f32_16x16x32_bf16 v[60:63], v[44:47], a[40:43], v[60:63]
ds_read_b64_tr_b16 v[40:41], v18 offset:4096
v_mfma_f32_16x16x32_bf16 v[60:63], v[48:51], a[56:59], v[60:63]
buffer_store_dwordx4 v[204:207], v1, s[28:31], s45 offen offset:2048 sc1
v_mfma_f32_16x16x32_bf16 v[64:67], v[48:51], a[60:63], v[64:67]
ds_read_b64_tr_b16 v[42:43], v18 offset:6144
v_mfma_f32_16x16x32_bf16 v[64:67], v[44:47], a[44:47], v[64:67]
s_waitcnt lgkmcnt(4)
v_mfma_f32_16x16x32_bf16 v[80:83], v[28:31], a[44:47], v[80:83]
ds_read_b64_tr_b16 v[44:45], v18 offset:8192
v_mfma_f32_16x16x32_bf16 v[80:83], v[32:35], a[60:63], v[80:83]
buffer_load_dwordx4 v3, s[16:19], s40 offen offset:0 sc1 lds
v_mfma_f32_16x16x32_bf16 v[76:79], v[32:35], a[56:59], v[76:79]
ds_read_b64_tr_b16 v[46:47], v18 offset:10240
v_mfma_f32_16x16x32_bf16 v[76:79], v[28:31], a[40:43], v[76:79]
v_mfma_f32_16x16x32_bf16 v[72:75], v[28:31], a[36:39], v[72:75]
ds_read_b64_tr_b16 v[48:49], v18 offset:12288
v_mfma_f32_16x16x32_bf16 v[72:75], v[32:35], a[52:55], v[72:75]
buffer_load_dwordx4 v4, s[16:19], s40 offen offset:1024 sc1 lds
v_mfma_f32_16x16x32_bf16 v[68:71], v[32:35], a[48:51], v[68:71]
ds_read_b64_tr_b16 v[50:51], v18 offset:14336
v_mfma_f32_16x16x32_bf16 v[68:71], v[28:31], a[32:35], v[68:71]
s_waitcnt lgkmcnt(4)
v_mfma_f32_16x16x32_bf16 v[84:87], v[36:39], a[32:35], v[84:87]
ds_read_b64_tr_b16 v[28:29], v19 offset:0
v_mfma_f32_16x16x32_bf16 v[84:87], v[40:43], a[48:51], v[84:87]
buffer_load_dwordx4 v5, s[16:19], s40 offen offset:2048 sc1 lds
v_mfma_f32_16x16x32_bf16 v[88:91], v[40:43], a[52:55], v[88:91]
ds_read_b64_tr_b16 v[30:31], v19 offset:2048
v_mfma_f32_16x16x32_bf16 v[88:91], v[36:39], a[36:39], v[88:91]
v_mfma_f32_16x16x32_bf16 v[92:95], v[36:39], a[40:43], v[92:95]
ds_read_b64_tr_b16 v[32:33], v19 offset:4096
v_mfma_f32_16x16x32_bf16 v[92:95], v[40:43], a[56:59], v[92:95]
buffer_store_dwordx4 v[208:211], v1, s[28:31], s45 offen offset:3072 sc1
v_mfma_f32_16x16x32_bf16 v[96:99], v[40:43], a[60:63], v[96:99]
s_add_u32 s45, s45, 28672
ds_read_b64_tr_b16 v[34:35], v19 offset:6144
v_mfma_f32_16x16x32_bf16 v[96:99], v[36:39], a[44:47], v[96:99]
s_waitcnt lgkmcnt(4)
v_mfma_f32_16x16x32_bf16 v[112:115], v[44:47], a[44:47], v[112:115]
ds_read_b64_tr_b16 v[36:37], v19 offset:8192
v_mfma_f32_16x16x32_bf16 v[112:115], v[48:51], a[60:63], v[112:115]
buffer_load_dwordx4 v6, s[16:19], s40 offen offset:3072 sc1 lds
v_mfma_f32_16x16x32_bf16 v[108:111], v[48:51], a[56:59], v[108:111]
s_add_u32 s40, s40, 663552
ds_read_b64_tr_b16 v[38:39], v19 offset:10240
v_mfma_f32_16x16x32_bf16 v[108:111], v[44:47], a[40:43], v[108:111]
s_cmp_ge_u32 s40, s71
s_cselect_b32 s37, 5308416, 0
s_sub_u32 s40, s40, s37
v_mfma_f32_16x16x32_bf16 v[104:107], v[44:47], a[36:39], v[104:107]
ds_read_b64_tr_b16 v[40:41], v19 offset:12288
v_mfma_f32_16x16x32_bf16 v[104:107], v[48:51], a[52:55], v[104:107]
v_mfma_f32_16x16x32_bf16 v[100:103], v[48:51], a[48:51], v[100:103]
ds_read_b64_tr_b16 v[42:43], v19 offset:14336
v_mfma_f32_16x16x32_bf16 v[100:103], v[44:47], a[32:35], v[100:103]
s_waitcnt lgkmcnt(4)
v_mfma_f32_16x16x32_bf16 v[116:119], v[28:31], a[32:35], v[116:119]
ds_read_b64_tr_b16 v[44:45], v20 offset:0
v_mfma_f32_16x16x32_bf16 v[116:119], v[32:35], a[48:51], v[116:119]
v_mfma_f32_16x16x32_bf16 v[120:123], v[32:35], a[52:55], v[120:123]
ds_read_b64_tr_b16 v[46:47], v20 offset:2048
v_mfma_f32_16x16x32_bf16 v[120:123], v[28:31], a[36:39], v[120:123]
v_mfma_f32_16x16x32_bf16 v[124:127], v[28:31], a[40:43], v[124:127]
ds_read_b64_tr_b16 v[48:49], v20 offset:4096
v_mfma_f32_16x16x32_bf16 v[124:127], v[32:35], a[56:59], v[124:127]
v_mfma_f32_16x16x32_bf16 v[128:131], v[32:35], a[60:63], v[128:131]
ds_read_b64_tr_b16 v[50:51], v20 offset:6144
v_mfma_f32_16x16x32_bf16 v[128:131], v[28:31], a[44:47], v[128:131]
s_waitcnt lgkmcnt(4)
v_mfma_f32_16x16x32_bf16 v[144:147], v[36:39], a[44:47], v[144:147]
ds_read_b64_tr_b16 v[28:29], v20 offset:8192
v_mfma_f32_16x16x32_bf16 v[144:147], v[40:43], a[60:63], v[144:147]
v_mfma_f32_16x16x32_bf16 v[140:143], v[40:43], a[56:59], v[140:143]
ds_read_b64_tr_b16 v[30:31], v20 offset:10240
v_mfma_f32_16x16x32_bf16 v[140:143], v[36:39], a[40:43], v[140:143]
v_mfma_f32_16x16x32_bf16 v[136:139], v[36:39], a[36:39], v[136:139]
ds_read_b64_tr_b16 v[32:33], v20 offset:12288
v_mfma_f32_16x16x32_bf16 v[136:139], v[40:43], a[52:55], v[136:139]
v_mfma_f32_16x16x32_bf16 v[132:135], v[40:43], a[48:51], v[132:135]
ds_read_b64_tr_b16 v[34:35], v20 offset:14336
v_mfma_f32_16x16x32_bf16 v[132:135], v[36:39], a[32:35], v[132:135]
s_waitcnt vmcnt(21) lgkmcnt(4)
s_barrier
v_mfma_f32_16x16x32_bf16 v[148:151], v[44:47], a[32:35], v[148:151]
ds_read_b64_tr_b16 v[36:37], v17 offset:16384
v_mfma_f32_16x16x32_bf16 v[148:151], v[48:51], a[48:51], v[148:151]
v_mfma_f32_16x16x32_bf16 v[152:155], v[48:51], a[52:55], v[152:155]
ds_read_b64_tr_b16 v[38:39], v17 offset:18432
v_mfma_f32_16x16x32_bf16 v[152:155], v[44:47], a[36:39], v[152:155]
v_mfma_f32_16x16x32_bf16 v[156:159], v[44:47], a[40:43], v[156:159]
ds_read_b64_tr_b16 v[40:41], v17 offset:20480
v_mfma_f32_16x16x32_bf16 v[156:159], v[48:51], a[56:59], v[156:159]
v_mfma_f32_16x16x32_bf16 v[160:163], v[48:51], a[60:63], v[160:163]
ds_read_b64_tr_b16 v[42:43], v17 offset:22528
v_mfma_f32_16x16x32_bf16 v[160:163], v[44:47], a[44:47], v[160:163]
s_waitcnt lgkmcnt(4)
v_mfma_f32_16x16x32_bf16 v[176:179], v[28:31], a[44:47], v[176:179]
ds_read_b64_tr_b16 v[44:45], v17 offset:24576
v_mfma_f32_16x16x32_bf16 v[176:179], v[32:35], a[60:63], v[176:179]
v_mfma_f32_16x16x32_bf16 v[172:175], v[32:35], a[56:59], v[172:175]
ds_read_b64_tr_b16 v[46:47], v17 offset:26624
v_mfma_f32_16x16x32_bf16 v[172:175], v[28:31], a[40:43], v[172:175]
v_mfma_f32_16x16x32_bf16 v[168:171], v[28:31], a[36:39], v[168:171]
ds_read_b64_tr_b16 v[48:49], v17 offset:28672
v_mfma_f32_16x16x32_bf16 v[168:171], v[32:35], a[52:55], v[168:171]
v_mfma_f32_16x16x32_bf16 v[164:167], v[32:35], a[48:51], v[164:167]
ds_read_b64_tr_b16 v[50:51], v17 offset:30720
v_mfma_f32_16x16x32_bf16 v[164:167], v[28:31], a[32:35], v[164:167]
s_waitcnt lgkmcnt(4)
v_mfma_f32_16x16x32_bf16 v[52:55], v[36:39], a[64:67], v[52:55]
s_waitcnt vmcnt(6)
ds_read_b64_tr_b16 v[28:29], v18 offset:16384
v_cmp_eq_u32 vcc, 1, v23
v_mfma_f32_16x16x32_bf16 v[52:55], v[40:43], a[80:83], v[52:55]
v_mfma_f32_16x16x32_bf16 v[56:59], v[40:43], a[84:87], v[56:59]
s_cmp_eq_u64 vcc, exec
s_cbranch_scc0 sequential_preLN__linear_kernel_hedgehog__glu_gated_bilinear__prompt_kernel_f_slow4
sequential_preLN__linear_kernel_hedgehog__glu_gated_bilinear__prompt_kernel_f_back4:
ds_read_b64_tr_b16 v[30:31], v18 offset:18432
v_mfma_f32_16x16x32_bf16 v[56:59], v[36:39], a[68:71], v[56:59]
s_add_u32 m0, s34, 49152
v_mfma_f32_16x16x32_bf16 v[60:63], v[36:39], a[72:75], v[60:63]
ds_read_b64_tr_b16 v[32:33], v18 offset:20480
v_mfma_f32_16x16x32_bf16 v[60:63], v[40:43], a[88:91], v[60:63]
buffer_load_dwordx4 v3, s[16:19], s40 offen offset:0 sc1 lds
v_mfma_f32_16x16x32_bf16 v[64:67], v[40:43], a[92:95], v[64:67]
ds_read_b64_tr_b16 v[34:35], v18 offset:22528
v_mfma_f32_16x16x32_bf16 v[64:67], v[36:39], a[76:79], v[64:67]
s_waitcnt lgkmcnt(4)
v_mfma_f32_16x16x32_bf16 v[80:83], v[44:47], a[76:79], v[80:83]
ds_read_b64_tr_b16 v[36:37], v18 offset:24576
v_mfma_f32_16x16x32_bf16 v[80:83], v[48:51], a[92:95], v[80:83]
buffer_load_dwordx4 v4, s[16:19], s40 offen offset:1024 sc1 lds
v_mfma_f32_16x16x32_bf16 v[76:79], v[48:51], a[88:91], v[76:79]
ds_read_b64_tr_b16 v[38:39], v18 offset:26624
v_mfma_f32_16x16x32_bf16 v[76:79], v[44:47], a[72:75], v[76:79]
v_mfma_f32_16x16x32_bf16 v[72:75], v[44:47], a[68:71], v[72:75]
ds_read_b64_tr_b16 v[40:41], v18 offset:28672
v_mfma_f32_16x16x32_bf16 v[72:75], v[48:51], a[84:87], v[72:75]
buffer_load_dwordx4 v5, s[16:19], s40 offen offset:2048 sc1 lds
v_mfma_f32_16x16x32_bf16 v[68:71], v[48:51], a[80:83], v[68:71]
ds_read_b64_tr_b16 v[42:43], v18 offset:30720
v_mfma_f32_16x16x32_bf16 v[68:71], v[44:47], a[64:67], v[68:71]
s_waitcnt lgkmcnt(4)
v_mfma_f32_16x16x32_bf16 v[84:87], v[28:31], a[64:67], v[84:87]
ds_read_b64_tr_b16 v[44:45], v19 offset:16384
v_mfma_f32_16x16x32_bf16 v[84:87], v[32:35], a[80:83], v[84:87]
buffer_load_dwordx4 v6, s[16:19], s40 offen offset:3072 sc1 lds
v_mfma_f32_16x16x32_bf16 v[88:91], v[32:35], a[84:87], v[88:91]
s_add_u32 s40, s40, 663552
ds_read_b64_tr_b16 v[46:47], v19 offset:18432
v_mfma_f32_16x16x32_bf16 v[88:91], v[28:31], a[68:71], v[88:91]
s_cmp_ge_u32 s40, s71
s_cselect_b32 s37, 5308416, 0
s_sub_u32 s40, s40, s37
v_mfma_f32_16x16x32_bf16 v[92:95], v[28:31], a[72:75], v[92:95]
ds_read_b64_tr_b16 v[48:49], v19 offset:20480
v_mfma_f32_16x16x32_bf16 v[92:95], v[32:35], a[88:91], v[92:95]
buffer_load_dword v27, v26, s[20:23], s74 offen
v_mfma_f32_16x16x32_bf16 v[96:99], v[32:35], a[92:95], v[96:99]
s_add_u32 s74, s74, 4608
ds_read_b64_tr_b16 v[50:51], v19 offset:22528
v_mfma_f32_16x16x32_bf16 v[96:99], v[28:31], a[76:79], v[96:99]
s_waitcnt lgkmcnt(4)
v_mfma_f32_16x16x32_bf16 v[112:115], v[36:39], a[76:79], v[112:115]
ds_read_b64_tr_b16 v[28:29], v19 offset:24576
v_mfma_f32_16x16x32_bf16 v[112:115], v[40:43], a[92:95], v[112:115]
buffer_load_dword v27, v26, s[20:23], s74 offen
v_mfma_f32_16x16x32_bf16 v[108:111], v[40:43], a[88:91], v[108:111]
s_add_u32 s74, s74, 4608
ds_read_b64_tr_b16 v[30:31], v19 offset:26624
v_mfma_f32_16x16x32_bf16 v[108:111], v[36:39], a[72:75], v[108:111]
v_mfma_f32_16x16x32_bf16 v[104:107], v[36:39], a[68:71], v[104:107]
ds_read_b64_tr_b16 v[32:33], v19 offset:28672
v_mfma_f32_16x16x32_bf16 v[104:107], v[40:43], a[84:87], v[104:107]
buffer_load_dword v27, v26, s[20:23], s74 offen
v_mfma_f32_16x16x32_bf16 v[100:103], v[40:43], a[80:83], v[100:103]
s_add_u32 s74, s74, 4608
ds_read_b64_tr_b16 v[34:35], v19 offset:30720
v_mfma_f32_16x16x32_bf16 v[100:103], v[36:39], a[64:67], v[100:103]
s_waitcnt lgkmcnt(4)
v_mfma_f32_16x16x32_bf16 v[116:119], v[44:47], a[64:67], v[116:119]
ds_read_b64_tr_b16 v[36:37], v20 offset:16384
v_mfma_f32_16x16x32_bf16 v[116:119], v[48:51], a[80:83], v[116:119]
buffer_load_dword v27, v26, s[20:23], s74 offen
v_mfma_f32_16x16x32_bf16 v[120:123], v[48:51], a[84:87], v[120:123]
s_add_u32 s74, s74, 2304
ds_read_b64_tr_b16 v[38:39], v20 offset:18432
v_mfma_f32_16x16x32_bf16 v[120:123], v[44:47], a[68:71], v[120:123]
v_mfma_f32_16x16x32_bf16 v[124:127], v[44:47], a[72:75], v[124:127]
ds_read_b64_tr_b16 v[40:41], v20 offset:20480
v_mfma_f32_16x16x32_bf16 v[124:127], v[48:51], a[88:91], v[124:127]
buffer_load_dword v27, v26, s[20:23], s74 offen
v_mfma_f32_16x16x32_bf16 v[128:131], v[48:51], a[92:95], v[128:131]
s_add_u32 s74, s74, 2304
ds_read_b64_tr_b16 v[42:43], v20 offset:22528
v_mfma_f32_16x16x32_bf16 v[128:131], v[44:47], a[76:79], v[128:131]
s_waitcnt lgkmcnt(4)
v_mfma_f32_16x16x32_bf16 v[144:147], v[28:31], a[76:79], v[144:147]
ds_read_b64_tr_b16 v[44:45], v20 offset:24576
v_mfma_f32_16x16x32_bf16 v[144:147], v[32:35], a[92:95], v[144:147]
v_mfma_f32_16x16x32_bf16 v[140:143], v[32:35], a[88:91], v[140:143]
ds_read_b64_tr_b16 v[46:47], v20 offset:26624
v_mfma_f32_16x16x32_bf16 v[140:143], v[28:31], a[72:75], v[140:143]
v_mfma_f32_16x16x32_bf16 v[136:139], v[28:31], a[68:71], v[136:139]
ds_read_b64_tr_b16 v[48:49], v20 offset:28672
v_mfma_f32_16x16x32_bf16 v[136:139], v[32:35], a[84:87], v[136:139]
v_mfma_f32_16x16x32_bf16 v[132:135], v[32:35], a[80:83], v[132:135]
ds_read_b64_tr_b16 v[50:51], v20 offset:30720
v_mfma_f32_16x16x32_bf16 v[132:135], v[28:31], a[64:67], v[132:135]
s_waitcnt lgkmcnt(4)
s_barrier
v_mfma_f32_16x16x32_bf16 v[148:151], v[36:39], a[64:67], v[148:151]
ds_read_b64_tr_b16 v[28:29], v13 offset:0
v_mfma_f32_16x16x32_bf16 v[148:151], v[40:43], a[80:83], v[148:151]
v_mfma_f32_16x16x32_bf16 v[152:155], v[40:43], a[84:87], v[152:155]
ds_read_b64_tr_b16 v[30:31], v13 offset:2048
v_mfma_f32_16x16x32_bf16 v[152:155], v[36:39], a[68:71], v[152:155]
v_mfma_f32_16x16x32_bf16 v[156:159], v[36:39], a[72:75], v[156:159]
ds_read_b64_tr_b16 v[32:33], v13 offset:4096
v_mfma_f32_16x16x32_bf16 v[156:159], v[40:43], a[88:91], v[156:159]
v_mfma_f32_16x16x32_bf16 v[160:163], v[40:43], a[92:95], v[160:163]
ds_read_b64_tr_b16 v[34:35], v13 offset:6144
v_mfma_f32_16x16x32_bf16 v[160:163], v[36:39], a[76:79], v[160:163]
s_waitcnt lgkmcnt(4)
v_mfma_f32_16x16x32_bf16 v[176:179], v[44:47], a[76:79], v[176:179]
ds_read_b64_tr_b16 v[36:37], v13 offset:8192
v_mfma_f32_16x16x32_bf16 v[176:179], v[48:51], a[92:95], v[176:179]
v_mfma_f32_16x16x32_bf16 v[172:175], v[48:51], a[88:91], v[172:175]
ds_read_b64_tr_b16 v[38:39], v13 offset:10240
v_mfma_f32_16x16x32_bf16 v[172:175], v[44:47], a[72:75], v[172:175]
v_mfma_f32_16x16x32_bf16 v[168:171], v[44:47], a[68:71], v[168:171]
ds_read_b64_tr_b16 v[40:41], v13 offset:12288
v_mfma_f32_16x16x32_bf16 v[168:171], v[48:51], a[84:87], v[168:171]
v_mfma_f32_16x16x32_bf16 v[164:167], v[48:51], a[80:83], v[164:167]
ds_read_b64_tr_b16 v[42:43], v13 offset:14336
v_mfma_f32_16x16x32_bf16 v[164:167], v[44:47], a[64:67], v[164:167]
s_waitcnt lgkmcnt(4)
v_mfma_f32_16x16x32_bf16 v[52:55], v[28:31], a[96:99], v[52:55]
s_add_u32 m0, s34, 65536
ds_read_b64_tr_b16 v[44:45], v14 offset:0
v_mfma_f32_16x16x32_bf16 v[52:55], v[32:35], a[112:115], v[52:55]
buffer_load_dwordx4 v3, s[16:19], s40 offen offset:0 sc1 lds
v_mfma_f32_16x16x32_bf16 v[56:59], v[32:35], a[116:119], v[56:59]
ds_read_b64_tr_b16 v[46:47], v14 offset:2048
v_mfma_f32_16x16x32_bf16 v[56:59], v[28:31], a[100:103], v[56:59]
v_mfma_f32_16x16x32_bf16 v[60:63], v[28:31], a[104:107], v[60:63]
ds_read_b64_tr_b16 v[48:49], v14 offset:4096
v_mfma_f32_16x16x32_bf16 v[60:63], v[32:35], a[120:123], v[60:63]
buffer_load_dwordx4 v4, s[16:19], s40 offen offset:1024 sc1 lds
v_mfma_f32_16x16x32_bf16 v[64:67], v[32:35], a[124:127], v[64:67]
ds_read_b64_tr_b16 v[50:51], v14 offset:6144
v_mfma_f32_16x16x32_bf16 v[64:67], v[28:31], a[108:111], v[64:67]
s_waitcnt lgkmcnt(4)
v_mfma_f32_16x16x32_bf16 v[80:83], v[36:39], a[108:111], v[80:83]
ds_read_b64_tr_b16 v[28:29], v14 offset:8192
v_mfma_f32_16x16x32_bf16 v[80:83], v[40:43], a[124:127], v[80:83]
buffer_load_dwordx4 v5, s[16:19], s40 offen offset:2048 sc1 lds
v_mfma_f32_16x16x32_bf16 v[76:79], v[40:43], a[120:123], v[76:79]
ds_read_b64_tr_b16 v[30:31], v14 offset:10240
v_mfma_f32_16x16x32_bf16 v[76:79], v[36:39], a[104:107], v[76:79]
v_mfma_f32_16x16x32_bf16 v[72:75], v[36:39], a[100:103], v[72:75]
ds_read_b64_tr_b16 v[32:33], v14 offset:12288
v_mfma_f32_16x16x32_bf16 v[72:75], v[40:43], a[116:119], v[72:75]
buffer_load_dwordx4 v6, s[16:19], s40 offen offset:3072 sc1 lds
v_mfma_f32_16x16x32_bf16 v[68:71], v[40:43], a[112:115], v[68:71]
ds_read_b64_tr_b16 v[34:35], v14 offset:14336
v_mfma_f32_16x16x32_bf16 v[68:71], v[36:39], a[96:99], v[68:71]
s_waitcnt lgkmcnt(4)
v_mfma_f32_16x16x32_bf16 v[84:87], v[44:47], a[96:99], v[84:87]
ds_read_b64_tr_b16 v[36:37], v15 offset:0
v_mfma_f32_16x16x32_bf16 v[84:87], v[48:51], a[112:115], v[84:87]
buffer_load_dword v23, v244, s[28:31], s99 offen sc1
v_mfma_f32_16x16x32_bf16 v[88:91], v[48:51], a[116:119], v[88:91]
ds_read_b64_tr_b16 v[38:39], v15 offset:2048
v_mfma_f32_16x16x32_bf16 v[88:91], v[44:47], a[100:103], v[88:91]
v_mfma_f32_16x16x32_bf16 v[92:95], v[44:47], a[104:107], v[92:95]
ds_read_b64_tr_b16 v[40:41], v15 offset:4096
v_mfma_f32_16x16x32_bf16 v[92:95], v[48:51], a[120:123], v[92:95]
v_mfma_f32_16x16x32_bf16 v[96:99], v[48:51], a[124:127], v[96:99]
ds_read_b64_tr_b16 v[42:43], v15 offset:6144
v_mfma_f32_16x16x32_bf16 v[96:99], v[44:47], a[108:111], v[96:99]
s_waitcnt lgkmcnt(4)
v_mfma_f32_16x16x32_bf16 v[112:115], v[28:31], a[108:111], v[112:115]
ds_read_b64_tr_b16 v[44:45], v15 offset:8192
v_mfma_f32_16x16x32_bf16 v[112:115], v[32:35], a[124:127], v[112:115]
v_mfma_f32_16x16x32_bf16 v[108:111], v[32:35], a[120:123], v[108:111]
ds_read_b64_tr_b16 v[46:47], v15 offset:10240
v_mfma_f32_16x16x32_bf16 v[108:111], v[28:31], a[104:107], v[108:111]
v_mfma_f32_16x16x32_bf16 v[104:107], v[28:31], a[100:103], v[104:107]
ds_read_b64_tr_b16 v[48:49], v15 offset:12288
v_mfma_f32_16x16x32_bf16 v[104:107], v[32:35], a[116:119], v[104:107]
v_mfma_f32_16x16x32_bf16 v[100:103], v[32:35], a[112:115], v[100:103]
ds_read_b64_tr_b16 v[50:51], v15 offset:14336
v_mfma_f32_16x16x32_bf16 v[100:103], v[28:31], a[96:99], v[100:103]
s_waitcnt lgkmcnt(4)
v_mfma_f32_16x16x32_bf16 v[116:119], v[36:39], a[96:99], v[116:119]
s_waitcnt vmcnt(15)
ds_read_b64_tr_b16 v[28:29], v16 offset:0
v_mfma_f32_16x16x32_bf16 v[116:119], v[40:43], a[112:115], v[116:119]
buffer_store_dword v24, v25, s[28:31], s51 offen offset:128 sc1
v_mfma_f32_16x16x32_bf16 v[120:123], v[40:43], a[116:119], v[120:123]
ds_read_b64_tr_b16 v[30:31], v16 offset:2048
v_mfma_f32_16x16x32_bf16 v[120:123], v[36:39], a[100:103], v[120:123]
v_mfma_f32_16x16x32_bf16 v[124:127], v[36:39], a[104:107], v[124:127]
ds_read_b64_tr_b16 v[32:33], v16 offset:4096
v_mfma_f32_16x16x32_bf16 v[124:127], v[40:43], a[120:123], v[124:127]
v_mfma_f32_16x16x32_bf16 v[128:131], v[40:43], a[124:127], v[128:131]
ds_read_b64_tr_b16 v[34:35], v16 offset:6144
v_mfma_f32_16x16x32_bf16 v[128:131], v[36:39], a[108:111], v[128:131]
s_waitcnt lgkmcnt(4)
v_mfma_f32_16x16x32_bf16 v[144:147], v[44:47], a[108:111], v[144:147]
ds_read_b64_tr_b16 v[36:37], v16 offset:8192
v_mfma_f32_16x16x32_bf16 v[144:147], v[48:51], a[124:127], v[144:147]
v_mfma_f32_16x16x32_bf16 v[140:143], v[48:51], a[120:123], v[140:143]
ds_read_b64_tr_b16 v[38:39], v16 offset:10240
v_mfma_f32_16x16x32_bf16 v[140:143], v[44:47], a[104:107], v[140:143]
v_mfma_f32_16x16x32_bf16 v[136:139], v[44:47], a[100:103], v[136:139]
ds_read_b64_tr_b16 v[40:41], v16 offset:12288
v_mfma_f32_16x16x32_bf16 v[136:139], v[48:51], a[116:119], v[136:139]
v_mfma_f32_16x16x32_bf16 v[132:135], v[48:51], a[112:115], v[132:135]
ds_read_b64_tr_b16 v[42:43], v16 offset:14336
v_mfma_f32_16x16x32_bf16 v[132:135], v[44:47], a[96:99], v[132:135]
s_waitcnt lgkmcnt(4)
s_barrier
v_mfma_f32_16x16x32_bf16 v[148:151], v[28:31], a[96:99], v[148:151]
ds_read_b64_tr_b16 v[44:45], v13 offset:16384
v_mfma_f32_16x16x32_bf16 v[148:151], v[32:35], a[112:115], v[148:151]
buffer_load_dword v27, v26, s[28:31], s64 offen offset:0 sc1
v_mfma_f32_16x16x32_bf16 v[152:155], v[32:35], a[116:119], v[152:155]
ds_read_b64_tr_b16 v[46:47], v13 offset:18432
v_mfma_f32_16x16x32_bf16 v[152:155], v[28:31], a[100:103], v[152:155]
v_mfma_f32_16x16x32_bf16 v[156:159], v[28:31], a[104:107], v[156:159]
ds_read_b64_tr_b16 v[48:49], v13 offset:20480
v_mfma_f32_16x16x32_bf16 v[156:159], v[32:35], a[120:123], v[156:159]
v_mfma_f32_16x16x32_bf16 v[160:163], v[32:35], a[124:127], v[160:163]
ds_read_b64_tr_b16 v[50:51], v13 offset:22528
v_mfma_f32_16x16x32_bf16 v[160:163], v[28:31], a[108:111], v[160:163]
s_waitcnt lgkmcnt(4)
v_mfma_f32_16x16x32_bf16 v[176:179], v[36:39], a[108:111], v[176:179]
ds_read_b64_tr_b16 v[28:29], v13 offset:24576
v_mfma_f32_16x16x32_bf16 v[176:179], v[40:43], a[124:127], v[176:179]
v_mfma_f32_16x16x32_bf16 v[172:175], v[40:43], a[120:123], v[172:175]
ds_read_b64_tr_b16 v[30:31], v13 offset:26624
v_mfma_f32_16x16x32_bf16 v[172:175], v[36:39], a[104:107], v[172:175]
v_mfma_f32_16x16x32_bf16 v[168:171], v[36:39], a[100:103], v[168:171]
ds_read_b64_tr_b16 v[32:33], v13 offset:28672
v_mfma_f32_16x16x32_bf16 v[168:171], v[40:43], a[116:119], v[168:171]
v_mfma_f32_16x16x32_bf16 v[164:167], v[40:43], a[112:115], v[164:167]
ds_read_b64_tr_b16 v[34:35], v13 offset:30720
v_mfma_f32_16x16x32_bf16 v[164:167], v[36:39], a[96:99], v[164:167]
s_waitcnt lgkmcnt(4)
v_mfma_f32_16x16x32_bf16 v[52:55], v[44:47], a[128:131], v[52:55]
s_add_u32 m0, s34, 81920
ds_read_b64_tr_b16 v[36:37], v14 offset:16384
v_mfma_f32_16x16x32_bf16 v[52:55], v[48:51], a[144:147], v[52:55]
buffer_load_dwordx4 v7, s[16:19], s41 offen offset:0 sc1 lds
v_mfma_f32_16x16x32_bf16 v[56:59], v[48:51], a[148:151], v[56:59]
s_add_u32 s41, s41, 662528
ds_read_b64_tr_b16 v[38:39], v14 offset:18432
v_mfma_f32_16x16x32_bf16 v[56:59], v[44:47], a[132:135], v[56:59]
v_mfma_f32_16x16x32_bf16 v[60:63], v[44:47], a[136:139], v[60:63]
ds_read_b64_tr_b16 v[40:41], v14 offset:20480
v_mfma_f32_16x16x32_bf16 v[60:63], v[48:51], a[152:155], v[60:63]
buffer_load_dwordx4 v7, s[16:19], s41 offen offset:1024 sc1 lds
v_mfma_f32_16x16x32_bf16 v[64:67], v[48:51], a[156:159], v[64:67]
s_add_u32 s41, s41, 662528
ds_read_b64_tr_b16 v[42:43], v14 offset:22528
v_mfma_f32_16x16x32_bf16 v[64:67], v[44:47], a[140:143], v[64:67]
s_waitcnt lgkmcnt(4)
v_mfma_f32_16x16x32_bf16 v[80:83], v[28:31], a[140:143], v[80:83]
ds_read_b64_tr_b16 v[44:45], v14 offset:24576
v_mfma_f32_16x16x32_bf16 v[80:83], v[32:35], a[156:159], v[80:83]
buffer_load_dwordx4 v7, s[16:19], s41 offen offset:2048 sc1 lds
v_mfma_f32_16x16x32_bf16 v[76:79], v[32:35], a[152:155], v[76:79]
s_add_u32 s41, s41, 662528
ds_read_b64_tr_b16 v[46:47], v14 offset:26624
v_mfma_f32_16x16x32_bf16 v[76:79], v[28:31], a[136:139], v[76:79]
v_mfma_f32_16x16x32_bf16 v[72:75], v[28:31], a[132:135], v[72:75]
ds_read_b64_tr_b16 v[48:49], v14 offset:28672
v_mfma_f32_16x16x32_bf16 v[72:75], v[32:35], a[148:151], v[72:75]
buffer_load_dwordx4 v7, s[16:19], s41 offen offset:3072 sc1 lds
v_mfma_f32_16x16x32_bf16 v[68:71], v[32:35], a[144:147], v[68:71]
s_sub_u32 s41, s41, 1987072
ds_read_b64_tr_b16 v[50:51], v14 offset:30720
s_waitcnt vmcnt(6)
v_mfma_f32_16x16x32_bf16 v[68:71], v[28:31], a[128:131], v[68:71]
s_waitcnt lgkmcnt(4)
v_cmp_eq_u32 vcc, 1, v23
v_mfma_f32_16x16x32_bf16 v[84:87], v[36:39], a[128:131], v[84:87]
ds_read_b64_tr_b16 v[28:29], v15 offset:16384
v_mfma_f32_16x16x32_bf16 v[84:87], v[40:43], a[144:147], v[84:87]
v_mfma_f32_16x16x32_bf16 v[88:91], v[40:43], a[148:151], v[88:91]
s_cmp_eq_u64 vcc, exec
s_cbranch_scc0 sequential_preLN__linear_kernel_hedgehog__glu_gated_bilinear__prompt_kernel_f_slow3
sequential_preLN__linear_kernel_hedgehog__glu_gated_bilinear__prompt_kernel_f_back3:
ds_read_b64_tr_b16 v[30:31], v15 offset:18432
v_mfma_f32_16x16x32_bf16 v[88:91], v[36:39], a[132:135], v[88:91]
s_add_u32 m0, s35, 0
v_mfma_f32_16x16x32_bf16 v[92:95], v[36:39], a[136:139], v[92:95]
ds_read_b64_tr_b16 v[32:33], v15 offset:20480
v_mfma_f32_16x16x32_bf16 v[92:95], v[40:43], a[152:155], v[92:95]
buffer_load_dwordx4 v1, s[28:31], s43 offen sc1 lds
v_mfma_f32_16x16x32_bf16 v[96:99], v[40:43], a[156:159], v[96:99]
s_add_u32 s43, s43, 2048
ds_read_b64_tr_b16 v[34:35], v15 offset:22528
v_mfma_f32_16x16x32_bf16 v[96:99], v[36:39], a[140:143], v[96:99]
s_waitcnt lgkmcnt(4)
s_cmp_ge_u32 s43, s73
s_cselect_b32 s37, 16384, 0
v_mfma_f32_16x16x32_bf16 v[112:115], v[44:47], a[140:143], v[112:115]
s_sub_u32 s43, s43, s37
ds_read_b64_tr_b16 v[36:37], v15 offset:24576
s_add_u32 m0, s35, 4096
v_mfma_f32_16x16x32_bf16 v[112:115], v[48:51], a[156:159], v[112:115]
buffer_load_dwordx4 v1, s[28:31], s43 offen sc1 lds
v_mfma_f32_16x16x32_bf16 v[108:111], v[48:51], a[152:155], v[108:111]
s_add_u32 s43, s43, 2048
ds_read_b64_tr_b16 v[38:39], v15 offset:26624
v_mfma_f32_16x16x32_bf16 v[108:111], v[44:47], a[136:139], v[108:111]
s_cmp_ge_u32 s43, s73
s_cselect_b32 s37, 16384, 0
s_sub_u32 s43, s43, s37
v_mfma_f32_16x16x32_bf16 v[104:107], v[44:47], a[132:135], v[104:107]
s_add_u32 m0, s35, 8192
ds_read_b64_tr_b16 v[40:41], v15 offset:28672
v_mfma_f32_16x16x32_bf16 v[104:107], v[48:51], a[148:151], v[104:107]
buffer_load_dwordx4 v1, s[28:31], s43 offen sc1 lds
v_mfma_f32_16x16x32_bf16 v[100:103], v[48:51], a[144:147], v[100:103]
s_add_u32 s43, s43, 2048
ds_read_b64_tr_b16 v[42:43], v15 offset:30720
v_mfma_f32_16x16x32_bf16 v[100:103], v[44:47], a[128:131], v[100:103]
s_waitcnt lgkmcnt(4)
s_cmp_ge_u32 s43, s73
s_cselect_b32 s37, 16384, 0
v_mfma_f32_16x16x32_bf16 v[116:119], v[28:31], a[128:131], v[116:119]
s_sub_u32 s43, s43, s37
ds_read_b64_tr_b16 v[44:45], v16 offset:16384
s_add_u32 m0, s35, 12288
v_mfma_f32_16x16x32_bf16 v[116:119], v[32:35], a[144:147], v[116:119]
s_branch iskip8
.p2align 12
ipad8:
s_branch ipad12
s_nop 0
iskip8:
buffer_load_dwordx4 v1, s[28:31], s43 offen sc1 lds
v_mfma_f32_16x16x32_bf16 v[120:123], v[32:35], a[148:151], v[120:123]
s_add_u32 s43, s43, 2048
ds_read_b64_tr_b16 v[46:47], v16 offset:18432
v_mfma_f32_16x16x32_bf16 v[120:123], v[28:31], a[132:135], v[120:123]
s_cmp_ge_u32 s43, s73
s_cselect_b32 s37, 16384, 0
s_sub_u32 s43, s43, s37
v_mfma_f32_16x16x32_bf16 v[124:127], v[28:31], a[136:139], v[124:127]
ds_read_b64_tr_b16 v[48:49], v16 offset:20480
v_mfma_f32_16x16x32_bf16 v[124:127], v[32:35], a[152:155], v[124:127]
buffer_load_dword v27, v26, s[28:31], s64 offen offset:1024 sc1
v_mfma_f32_16x16x32_bf16 v[128:131], v[32:35], a[156:159], v[128:131]
ds_read_b64_tr_b16 v[50:51], v16 offset:22528
v_mfma_f32_16x16x32_bf16 v[128:131], v[28:31], a[140:143], v[128:131]
s_waitcnt lgkmcnt(4)
v_mfma_f32_16x16x32_bf16 v[144:147], v[36:39], a[140:143], v[144:147]
ds_read_b64_tr_b16 v[28:29], v16 offset:24576
v_mfma_f32_16x16x32_bf16 v[144:147], v[40:43], a[156:159], v[144:147]
v_mfma_f32_16x16x32_bf16 v[140:143], v[40:43], a[152:155], v[140:143]
ds_read_b64_tr_b16 v[30:31], v16 offset:26624
v_mfma_f32_16x16x32_bf16 v[140:143], v[36:39], a[136:139], v[140:143]
v_mfma_f32_16x16x32_bf16 v[136:139], v[36:39], a[132:135], v[136:139]
ds_read_b64_tr_b16 v[32:33], v16 offset:28672
v_mfma_f32_16x16x32_bf16 v[136:139], v[40:43], a[148:151], v[136:139]
v_mfma_f32_16x16x32_bf16 v[132:135], v[40:43], a[144:147], v[132:135]
ds_read_b64_tr_b16 v[34:35], v16 offset:30720
v_mfma_f32_16x16x32_bf16 v[132:135], v[36:39], a[128:131], v[132:135]
s_waitcnt lgkmcnt(4)
s_barrier
v_mfma_f32_16x16x32_bf16 v[148:151], v[44:47], a[128:131], v[148:151]
ds_read_b64_tr_b16 v[36:37], v13 offset:32768
v_mfma_f32_16x16x32_bf16 v[148:151], v[48:51], a[144:147], v[148:151]
buffer_load_dword v27, v26, s[28:31], s64 offen offset:2048 sc1
v_mfma_f32_16x16x32_bf16 v[152:155], v[48:51], a[148:151], v[152:155]
ds_read_b64_tr_b16 v[38:39], v13 offset:34816
v_mfma_f32_16x16x32_bf16 v[152:155], v[44:47], a[132:135], v[152:155]
v_mfma_f32_16x16x32_bf16 v[156:159], v[44:47], a[136:139], v[156:159]
ds_read_b64_tr_b16 v[40:41], v13 offset:36864
v_mfma_f32_16x16x32_bf16 v[156:159], v[48:51], a[152:155], v[156:159]
v_mfma_f32_16x16x32_bf16 v[160:163], v[48:51], a[156:159], v[160:163]
ds_read_b64_tr_b16 v[42:43], v13 offset:38912
v_mfma_f32_16x16x32_bf16 v[160:163], v[44:47], a[140:143], v[160:163]
s_waitcnt lgkmcnt(4)
v_mfma_f32_16x16x32_bf16 v[176:179], v[28:31], a[140:143], v[176:179]
ds_read_b64_tr_b16 v[44:45], v13 offset:40960
v_mfma_f32_16x16x32_bf16 v[176:179], v[32:35], a[156:159], v[176:179]
v_mfma_f32_16x16x32_bf16 v[172:175], v[32:35], a[152:155], v[172:175]
ds_read_b64_tr_b16 v[46:47], v13 offset:43008
v_mfma_f32_16x16x32_bf16 v[172:175], v[28:31], a[136:139], v[172:175]
v_mfma_f32_16x16x32_bf16 v[168:171], v[28:31], a[132:135], v[168:171]
ds_read_b64_tr_b16 v[48:49], v13 offset:45056
v_mfma_f32_16x16x32_bf16 v[168:171], v[32:35], a[148:151], v[168:171]
v_mfma_f32_16x16x32_bf16 v[164:167], v[32:35], a[144:147], v[164:167]
ds_read_b64_tr_b16 v[50:51], v13 offset:47104
v_mfma_f32_16x16x32_bf16 v[164:167], v[28:31], a[128:131], v[164:167]
s_waitcnt lgkmcnt(4)
v_mfma_f32_16x16x32_bf16 v[52:55], v[36:39], a[160:163], v[52:55]
s_add_u32 m0, s34, 0
ds_read_b64_tr_b16 v[28:29], v14 offset:32768
v_mfma_f32_16x16x32_bf16 v[52:55], v[40:43], a[176:179], v[52:55]
buffer_load_dwordx4 v8, s[20:23], s60 offen offset:0 sc1 lds
v_mfma_f32_16x16x32_bf16 v[56:59], v[40:43], a[180:183], v[56:59]
ds_read_b64_tr_b16 v[30:31], v14 offset:34816
v_mfma_f32_16x16x32_bf16 v[56:59], v[36:39], a[164:167], v[56:59]
v_mfma_f32_16x16x32_bf16 v[60:63], v[36:39], a[168:171], v[60:63]
ds_read_b64_tr_b16 v[32:33], v14 offset:36864
v_mfma_f32_16x16x32_bf16 v[60:63], v[40:43], a[184:187], v[60:63]
buffer_load_dwordx4 v9, s[20:23], s60 offen offset:1024 sc1 lds
v_mfma_f32_16x16x32_bf16 v[64:67], v[40:43], a[188:191], v[64:67]
ds_read_b64_tr_b16 v[34:35], v14 offset:38912
v_mfma_f32_16x16x32_bf16 v[64:67], v[36:39], a[172:175], v[64:67]
s_waitcnt lgkmcnt(4)
v_mfma_f32_16x16x32_bf16 v[80:83], v[44:47], a[172:175], v[80:83]
ds_read_b64_tr_b16 v[36:37], v14 offset:40960
v_mfma_f32_16x16x32_bf16 v[80:83], v[48:51], a[188:191], v[80:83]
buffer_load_dwordx4 v10, s[20:23], s60 offen offset:2048 sc1 lds
v_mfma_f32_16x16x32_bf16 v[76:79], v[48:51], a[184:187], v[76:79]
ds_read_b64_tr_b16 v[38:39], v14 offset:43008
v_mfma_f32_16x16x32_bf16 v[76:79], v[44:47], a[168:171], v[76:79]
v_mfma_f32_16x16x32_bf16 v[72:75], v[44:47], a[164:167], v[72:75]
ds_read_b64_tr_b16 v[40:41], v14 offset:45056
v_mfma_f32_16x16x32_bf16 v[72:75], v[48:51], a[180:183], v[72:75]
buffer_load_dwordx4 v11, s[20:23], s60 offen offset:3072 sc1 lds
v_mfma_f32_16x16x32_bf16 v[68:71], v[48:51], a[176:179], v[68:71]
s_add_u32 s60, s60, 294912
ds_read_b64_tr_b16 v[42:43], v14 offset:47104
s_add_u32 m0, s35, 16384
v_mfma_f32_16x16x32_bf16 v[68:71], v[44:47], a[160:163], v[68:71]
s_waitcnt lgkmcnt(4)
v_mfma_f32_16x16x32_bf16 v[84:87], v[28:31], a[160:163], v[84:87]
ds_read_b64_tr_b16 v[44:45], v15 offset:32768
v_mfma_f32_16x16x32_bf16 v[84:87], v[32:35], a[176:179], v[84:87]
buffer_load_dwordx4 v1, s[28:31], s43 offen sc1 lds
v_mfma_f32_16x16x32_bf16 v[88:91], v[32:35], a[180:183], v[88:91]
s_add_u32 s43, s43, 2048
ds_read_b64_tr_b16 v[46:47], v15 offset:34816
v_mfma_f32_16x16x32_bf16 v[88:91], v[28:31], a[164:167], v[88:91]
s_cmp_ge_u32 s43, s73
s_cselect_b32 s37, 16384, 0
s_sub_u32 s43, s43, s37
v_mfma_f32_16x16x32_bf16 v[92:95], v[28:31], a[168:171], v[92:95]
s_add_u32 m0, s35, 20480
ds_read_b64_tr_b16 v[48:49], v15 offset:36864
v_mfma_f32_16x16x32_bf16 v[92:95], v[32:35], a[184:187], v[92:95]
buffer_load_dwordx4 v1, s[28:31], s43 offen sc1 lds
v_mfma_f32_16x16x32_bf16 v[96:99], v[32:35], a[188:191], v[96:99]
s_add_u32 s43, s43, 2048
ds_read_b64_tr_b16 v[50:51], v15 offset:38912
v_mfma_f32_16x16x32_bf16 v[96:99], v[28:31], a[172:175], v[96:99]
s_waitcnt lgkmcnt(4)
s_cmp_ge_u32 s43, s73
s_cselect_b32 s37, 16384, 0
v_mfma_f32_16x16x32_bf16 v[112:115], v[36:39], a[172:175], v[112:115]
s_sub_u32 s43, s43, s37
ds_read_b64_tr_b16 v[28:29], v15 offset:40960
s_add_u32 m0, s35, 24576
v_mfma_f32_16x16x32_bf16 v[112:115], v[40:43], a[188:191], v[112:115]
buffer_load_dwordx4 v1, s[28:31], s43 offen sc1 lds
v_mfma_f32_16x16x32_bf16 v[108:111], v[40:43], a[184:187], v[108:111]
s_add_u32 s43, s43, 2048
ds_read_b64_tr_b16 v[30:31], v15 offset:43008
v_mfma_f32_16x16x32_bf16 v[108:111], v[36:39], a[168:171], v[108:111]
s_cmp_ge_u32 s43, s73
s_cselect_b32 s37, 16384, 0
s_sub_u32 s43, s43, s37
v_mfma_f32_16x16x32_bf16 v[104:107], v[36:39], a[164:167], v[104:107]
s_add_u32 m0, s35, 28672
ds_read_b64_tr_b16 v[32:33], v15 offset:45056
v_mfma_f32_16x16x32_bf16 v[104:107], v[40:43], a[180:183], v[104:107]
buffer_load_dwordx4 v1, s[28:31], s43 offen sc1 lds
v_mfma_f32_16x16x32_bf16 v[100:103], v[40:43], a[176:179], v[100:103]
ds_read_b64_tr_b16 v[34:35], v15 offset:47104
v_mfma_f32_16x16x32_bf16 v[100:103], v[36:39], a[160:163], v[100:103]
s_waitcnt lgkmcnt(4)
v_mfma_f32_16x16x32_bf16 v[116:119], v[44:47], a[160:163], v[116:119]
ds_read_b64_tr_b16 v[36:37], v16 offset:32768
v_mfma_f32_16x16x32_bf16 v[116:119], v[48:51], a[176:179], v[116:119]
buffer_load_dword v27, v26, s[28:31], s64 offen offset:3072 sc1
v_mfma_f32_16x16x32_bf16 v[120:123], v[48:51], a[180:183], v[120:123]
s_add_u32 s64, s64, 4096
ds_read_b64_tr_b16 v[38:39], v16 offset:34816
s_lshl_b32 s5, s15, 1
v_mfma_f32_16x16x32_bf16 v[120:123], v[44:47], a[164:167], v[120:123]
s_add_u32 s5, s5, s59
s_lshl_b32 s4, s5, 11
s_add_u32 s4, s4, 4194304
v_mfma_f32_16x16x32_bf16 v[124:127], v[44:47], a[168:171], v[124:127]
s_lshl_b32 s5, s5, 7
ds_read_b64_tr_b16 v[40:41], v16 offset:36864
s_add_u32 s5, s5, 12582912
v_mfma_f32_16x16x32_bf16 v[124:127], v[48:51], a[184:187], v[124:127]
v_and_b32 v12, 127, v2
s_mov_b32 s96, 0x3ae38e39
v_mfma_f32_16x16x32_bf16 v[128:131], v[48:51], a[188:191], v[128:131]
ds_read_b64_tr_b16 v[42:43], v16 offset:38912
v_mfma_f32_16x16x32_bf16 v[128:131], v[44:47], a[172:175], v[128:131]
s_waitcnt lgkmcnt(4)
buffer_load_dwordx2 v[246:247], v2, s[28:31], s4 offen offset:0 sc1
v_mfma_f32_16x16x32_bf16 v[144:147], v[28:31], a[172:175], v[144:147]
ds_read_b64_tr_b16 v[44:45], v16 offset:40960
v_mfma_f32_16x16x32_bf16 v[144:147], v[32:35], a[188:191], v[144:147]
v_mfma_f32_16x16x32_bf16 v[140:143], v[32:35], a[184:187], v[140:143]
ds_read_b64_tr_b16 v[46:47], v16 offset:43008
v_mfma_f32_16x16x32_bf16 v[140:143], v[28:31], a[168:171], v[140:143]
buffer_load_dwordx2 v[248:249], v2, s[28:31], s4 offen offset:512 sc1
v_mfma_f32_16x16x32_bf16 v[136:139], v[28:31], a[164:167], v[136:139]
ds_read_b64_tr_b16 v[48:49], v16 offset:45056
v_mfma_f32_16x16x32_bf16 v[136:139], v[32:35], a[180:183], v[136:139]
v_mfma_f32_16x16x32_bf16 v[132:135], v[32:35], a[176:179], v[132:135]
ds_read_b64_tr_b16 v[50:51], v16 offset:47104
v_mfma_f32_16x16x32_bf16 v[132:135], v[28:31], a[160:163], v[132:135]
s_waitcnt lgkmcnt(4)
s_barrier
v_mfma_f32_16x16x32_bf16 v[148:151], v[36:39], a[160:163], v[148:151]
ds_read_b64_tr_b16 v[28:29], v13 offset:49152
v_mfma_f32_16x16x32_bf16 v[148:151], v[40:43], a[176:179], v[148:151]
buffer_load_dwordx2 v[252:253], v2, s[28:31], s4 offen offset:1024 sc1
v_mfma_f32_16x16x32_bf16 v[152:155], v[40:43], a[180:183], v[152:155]
ds_read_b64_tr_b16 v[30:31], v13 offset:51200
v_mfma_f32_16x16x32_bf16 v[152:155], v[36:39], a[164:167], v[152:155]
v_mfma_f32_16x16x32_bf16 v[156:159], v[36:39], a[168:171], v[156:159]
ds_read_b64_tr_b16 v[32:33], v13 offset:53248
v_mfma_f32_16x16x32_bf16 v[156:159], v[40:43], a[184:187], v[156:159]
buffer_load_dwordx2 v[254:255], v2, s[28:31], s4 offen offset:1536 sc1
v_mfma_f32_16x16x32_bf16 v[160:163], v[40:43], a[188:191], v[160:163]
ds_read_b64_tr_b16 v[34:35], v13 offset:55296
v_mfma_f32_16x16x32_bf16 v[160:163], v[36:39], a[172:175], v[160:163]
s_waitcnt lgkmcnt(4)
v_mfma_f32_16x16x32_bf16 v[176:179], v[44:47], a[172:175], v[176:179]
ds_read_b64_tr_b16 v[36:37], v13 offset:57344
v_mfma_f32_16x16x32_bf16 v[176:179], v[48:51], a[188:191], v[176:179]
buffer_load_dwordx2 v[6:7], v12, s[28:31], s5 offen offset:0 sc1
v_mfma_f32_16x16x32_bf16 v[172:175], v[48:51], a[184:187], v[172:175]
ds_read_b64_tr_b16 v[38:39], v13 offset:59392
v_mfma_f32_16x16x32_bf16 v[172:175], v[44:47], a[168:171], v[172:175]
v_mfma_f32_16x16x32_bf16 v[168:171], v[44:47], a[164:167], v[168:171]
ds_read_b64_tr_b16 v[40:41], v13 offset:61440
v_mfma_f32_16x16x32_bf16 v[168:171], v[48:51], a[180:183], v[168:171]
buffer_load_dword v27, v26, s[28:31], s64 offen offset:0 sc1
v_mfma_f32_16x16x32_bf16 v[164:167], v[48:51], a[176:179], v[164:167]
ds_read_b64_tr_b16 v[42:43], v13 offset:63488
v_mfma_f32_16x16x32_bf16 v[164:167], v[44:47], a[160:163], v[164:167]
s_waitcnt lgkmcnt(4)
v_mfma_f32_16x16x32_bf16 v[52:55], v[28:31], a[192:195], v[52:55]
s_add_u32 m0, s34, 16384
ds_read_b64_tr_b16 v[44:45], v14 offset:49152
v_mfma_f32_16x16x32_bf16 v[52:55], v[32:35], a[208:211], v[52:55]
buffer_load_dwordx4 v8, s[20:23], s61 offen offset:0 sc1 lds
v_mfma_f32_16x16x32_bf16 v[56:59], v[32:35], a[212:215], v[56:59]
ds_read_b64_tr_b16 v[46:47], v14 offset:51200
v_mfma_f32_16x16x32_bf16 v[56:59], v[28:31], a[196:199], v[56:59]
v_mfma_f32_16x16x32_bf16 v[60:63], v[28:31], a[200:203], v[60:63]
ds_read_b64_tr_b16 v[48:49], v14 offset:53248
v_mfma_f32_16x16x32_bf16 v[60:63], v[32:35], a[216:219], v[60:63]
buffer_load_dwordx4 v9, s[20:23], s61 offen offset:1024 sc1 lds
v_mfma_f32_16x16x32_bf16 v[64:67], v[32:35], a[220:223], v[64:67]
ds_read_b64_tr_b16 v[50:51], v14 offset:55296
v_mfma_f32_16x16x32_bf16 v[64:67], v[28:31], a[204:207], v[64:67]
s_waitcnt lgkmcnt(4)
v_mfma_f32_16x16x32_bf16 v[80:83], v[36:39], a[204:207], v[80:83]
ds_read_b64_tr_b16 v[28:29], v14 offset:57344
v_mfma_f32_16x16x32_bf16 v[80:83], v[40:43], a[220:223], v[80:83]
buffer_load_dwordx4 v10, s[20:23], s61 offen offset:2048 sc1 lds
v_mfma_f32_16x16x32_bf16 v[76:79], v[40:43], a[216:219], v[76:79]
ds_read_b64_tr_b16 v[30:31], v14 offset:59392
v_mfma_f32_16x16x32_bf16 v[76:79], v[36:39], a[200:203], v[76:79]
v_mfma_f32_16x16x32_bf16 v[72:75], v[36:39], a[196:199], v[72:75]
ds_read_b64_tr_b16 v[32:33], v14 offset:61440
v_mfma_f32_16x16x32_bf16 v[72:75], v[40:43], a[212:215], v[72:75]
buffer_load_dwordx4 v11, s[20:23], s61 offen offset:3072 sc1 lds
v_mfma_f32_16x16x32_bf16 v[68:71], v[40:43], a[208:211], v[68:71]
s_add_u32 s61, s61, 294912
ds_read_b64_tr_b16 v[34:35], v14 offset:63488
s_add_u32 m0, s35, 32768
v_mfma_f32_16x16x32_bf16 v[68:71], v[36:39], a[192:195], v[68:71]
s_waitcnt lgkmcnt(4)
v_mfma_f32_16x16x32_bf16 v[84:87], v[44:47], a[192:195], v[84:87]
ds_read_b64_tr_b16 v[36:37], v15 offset:49152
v_mfma_f32_16x16x32_bf16 v[84:87], v[48:51], a[208:211], v[84:87]
buffer_load_dwordx4 v1, s[28:31], s73 offen sc1 lds
v_mfma_f32_16x16x32_bf16 v[88:91], v[48:51], a[212:215], v[88:91]
s_add_u32 m0, s35, 36864
ds_read_b64_tr_b16 v[38:39], v15 offset:51200
v_mfma_f32_16x16x32_bf16 v[88:91], v[44:47], a[196:199], v[88:91]
v_mfma_f32_16x16x32_bf16 v[92:95], v[44:47], a[200:203], v[92:95]
ds_read_b64_tr_b16 v[40:41], v15 offset:53248
v_mfma_f32_16x16x32_bf16 v[92:95], v[48:51], a[216:219], v[92:95]
buffer_load_dwordx4 v1, s[28:31], s68 offen sc1 lds
v_mfma_f32_16x16x32_bf16 v[96:99], v[48:51], a[220:223], v[96:99]
s_add_u32 s68, s68, 8192
ds_read_b64_tr_b16 v[42:43], v15 offset:55296
s_add_u32 m0, s35, 40960
v_mfma_f32_16x16x32_bf16 v[96:99], v[44:47], a[204:207], v[96:99]
s_waitcnt lgkmcnt(4)
v_mfma_f32_16x16x32_bf16 v[112:115], v[28:31], a[204:207], v[112:115]
ds_read_b64_tr_b16 v[44:45], v15 offset:57344
v_mfma_f32_16x16x32_bf16 v[112:115], v[32:35], a[220:223], v[112:115]
buffer_load_dwordx4 v1, s[28:31], s69 offen sc1 lds
v_mfma_f32_16x16x32_bf16 v[108:111], v[32:35], a[216:219], v[108:111]
s_add_u32 s69, s69, 8192
ds_read_b64_tr_b16 v[46:47], v15 offset:59392
s_add_u32 m0, s35, 45056
v_mfma_f32_16x16x32_bf16 v[108:111], v[28:31], a[200:203], v[108:111]
v_mfma_f32_16x16x32_bf16 v[104:107], v[28:31], a[196:199], v[104:107]
ds_read_b64_tr_b16 v[48:49], v15 offset:61440
v_mfma_f32_16x16x32_bf16 v[104:107], v[32:35], a[212:215], v[104:107]
buffer_load_dwordx4 v1, s[28:31], s68 offen sc1 lds
v_mfma_f32_16x16x32_bf16 v[100:103], v[32:35], a[208:211], v[100:103]
ds_read_b64_tr_b16 v[50:51], v15 offset:63488
v_mfma_f32_16x16x32_bf16 v[100:103], v[28:31], a[192:195], v[100:103]
s_waitcnt lgkmcnt(4)
v_mfma_f32_16x16x32_bf16 v[116:119], v[36:39], a[192:195], v[116:119]
ds_read_b64_tr_b16 v[28:29], v16 offset:49152
v_mfma_f32_16x16x32_bf16 v[116:119], v[40:43], a[208:211], v[116:119]
buffer_load_dword v23, v22, s[28:31], s50 offen offset:128 sc1
v_mfma_f32_16x16x32_bf16 v[120:123], v[40:43], a[212:215], v[120:123]
ds_read_b64_tr_b16 v[30:31], v16 offset:51200
v_mfma_f32_16x16x32_bf16 v[120:123], v[36:39], a[196:199], v[120:123]
v_mfma_f32_16x16x32_bf16 v[124:127], v[36:39], a[200:203], v[124:127]
ds_read_b64_tr_b16 v[32:33], v16 offset:53248
v_mfma_f32_16x16x32_bf16 v[124:127], v[40:43], a[216:219], v[124:127]
buffer_load_dword v27, v26, s[28:31], s64 offen offset:1024 sc1
v_mfma_f32_16x16x32_bf16 v[128:131], v[40:43], a[220:223], v[128:131]
ds_read_b64_tr_b16 v[34:35], v16 offset:55296
v_mfma_f32_16x16x32_bf16 v[128:131], v[36:39], a[204:207], v[128:131]
s_waitcnt lgkmcnt(4)
v_mfma_f32_16x16x32_bf16 v[144:147], v[44:47], a[204:207], v[144:147]
ds_read_b64_tr_b16 v[36:37], v16 offset:57344
v_mfma_f32_16x16x32_bf16 v[144:147], v[48:51], a[220:223], v[144:147]
v_mfma_f32_16x16x32_bf16 v[140:143], v[48:51], a[216:219], v[140:143]
ds_read_b64_tr_b16 v[38:39], v16 offset:59392
v_mfma_f32_16x16x32_bf16 v[140:143], v[44:47], a[200:203], v[140:143]
v_mfma_f32_16x16x32_bf16 v[136:139], v[44:47], a[196:199], v[136:139]
ds_read_b64_tr_b16 v[40:41], v16 offset:61440
v_mfma_f32_16x16x32_bf16 v[136:139], v[48:51], a[212:215], v[136:139]
v_mfma_f32_16x16x32_bf16 v[132:135], v[48:51], a[208:211], v[132:135]
ds_read_b64_tr_b16 v[42:43], v16 offset:63488
v_mfma_f32_16x16x32_bf16 v[132:135], v[44:47], a[192:195], v[132:135]
s_waitcnt vmcnt(31) lgkmcnt(4)
s_barrier
v_mfma_f32_16x16x32_bf16 v[148:151], v[28:31], a[192:195], v[148:151]
ds_read_b64_tr_b16 v[44:45], v17 offset:0
v_mfma_f32_16x16x32_bf16 v[148:151], v[32:35], a[208:211], v[148:151]
buffer_load_dword v27, v26, s[28:31], s64 offen offset:2048 sc1
v_mfma_f32_16x16x32_bf16 v[152:155], v[32:35], a[212:215], v[152:155]
ds_read_b64_tr_b16 v[46:47], v17 offset:2048
v_mfma_f32_16x16x32_bf16 v[152:155], v[28:31], a[196:199], v[152:155]
v_mfma_f32_16x16x32_bf16 v[156:159], v[28:31], a[200:203], v[156:159]
ds_read_b64_tr_b16 v[48:49], v17 offset:4096
v_mfma_f32_16x16x32_bf16 v[156:159], v[32:35], a[216:219], v[156:159]
v_mfma_f32_16x16x32_bf16 v[160:163], v[32:35], a[220:223], v[160:163]
ds_read_b64_tr_b16 v[50:51], v17 offset:6144
v_mfma_f32_16x16x32_bf16 v[160:163], v[28:31], a[204:207], v[160:163]
s_waitcnt lgkmcnt(4)
v_mfma_f32_16x16x32_bf16 v[176:179], v[36:39], a[204:207], v[176:179]
ds_read_b64_tr_b16 v[28:29], v17 offset:8192
v_mfma_f32_16x16x32_bf16 v[176:179], v[40:43], a[220:223], v[176:179]
v_mfma_f32_16x16x32_bf16 v[172:175], v[40:43], a[216:219], v[172:175]
ds_read_b64_tr_b16 v[30:31], v17 offset:10240
v_mfma_f32_16x16x32_bf16 v[172:175], v[36:39], a[200:203], v[172:175]
v_mfma_f32_16x16x32_bf16 v[168:171], v[36:39], a[196:199], v[168:171]
ds_read_b64_tr_b16 v[32:33], v17 offset:12288
v_mfma_f32_16x16x32_bf16 v[168:171], v[40:43], a[212:215], v[168:171]
v_mfma_f32_16x16x32_bf16 v[164:167], v[40:43], a[208:211], v[164:167]
ds_read_b64_tr_b16 v[34:35], v17 offset:14336
v_mfma_f32_16x16x32_bf16 v[164:167], v[36:39], a[192:195], v[164:167]
s_waitcnt lgkmcnt(4)
v_mfma_f32_16x16x32_bf16 v[52:55], v[44:47], a[224:227], v[52:55]
s_add_u32 m0, s34, 32768
ds_read_b64_tr_b16 v[36:37], v18 offset:0
v_mfma_f32_16x16x32_bf16 v[52:55], v[48:51], a[240:243], v[52:55]
buffer_load_dwordx4 v8, s[20:23], s62 offen offset:0 sc1 lds
v_mfma_f32_16x16x32_bf16 v[56:59], v[48:51], a[244:247], v[56:59]
ds_read_b64_tr_b16 v[38:39], v18 offset:2048
v_mfma_f32_16x16x32_bf16 v[56:59], v[44:47], a[228:231], v[56:59]
v_mfma_f32_16x16x32_bf16 v[60:63], v[44:47], a[232:235], v[60:63]
ds_read_b64_tr_b16 v[40:41], v18 offset:4096
v_mfma_f32_16x16x32_bf16 v[60:63], v[48:51], a[248:251], v[60:63]
buffer_load_dwordx4 v9, s[20:23], s62 offen offset:1024 sc1 lds
v_mfma_f32_16x16x32_bf16 v[64:67], v[48:51], a[252:255], v[64:67]
ds_read_b64_tr_b16 v[42:43], v18 offset:6144
v_mfma_f32_16x16x32_bf16 v[64:67], v[44:47], a[236:239], v[64:67]
s_waitcnt lgkmcnt(4)
v_mfma_f32_16x16x32_bf16 v[80:83], v[28:31], a[236:239], v[80:83]
ds_read_b64_tr_b16 v[44:45], v18 offset:8192
v_mfma_f32_16x16x32_bf16 v[80:83], v[32:35], a[252:255], v[80:83]
buffer_load_dwordx4 v10, s[20:23], s62 offen offset:2048 sc1 lds
v_mfma_f32_16x16x32_bf16 v[76:79], v[32:35], a[248:251], v[76:79]
ds_read_b64_tr_b16 v[46:47], v18 offset:10240
v_mfma_f32_16x16x32_bf16 v[76:79], v[28:31], a[232:235], v[76:79]
v_mfma_f32_16x16x32_bf16 v[72:75], v[28:31], a[228:231], v[72:75]
ds_read_b64_tr_b16 v[48:49], v18 offset:12288
v_mfma_f32_16x16x32_bf16 v[72:75], v[32:35], a[244:247], v[72:75]
buffer_load_dwordx4 v11, s[20:23], s62 offen offset:3072 sc1 lds
v_mfma_f32_16x16x32_bf16 v[68:71], v[32:35], a[240:243], v[68:71]
s_add_u32 s62, s62, 294912
ds_read_b64_tr_b16 v[50:51], v18 offset:14336
s_add_u32 m0, s35, 49152
v_mfma_f32_16x16x32_bf16 v[68:71], v[28:31], a[224:227], v[68:71]
s_waitcnt lgkmcnt(4)
v_mfma_f32_16x16x32_bf16 v[84:87], v[36:39], a[224:227], v[84:87]
s_waitcnt vmcnt(16)
ds_read_b64_tr_b16 v[28:29], v17 offset:16384
v_add_f32 v4, v246, v248
v_mfma_f32_16x16x32_bf16 v[84:87], v[40:43], a[240:243], v[84:87]
buffer_load_dwordx4 v1, s[28:31], s69 offen sc1 lds
v_mfma_f32_16x16x32_bf16 v[88:91], v[40:43], a[244:247], v[88:91]
s_add_u32 m0, s35, 53248
ds_read_b64_tr_b16 v[30:31], v17 offset:18432
v_add_f32 v252, v252, v254
v_mfma_f32_16x16x32_bf16 v[88:91], v[36:39], a[228:231], v[88:91]
v_add_f32 v4, v4, v252
v_add_f32 v5, v247, v249
v_mfma_f32_16x16x32_bf16 v[92:95], v[36:39], a[232:235], v[92:95]
ds_read_b64_tr_b16 v[32:33], v17 offset:20480
v_add_f32 v253, v253, v255
v_mfma_f32_16x16x32_bf16 v[92:95], v[40:43], a[248:251], v[92:95]
buffer_load_dwordx4 v1, s[28:31], s70 offen sc1 lds
v_mfma_f32_16x16x32_bf16 v[96:99], v[40:43], a[252:255], v[96:99]
ds_read_b64_tr_b16 v[34:35], v17 offset:22528
v_add_f32 v5, v5, v253
v_mfma_f32_16x16x32_bf16 v[96:99], v[36:39], a[236:239], v[96:99]
s_waitcnt lgkmcnt(4)
v_mov_b32 v246, v4
v_mov_b32 v247, v5
v_mfma_f32_16x16x32_bf16 v[112:115], v[44:47], a[236:239], v[112:115]
ds_read_b64_tr_b16 v[36:37], v17 offset:24576
v_mov_b32 v248, 0x3727c5ac
v_mfma_f32_16x16x32_bf16 v[112:115], v[48:51], a[252:255], v[112:115]
buffer_load_dword v27, v26, s[28:31], s64 offen offset:3072 sc1
v_mfma_f32_16x16x32_bf16 v[108:111], v[48:51], a[248:251], v[108:111]
ds_read_b64_tr_b16 v[38:39], v17 offset:26624
v_mfma_f32_16x16x32_bf16 v[108:111], v[44:47], a[232:235], v[108:111]
v_permlane16_swap_b32 v246, v4
v_mfma_f32_16x16x32_bf16 v[104:107], v[44:47], a[228:231], v[104:107]
ds_read_b64_tr_b16 v[40:41], v17 offset:28672
v_mfma_f32_16x16x32_bf16 v[104:107], v[48:51], a[244:247], v[104:107]
v_permlane16_swap_b32 v247, v5
v_mfma_f32_16x16x32_bf16 v[100:103], v[48:51], a[240:243], v[100:103]
ds_read_b64_tr_b16 v[42:43], v17 offset:30720
v_add_f32 v4, v4, v246
v_mfma_f32_16x16x32_bf16 v[100:103], v[44:47], a[224:227], v[100:103]
s_waitcnt lgkmcnt(4)
v_add_f32 v5, v5, v247
v_mov_b32 v246, v4
v_mfma_f32_16x16x32_bf16 v[52:55], v[28:31], v[212:215], v[52:55]
ds_read_b64_tr_b16 v[44:45], v18 offset:16384
v_mov_b32 v247, v5
v_mfma_f32_16x16x32_bf16 v[52:55], v[32:35], v[228:231], v[52:55]
v_mov_b32 v248, 0x3727c5ac
v_mfma_f32_16x16x32_bf16 v[56:59], v[32:35], v[232:235], v[56:59]
ds_read_b64_tr_b16 v[46:47], v18 offset:18432
v_mfma_f32_16x16x32_bf16 v[56:59], v[28:31], v[216:219], v[56:59]
v_permlane32_swap_b32 v246, v4
v_mfma_f32_16x16x32_bf16 v[60:63], v[28:31], v[220:223], v[60:63]
ds_read_b64_tr_b16 v[48:49], v18 offset:20480
v_mfma_f32_16x16x32_bf16 v[60:63], v[32:35], v[236:239], v[60:63]
v_permlane32_swap_b32 v247, v5
v_mfma_f32_16x16x32_bf16 v[64:67], v[32:35], v[240:243], v[64:67]
ds_read_b64_tr_b16 v[50:51], v18 offset:22528
v_add_f32 v4, v4, v246
v_mfma_f32_16x16x32_bf16 v[64:67], v[28:31], v[224:227], v[64:67]
s_waitcnt lgkmcnt(4)
v_add_f32 v5, v5, v247
v_fma_f32 v4, v4, s96, v248
v_mfma_f32_16x16x32_bf16 v[68:71], v[36:39], v[212:215], v[68:71]
ds_read_b64_tr_b16 v[28:29], v18 offset:24576
v_fma_f32 v5, v5, s96, v248
v_mfma_f32_16x16x32_bf16 v[68:71], v[40:43], v[228:231], v[68:71]
v_rcp_f32 v4, v4
v_mfma_f32_16x16x32_bf16 v[72:75], v[40:43], v[232:235], v[72:75]
ds_read_b64_tr_b16 v[30:31], v18 offset:26624
v_mfma_f32_16x16x32_bf16 v[72:75], v[36:39], v[216:219], v[72:75]
v_rcp_f32 v5, v5
v_mfma_f32_16x16x32_bf16 v[76:79], v[36:39], v[220:223], v[76:79]
ds_read_b64_tr_b16 v[32:33], v18 offset:28672
v_mfma_f32_16x16x32_bf16 v[76:79], v[40:43], v[236:239], v[76:79]
v_mfma_f32_16x16x32_bf16 v[80:83], v[40:43], v[240:243], v[80:83]
ds_read_b64_tr_b16 v[34:35], v18 offset:30720
v_mfma_f32_16x16x32_bf16 v[80:83], v[36:39], v[224:227], v[80:83]
s_waitcnt lgkmcnt(4)
s_barrier
v_mfma_f32_16x16x32_bf16 v[84:87], v[44:47], v[212:215], v[84:87]
s_waitcnt vmcnt(9)
ds_read_b64_tr_b16 v[36:37], v19 offset:0
v_cmp_eq_u32 vcc, 1, v23
v_mfma_f32_16x16x32_bf16 v[84:87], v[48:51], v[228:231], v[84:87]
v_mfma_f32_16x16x32_bf16 v[88:91], v[48:51], v[232:235], v[88:91]
s_cmp_eq_u64 vcc, exec
s_cbranch_scc0 sequential_preLN__linear_kernel_hedgehog__glu_gated_bilinear__prompt_kernel_f_slow0
sequential_preLN__linear_kernel_hedgehog__glu_gated_bilinear__prompt_kernel_f_back0:
ds_read_b64_tr_b16 v[38:39], v19 offset:2048
v_mfma_f32_16x16x32_bf16 v[88:91], v[44:47], v[216:219], v[88:91]
v_mul_f32 v52, v52, v68
v_mul_f32 v53, v53, v69
v_mfma_f32_16x16x32_bf16 v[92:95], v[44:47], v[220:223], v[92:95]
ds_read_b64_tr_b16 v[40:41], v19 offset:4096
v_mul_f32 v54, v54, v70
v_mfma_f32_16x16x32_bf16 v[92:95], v[48:51], v[236:239], v[92:95]
v_mul_f32 v55, v55, v71
v_cvt_pk_bf16_f32 v52, v52, v53
v_mfma_f32_16x16x32_bf16 v[96:99], v[48:51], v[240:243], v[96:99]
ds_read_b64_tr_b16 v[42:43], v19 offset:6144
v_cvt_pk_bf16_f32 v53, v54, v55
v_mfma_f32_16x16x32_bf16 v[96:99], v[44:47], v[224:227], v[96:99]
s_waitcnt lgkmcnt(4)
v_mul_f32 v56, v56, v72
v_mul_f32 v57, v57, v73
v_mfma_f32_16x16x32_bf16 v[100:103], v[28:31], v[212:215], v[100:103]
ds_read_b64_tr_b16 v[44:45], v19 offset:8192
v_mul_f32 v58, v58, v74
v_mfma_f32_16x16x32_bf16 v[100:103], v[32:35], v[228:231], v[100:103]
v_mul_f32 v59, v59, v75
v_cvt_pk_bf16_f32 v56, v56, v57
v_mfma_f32_16x16x32_bf16 v[104:107], v[32:35], v[232:235], v[104:107]
ds_read_b64_tr_b16 v[46:47], v19 offset:10240
v_cvt_pk_bf16_f32 v57, v58, v59
v_mfma_f32_16x16x32_bf16 v[104:107], v[28:31], v[216:219], v[104:107]
v_mul_f32 v60, v60, v76
v_mul_f32 v61, v61, v77
v_mfma_f32_16x16x32_bf16 v[108:111], v[28:31], v[220:223], v[108:111]
ds_read_b64_tr_b16 v[48:49], v19 offset:12288
v_mul_f32 v62, v62, v78
v_mfma_f32_16x16x32_bf16 v[108:111], v[32:35], v[236:239], v[108:111]
v_mul_f32 v63, v63, v79
v_cvt_pk_bf16_f32 v60, v60, v61
v_mfma_f32_16x16x32_bf16 v[112:115], v[32:35], v[240:243], v[112:115]
ds_read_b64_tr_b16 v[50:51], v19 offset:14336
v_cvt_pk_bf16_f32 v61, v62, v63
v_mfma_f32_16x16x32_bf16 v[112:115], v[28:31], v[224:227], v[112:115]
s_waitcnt lgkmcnt(4)
v_mul_f32 v64, v64, v80
v_mul_f32 v65, v65, v81
v_mfma_f32_16x16x32_bf16 v[116:119], v[36:39], a[224:227], v[116:119]
s_add_u32 m0, s34, 49152
ds_read_b64_tr_b16 v[28:29], v20 offset:0
v_mul_f32 v66, v66, v82
v_mfma_f32_16x16x32_bf16 v[116:119], v[40:43], a[240:243], v[116:119]
buffer_load_dwordx4 v8, s[20:23], s63 offen offset:0 sc1 lds
v_mfma_f32_16x16x32_bf16 v[120:123], v[40:43], a[244:247], v[120:123]
ds_read_b64_tr_b16 v[30:31], v20 offset:2048
v_mul_f32 v67, v67, v83
v_mfma_f32_16x16x32_bf16 v[120:123], v[36:39], a[228:231], v[120:123]
v_cvt_pk_bf16_f32 v64, v64, v65
v_cvt_pk_bf16_f32 v65, v66, v67
v_mfma_f32_16x16x32_bf16 v[124:127], v[36:39], a[232:235], v[124:127]
ds_read_b64_tr_b16 v[32:33], v20 offset:4096
v_mul_f32 v84, v84, v100
v_mfma_f32_16x16x32_bf16 v[124:127], v[40:43], a[248:251], v[124:127]
buffer_load_dwordx4 v9, s[20:23], s63 offen offset:1024 sc1 lds
v_mfma_f32_16x16x32_bf16 v[128:131], v[40:43], a[252:255], v[128:131]
ds_read_b64_tr_b16 v[34:35], v20 offset:6144
v_mul_f32 v85, v85, v101
v_mfma_f32_16x16x32_bf16 v[128:131], v[36:39], a[236:239], v[128:131]
s_waitcnt lgkmcnt(4)
v_mul_f32 v86, v86, v102
v_mul_f32 v87, v87, v103
v_mfma_f32_16x16x32_bf16 v[144:147], v[44:47], a[236:239], v[144:147]
ds_read_b64_tr_b16 v[36:37], v20 offset:8192
v_cvt_pk_bf16_f32 v54, v84, v85
v_mfma_f32_16x16x32_bf16 v[144:147], v[48:51], a[252:255], v[144:147]
buffer_load_dwordx4 v10, s[20:23], s63 offen offset:2048 sc1 lds
v_mfma_f32_16x16x32_bf16 v[140:143], v[48:51], a[248:251], v[140:143]
ds_read_b64_tr_b16 v[38:39], v20 offset:10240
v_cvt_pk_bf16_f32 v55, v86, v87
v_mfma_f32_16x16x32_bf16 v[140:143], v[44:47], a[232:235], v[140:143]
v_mul_f32 v88, v88, v104
v_mul_f32 v89, v89, v105
v_mfma_f32_16x16x32_bf16 v[136:139], v[44:47], a[228:231], v[136:139]
ds_read_b64_tr_b16 v[40:41], v20 offset:12288
v_mul_f32 v90, v90, v106
v_mfma_f32_16x16x32_bf16 v[136:139], v[48:51], a[244:247], v[136:139]
buffer_store_dwordx4 v[52:55], v1, s[28:31], s45 offen offset:0 sc1
v_mul_f32 v91, v91, v107
v_mfma_f32_16x16x32_bf16 v[132:135], v[48:51], a[240:243], v[132:135]
ds_read_b64_tr_b16 v[42:43], v20 offset:14336
v_cvt_pk_bf16_f32 v58, v88, v89
v_mfma_f32_16x16x32_bf16 v[132:135], v[44:47], a[224:227], v[132:135]
s_waitcnt lgkmcnt(4)
v_cvt_pk_bf16_f32 v59, v90, v91
v_mul_f32 v92, v92, v108
v_mfma_f32_16x16x32_bf16 v[148:151], v[28:31], a[224:227], v[148:151]
ds_read_b64_tr_b16 v[44:45], v19 offset:16384
v_mul_f32 v93, v93, v109
v_mfma_f32_16x16x32_bf16 v[148:151], v[32:35], a[240:243], v[148:151]
s_branch iskip9
.p2align 12
ipad9:
s_branch ipad13
s_nop 0
iskip9:
buffer_load_dwordx4 v11, s[20:23], s63 offen offset:3072 sc1 lds
v_mfma_f32_16x16x32_bf16 v[152:155], v[32:35], a[244:247], v[152:155]
s_add_u32 s63, s63, 294912
ds_read_b64_tr_b16 v[46:47], v19 offset:18432
v_mul_f32 v94, v94, v110
v_mfma_f32_16x16x32_bf16 v[152:155], v[28:31], a[228:231], v[152:155]
v_mul_f32 v95, v95, v111
v_cvt_pk_bf16_f32 v62, v92, v93
v_mfma_f32_16x16x32_bf16 v[156:159], v[28:31], a[232:235], v[156:159]
ds_read_b64_tr_b16 v[48:49], v19 offset:20480
v_cvt_pk_bf16_f32 v63, v94, v95
v_mfma_f32_16x16x32_bf16 v[156:159], v[32:35], a[248:251], v[156:159]
v_mul_f32 v96, v96, v112
v_mul_f32 v97, v97, v113
v_mfma_f32_16x16x32_bf16 v[160:163], v[32:35], a[252:255], v[160:163]
ds_read_b64_tr_b16 v[50:51], v19 offset:22528
v_mul_f32 v98, v98, v114
v_mfma_f32_16x16x32_bf16 v[160:163], v[28:31], a[236:239], v[160:163]
s_waitcnt lgkmcnt(4)
v_mul_f32 v99, v99, v115
v_cvt_pk_bf16_f32 v66, v96, v97
v_mfma_f32_16x16x32_bf16 v[176:179], v[36:39], a[236:239], v[176:179]
ds_read_b64_tr_b16 v[28:29], v19 offset:24576
v_cvt_pk_bf16_f32 v67, v98, v99
v_mfma_f32_16x16x32_bf16 v[176:179], v[40:43], a[252:255], v[176:179]
v_mfma_f32_16x16x32_bf16 v[172:175], v[40:43], a[248:251], v[172:175]
ds_read_b64_tr_b16 v[30:31], v19 offset:26624
v_mfma_f32_16x16x32_bf16 v[172:175], v[36:39], a[232:235], v[172:175]
v_mfma_f32_16x16x32_bf16 v[168:171], v[36:39], a[228:231], v[168:171]
ds_read_b64_tr_b16 v[32:33], v19 offset:28672
v_mfma_f32_16x16x32_bf16 v[168:171], v[40:43], a[244:247], v[168:171]
buffer_store_dwordx4 v[56:59], v1, s[28:31], s45 offen offset:1024 sc1
v_mfma_f32_16x16x32_bf16 v[164:167], v[40:43], a[240:243], v[164:167]
ds_read_b64_tr_b16 v[34:35], v19 offset:30720
v_mfma_f32_16x16x32_bf16 v[164:167], v[36:39], a[224:227], v[164:167]
s_waitcnt lgkmcnt(4)
v_mfma_f32_16x16x32_bf16 v[116:119], v[44:47], v[212:215], v[116:119]
ds_read_b64_tr_b16 v[36:37], v20 offset:16384
v_mfma_f32_16x16x32_bf16 v[116:119], v[48:51], v[228:231], v[116:119]
v_mfma_f32_16x16x32_bf16 v[120:123], v[48:51], v[232:235], v[120:123]
ds_read_b64_tr_b16 v[38:39], v20 offset:18432
v_mfma_f32_16x16x32_bf16 v[120:123], v[44:47], v[216:219], v[120:123]
v_mfma_f32_16x16x32_bf16 v[124:127], v[44:47], v[220:223], v[124:127]
ds_read_b64_tr_b16 v[40:41], v20 offset:20480
v_mfma_f32_16x16x32_bf16 v[124:127], v[48:51], v[236:239], v[124:127]
v_mfma_f32_16x16x32_bf16 v[128:131], v[48:51], v[240:243], v[128:131]
ds_read_b64_tr_b16 v[42:43], v20 offset:22528
v_mfma_f32_16x16x32_bf16 v[128:131], v[44:47], v[224:227], v[128:131]
s_waitcnt lgkmcnt(4)
v_mfma_f32_16x16x32_bf16 v[132:135], v[28:31], v[212:215], v[132:135]
ds_read_b64_tr_b16 v[44:45], v20 offset:24576
v_mfma_f32_16x16x32_bf16 v[132:135], v[32:35], v[228:231], v[132:135]
v_mfma_f32_16x16x32_bf16 v[136:139], v[32:35], v[232:235], v[136:139]
ds_read_b64_tr_b16 v[46:47], v20 offset:26624
v_mfma_f32_16x16x32_bf16 v[136:139], v[28:31], v[216:219], v[136:139]
v_mfma_f32_16x16x32_bf16 v[140:143], v[28:31], v[220:223], v[140:143]
ds_read_b64_tr_b16 v[48:49], v20 offset:28672
v_mfma_f32_16x16x32_bf16 v[140:143], v[32:35], v[236:239], v[140:143]
buffer_store_dwordx4 v[60:63], v1, s[28:31], s45 offen offset:2048 sc1
v_mfma_f32_16x16x32_bf16 v[144:147], v[32:35], v[240:243], v[144:147]
ds_read_b64_tr_b16 v[50:51], v20 offset:30720
v_mfma_f32_16x16x32_bf16 v[144:147], v[28:31], v[224:227], v[144:147]
s_waitcnt lgkmcnt(4)
s_barrier
v_mfma_f32_16x16x32_bf16 v[148:151], v[36:39], v[212:215], v[148:151]
s_add_u32 m0, s34, 65536
ds_read_b64_tr_b16 v[28:29], v21 offset:0
v_mul_f32 v116, v116, v132
v_mfma_f32_16x16x32_bf16 v[148:151], v[40:43], v[228:231], v[148:151]
buffer_load_dwordx4 v8, s[20:23], s60 offen offset:0 sc1 lds
v_mfma_f32_16x16x32_bf16 v[152:155], v[40:43], v[232:235], v[152:155]
ds_read_b64_tr_b16 v[30:31], v21 offset:512
v_mul_f32 v117, v117, v133
v_mfma_f32_16x16x32_bf16 v[152:155], v[36:39], v[216:219], v[152:155]
v_mul_f32 v118, v118, v134
v_mul_f32 v119, v119, v135
v_mfma_f32_16x16x32_bf16 v[156:159], v[36:39], v[220:223], v[156:159]
ds_read_b64_tr_b16 v[32:33], v21 offset:1024
v_cvt_pk_bf16_f32 v116, v116, v117
v_mfma_f32_16x16x32_bf16 v[156:159], v[40:43], v[236:239], v[156:159]
buffer_load_dwordx4 v9, s[20:23], s60 offen offset:1024 sc1 lds
v_mfma_f32_16x16x32_bf16 v[160:163], v[40:43], v[240:243], v[160:163]
ds_read_b64_tr_b16 v[34:35], v21 offset:1536
v_cvt_pk_bf16_f32 v117, v118, v119
v_mfma_f32_16x16x32_bf16 v[160:163], v[36:39], v[224:227], v[160:163]
s_waitcnt lgkmcnt(4)
v_mul_f32 v120, v120, v136
v_mul_f32 v121, v121, v137
v_mfma_f32_16x16x32_bf16 v[164:167], v[44:47], v[212:215], v[164:167]
ds_read_b64_tr_b16 v[36:37], v21 offset:2048
v_mul_f32 v122, v122, v138
v_mfma_f32_16x16x32_bf16 v[164:167], v[48:51], v[228:231], v[164:167]
buffer_load_dwordx4 v10, s[20:23], s60 offen offset:2048 sc1 lds
v_mfma_f32_16x16x32_bf16 v[168:171], v[48:51], v[232:235], v[168:171]
ds_read_b64_tr_b16 v[38:39], v21 offset:2560
v_mul_f32 v123, v123, v139
v_mfma_f32_16x16x32_bf16 v[168:171], v[44:47], v[216:219], v[168:171]
v_cvt_pk_bf16_f32 v120, v120, v121
v_cvt_pk_bf16_f32 v121, v122, v123
v_mfma_f32_16x16x32_bf16 v[172:175], v[44:47], v[220:223], v[172:175]
ds_read_b64_tr_b16 v[40:41], v21 offset:3072
v_mul_f32 v124, v124, v140
v_mfma_f32_16x16x32_bf16 v[172:175], v[48:51], v[236:239], v[172:175]
buffer_store_dwordx4 v[64:67], v1, s[28:31], s45 offen offset:3072 sc1
v_mul_f32 v125, v125, v141
v_mfma_f32_16x16x32_bf16 v[176:179], v[48:51], v[240:243], v[176:179]
s_add_u32 s45, s45, 4096
ds_read_b64_tr_b16 v[42:43], v21 offset:3584
v_mul_f32 v126, v126, v142
v_mfma_f32_16x16x32_bf16 v[176:179], v[44:47], v[224:227], v[176:179]
s_waitcnt lgkmcnt(4)
v_mul_f32 v127, v127, v143
v_cvt_pk_bf16_f32 v124, v124, v125
v_mfma_f32_16x16x32_bf16 v[84:87], v[28:31], a[0:3], 0
ds_read_b64_tr_b16 v[44:45], v21 offset:4096
v_cvt_pk_bf16_f32 v125, v126, v127
v_mfma_f32_16x16x32_bf16 v[84:87], v[32:35], a[16:19], v[84:87]
buffer_load_dwordx4 v11, s[20:23], s60 offen offset:3072 sc1 lds
v_mfma_f32_16x16x32_bf16 v[88:91], v[32:35], a[20:23], 0
ds_read_b64_tr_b16 v[46:47], v21 offset:4608
v_mul_f32 v128, v128, v144
v_mfma_f32_16x16x32_bf16 v[88:91], v[28:31], a[4:7], v[88:91]
v_mul_f32 v129, v129, v145
v_mul_f32 v130, v130, v146
v_mfma_f32_16x16x32_bf16 v[92:95], v[28:31], a[8:11], 0
ds_read_b64_tr_b16 v[48:49], v21 offset:5120
v_mul_f32 v131, v131, v147
v_mfma_f32_16x16x32_bf16 v[92:95], v[32:35], a[24:27], v[92:95]
v_cvt_pk_bf16_f32 v128, v128, v129
v_cvt_pk_bf16_f32 v129, v130, v131
v_mfma_f32_16x16x32_bf16 v[96:99], v[32:35], a[28:31], 0
ds_read_b64_tr_b16 v[50:51], v21 offset:5632
v_mul_f32 v148, v148, v164
v_mfma_f32_16x16x32_bf16 v[96:99], v[28:31], a[12:15], v[96:99]
s_waitcnt lgkmcnt(4)
v_mul_f32 v149, v149, v165
v_mul_f32 v150, v150, v166
v_mfma_f32_16x16x32_bf16 v[100:103], v[36:39], a[0:3], 0
ds_read_b64_tr_b16 v[28:29], v21 offset:6144
v_mul_f32 v151, v151, v167
v_mfma_f32_16x16x32_bf16 v[100:103], v[40:43], a[16:19], v[100:103]
v_cvt_pk_bf16_f32 v118, v148, v149
v_cvt_pk_bf16_f32 v119, v150, v151
v_mfma_f32_16x16x32_bf16 v[104:107], v[40:43], a[20:23], 0
ds_read_b64_tr_b16 v[30:31], v21 offset:6656
v_mul_f32 v152, v152, v168
v_mfma_f32_16x16x32_bf16 v[104:107], v[36:39], a[4:7], v[104:107]
v_mul_f32 v153, v153, v169
v_mul_f32 v154, v154, v170
v_mfma_f32_16x16x32_bf16 v[108:111], v[36:39], a[8:11], 0
ds_read_b64_tr_b16 v[32:33], v21 offset:7168
v_mul_f32 v155, v155, v171
v_mfma_f32_16x16x32_bf16 v[108:111], v[40:43], a[24:27], v[108:111]
buffer_store_dwordx4 v[116:119], v1, s[28:31], s45 offen offset:0 sc1
v_cvt_pk_bf16_f32 v122, v152, v153
v_mfma_f32_16x16x32_bf16 v[112:115], v[40:43], a[28:31], 0
ds_read_b64_tr_b16 v[34:35], v21 offset:7680
v_cvt_pk_bf16_f32 v123, v154, v155
v_mfma_f32_16x16x32_bf16 v[112:115], v[36:39], a[12:15], v[112:115]
s_waitcnt lgkmcnt(4)
v_mul_f32 v156, v156, v172
v_mul_f32 v157, v157, v173
v_mfma_f32_16x16x32_bf16 v[84:87], v[44:47], a[32:35], v[84:87]
ds_read_b64_tr_b16 v[36:37], v21 offset:8192
v_mul_f32 v158, v158, v174
v_mfma_f32_16x16x32_bf16 v[84:87], v[48:51], a[48:51], v[84:87]
v_mul_f32 v159, v159, v175
v_cvt_pk_bf16_f32 v126, v156, v157
v_mfma_f32_16x16x32_bf16 v[88:91], v[48:51], a[52:55], v[88:91]
ds_read_b64_tr_b16 v[38:39], v21 offset:8704
v_cvt_pk_bf16_f32 v127, v158, v159
v_mfma_f32_16x16x32_bf16 v[88:91], v[44:47], a[36:39], v[88:91]
v_mul_f32 v160, v160, v176
v_mul_f32 v161, v161, v177
v_mfma_f32_16x16x32_bf16 v[92:95], v[44:47], a[40:43], v[92:95]
ds_read_b64_tr_b16 v[40:41], v21 offset:9216
v_mul_f32 v162, v162, v178
v_mfma_f32_16x16x32_bf16 v[92:95], v[48:51], a[56:59], v[92:95]
v_mul_f32 v163, v163, v179
v_cvt_pk_bf16_f32 v130, v160, v161
v_mfma_f32_16x16x32_bf16 v[96:99], v[48:51], a[60:63], v[96:99]
ds_read_b64_tr_b16 v[42:43], v21 offset:9728
v_cvt_pk_bf16_f32 v131, v162, v163
v_mfma_f32_16x16x32_bf16 v[96:99], v[44:47], a[44:47], v[96:99]
s_waitcnt lgkmcnt(4)
v_accvgpr_write_b32 a0, v180
v_accvgpr_write_b32 a1, v181
v_mfma_f32_16x16x32_bf16 v[112:115], v[28:31], a[44:47], v[112:115]
ds_read_b64_tr_b16 v[44:45], v21 offset:10240
v_accvgpr_write_b32 a2, v182
v_mfma_f32_16x16x32_bf16 v[112:115], v[32:35], a[60:63], v[112:115]
v_accvgpr_write_b32 a3, v183
v_accvgpr_write_b32 a4, v184
v_mfma_f32_16x16x32_bf16 v[108:111], v[32:35], a[56:59], v[108:111]
ds_read_b64_tr_b16 v[46:47], v21 offset:10752
v_accvgpr_write_b32 a5, v185
v_mfma_f32_16x16x32_bf16 v[108:111], v[28:31], a[40:43], v[108:111]
v_accvgpr_write_b32 a6, v186
v_accvgpr_write_b32 a7, v187
v_mfma_f32_16x16x32_bf16 v[104:107], v[28:31], a[36:39], v[104:107]
ds_read_b64_tr_b16 v[48:49], v21 offset:11264
v_accvgpr_write_b32 a8, v188
v_mfma_f32_16x16x32_bf16 v[104:107], v[32:35], a[52:55], v[104:107]
buffer_store_dwordx4 v[120:123], v1, s[28:31], s45 offen offset:1024 sc1
v_accvgpr_write_b32 a9, v189
v_mfma_f32_16x16x32_bf16 v[100:103], v[32:35], a[48:51], v[100:103]
ds_read_b64_tr_b16 v[50:51], v21 offset:11776
v_accvgpr_write_b32 a10, v190
v_mfma_f32_16x16x32_bf16 v[100:103], v[28:31], a[32:35], v[100:103]
s_waitcnt lgkmcnt(4)
v_accvgpr_write_b32 a11, v191
v_accvgpr_write_b32 a12, v192
v_mfma_f32_16x16x32_bf16 v[84:87], v[36:39], a[64:67], v[84:87]
ds_read_b64_tr_b16 v[28:29], v21 offset:12288
v_accvgpr_write_b32 a13, v193
v_mfma_f32_16x16x32_bf16 v[84:87], v[40:43], a[80:83], v[84:87]
buffer_load_dwordx4 a[32:35], v1, s[28:31], s65 offen offset:0 sc1
v_mfma_f32_16x16x32_bf16 v[88:91], v[40:43], a[84:87], v[88:91]
ds_read_b64_tr_b16 v[30:31], v21 offset:12800
v_accvgpr_write_b32 a14, v194
v_mfma_f32_16x16x32_bf16 v[88:91], v[36:39], a[68:71], v[88:91]
v_accvgpr_write_b32 a15, v195
v_accvgpr_write_b32 a16, v196
v_mfma_f32_16x16x32_bf16 v[92:95], v[36:39], a[72:75], v[92:95]
ds_read_b64_tr_b16 v[32:33], v21 offset:13312
v_accvgpr_write_b32 a17, v197
v_mfma_f32_16x16x32_bf16 v[92:95], v[40:43], a[88:91], v[92:95]
v_accvgpr_write_b32 a18, v198
v_accvgpr_write_b32 a19, v199
v_mfma_f32_16x16x32_bf16 v[96:99], v[40:43], a[92:95], v[96:99]
ds_read_b64_tr_b16 v[34:35], v21 offset:13824
v_accvgpr_write_b32 a20, v200
v_mfma_f32_16x16x32_bf16 v[96:99], v[36:39], a[76:79], v[96:99]
s_waitcnt lgkmcnt(4)
buffer_load_dwordx4 a[36:39], v1, s[28:31], s65 offen offset:1024 sc1
v_mfma_f32_16x16x32_bf16 v[112:115], v[44:47], a[76:79], v[112:115]
ds_read_b64_tr_b16 v[36:37], v21 offset:14336
v_accvgpr_write_b32 a21, v201
v_mfma_f32_16x16x32_bf16 v[112:115], v[48:51], a[92:95], v[112:115]
v_accvgpr_write_b32 a22, v202
v_accvgpr_write_b32 a23, v203
v_mfma_f32_16x16x32_bf16 v[108:111], v[48:51], a[88:91], v[108:111]
ds_read_b64_tr_b16 v[38:39], v21 offset:14848
v_accvgpr_write_b32 a24, v204
v_mfma_f32_16x16x32_bf16 v[108:111], v[44:47], a[72:75], v[108:111]
v_accvgpr_write_b32 a25, v205
v_accvgpr_write_b32 a26, v206
v_mfma_f32_16x16x32_bf16 v[104:107], v[44:47], a[68:71], v[104:107]
ds_read_b64_tr_b16 v[40:41], v21 offset:15360
v_accvgpr_write_b32 a27, v207
v_mfma_f32_16x16x32_bf16 v[104:107], v[48:51], a[84:87], v[104:107]
buffer_store_dwordx4 v[124:127], v1, s[28:31], s45 offen offset:2048 sc1
v_accvgpr_write_b32 a28, v208
v_mfma_f32_16x16x32_bf16 v[100:103], v[48:51], a[80:83], v[100:103]
ds_read_b64_tr_b16 v[42:43], v21 offset:15872
v_accvgpr_write_b32 a29, v209
v_mfma_f32_16x16x32_bf16 v[100:103], v[44:47], a[64:67], v[100:103]
s_waitcnt lgkmcnt(4)
v_accvgpr_write_b32 a30, v210
v_accvgpr_write_b32 a31, v211
v_mfma_f32_16x16x32_bf16 v[84:87], v[28:31], a[96:99], v[84:87]
ds_read_b64_tr_b16 v[44:45], v21 offset:16384
v_mfma_f32_16x16x32_bf16 v[84:87], v[32:35], a[112:115], v[84:87]
buffer_load_dwordx4 a[40:43], v1, s[28:31], s65 offen offset:2048 sc1
v_mfma_f32_16x16x32_bf16 v[88:91], v[32:35], a[116:119], v[88:91]
ds_read_b64_tr_b16 v[46:47], v21 offset:16896
v_mfma_f32_16x16x32_bf16 v[88:91], v[28:31], a[100:103], v[88:91]
v_mfma_f32_16x16x32_bf16 v[92:95], v[28:31], a[104:107], v[92:95]
ds_read_b64_tr_b16 v[48:49], v21 offset:17408
v_mfma_f32_16x16x32_bf16 v[92:95], v[32:35], a[120:123], v[92:95]
v_mfma_f32_16x16x32_bf16 v[96:99], v[32:35], a[124:127], v[96:99]
ds_read_b64_tr_b16 v[50:51], v21 offset:17920
v_mfma_f32_16x16x32_bf16 v[96:99], v[28:31], a[108:111], v[96:99]
s_waitcnt lgkmcnt(4)
buffer_load_dwordx4 a[44:47], v1, s[28:31], s65 offen offset:3072 sc1
v_mfma_f32_16x16x32_bf16 v[112:115], v[36:39], a[108:111], v[112:115]
s_add_u32 s65, s65, 4096
ds_read_b64_tr_b16 v[28:29], v21 offset:18432
v_mfma_f32_16x16x32_bf16 v[112:115], v[40:43], a[124:127], v[112:115]
v_mfma_f32_16x16x32_bf16 v[108:111], v[40:43], a[120:123], v[108:111]
ds_read_b64_tr_b16 v[30:31], v21 offset:18944
v_mfma_f32_16x16x32_bf16 v[108:111], v[36:39], a[104:107], v[108:111]
v_mfma_f32_16x16x32_bf16 v[104:107], v[36:39], a[100:103], v[104:107]
ds_read_b64_tr_b16 v[32:33], v21 offset:19456
v_mfma_f32_16x16x32_bf16 v[104:107], v[40:43], a[116:119], v[104:107]
buffer_store_dwordx4 v[128:131], v1, s[28:31], s45 offen offset:3072 sc1
v_mfma_f32_16x16x32_bf16 v[100:103], v[40:43], a[112:115], v[100:103]
s_add_u32 s45, s45, 28672
ds_read_b64_tr_b16 v[34:35], v21 offset:19968
v_mfma_f32_16x16x32_bf16 v[100:103], v[36:39], a[96:99], v[100:103]
s_waitcnt lgkmcnt(4)
v_mfma_f32_16x16x32_bf16 v[84:87], v[44:47], a[128:131], v[84:87]
ds_read_b64_tr_b16 v[36:37], v21 offset:20480
v_mfma_f32_16x16x32_bf16 v[84:87], v[48:51], a[144:147], v[84:87]
buffer_load_dwordx4 a[48:51], v1, s[28:31], s65 offen offset:0 sc1
v_mfma_f32_16x16x32_bf16 v[88:91], v[48:51], a[148:151], v[88:91]
ds_read_b64_tr_b16 v[38:39], v21 offset:20992
v_mfma_f32_16x16x32_bf16 v[88:91], v[44:47], a[132:135], v[88:91]
v_mfma_f32_16x16x32_bf16 v[92:95], v[44:47], a[136:139], v[92:95]
ds_read_b64_tr_b16 v[40:41], v21 offset:21504
v_mfma_f32_16x16x32_bf16 v[92:95], v[48:51], a[152:155], v[92:95]
v_mfma_f32_16x16x32_bf16 v[96:99], v[48:51], a[156:159], v[96:99]
ds_read_b64_tr_b16 v[42:43], v21 offset:22016
v_mfma_f32_16x16x32_bf16 v[96:99], v[44:47], a[140:143], v[96:99]
s_waitcnt lgkmcnt(4)
buffer_load_dwordx4 a[52:55], v1, s[28:31], s65 offen offset:1024 sc1
v_mfma_f32_16x16x32_bf16 v[100:103], v[28:31], a[128:131], v[100:103]
ds_read_b64_tr_b16 v[44:45], v21 offset:22528
v_mfma_f32_16x16x32_bf16 v[100:103], v[32:35], a[144:147], v[100:103]
v_mfma_f32_16x16x32_bf16 v[104:107], v[32:35], a[148:151], v[104:107]
ds_read_b64_tr_b16 v[46:47], v21 offset:23040
v_mfma_f32_16x16x32_bf16 v[104:107], v[28:31], a[132:135], v[104:107]
v_mfma_f32_16x16x32_bf16 v[108:111], v[28:31], a[136:139], v[108:111]
ds_read_b64_tr_b16 v[48:49], v21 offset:23552
v_mfma_f32_16x16x32_bf16 v[108:111], v[32:35], a[152:155], v[108:111]
buffer_load_dwordx4 a[56:59], v1, s[28:31], s65 offen offset:2048 sc1
v_mfma_f32_16x16x32_bf16 v[112:115], v[32:35], a[156:159], v[112:115]
ds_read_b64_tr_b16 v[50:51], v21 offset:24064
v_mfma_f32_16x16x32_bf16 v[112:115], v[28:31], a[140:143], v[112:115]
s_waitcnt lgkmcnt(4)
v_mfma_f32_16x16x32_bf16 v[84:87], v[36:39], a[160:163], v[84:87]
ds_read_b64_tr_b16 v[28:29], v21 offset:24576
v_accvgpr_write_b32 a128, v52
v_mfma_f32_16x16x32_bf16 v[84:87], v[40:43], a[176:179], v[84:87]
v_accvgpr_write_b32 a129, v53
v_accvgpr_write_b32 a130, v54
v_mfma_f32_16x16x32_bf16 v[88:91], v[40:43], a[180:183], v[88:91]
ds_read_b64_tr_b16 v[30:31], v21 offset:25088
v_accvgpr_write_b32 a131, v55
v_mfma_f32_16x16x32_bf16 v[88:91], v[36:39], a[164:167], v[88:91]
buffer_load_dwordx4 a[60:63], v1, s[28:31], s65 offen offset:3072 sc1
v_mfma_f32_16x16x32_bf16 v[92:95], v[36:39], a[168:171], v[92:95]
s_add_u32 s65, s65, 28672
ds_read_b64_tr_b16 v[32:33], v21 offset:25600
v_accvgpr_write_b32 a132, v56
v_mfma_f32_16x16x32_bf16 v[92:95], v[40:43], a[184:187], v[92:95]
v_accvgpr_write_b32 a133, v57
v_accvgpr_write_b32 a134, v58
v_mfma_f32_16x16x32_bf16 v[96:99], v[40:43], a[188:191], v[96:99]
ds_read_b64_tr_b16 v[34:35], v21 offset:26112
v_accvgpr_write_b32 a135, v59
v_mfma_f32_16x16x32_bf16 v[96:99], v[36:39], a[172:175], v[96:99]
s_waitcnt lgkmcnt(4)
v_accvgpr_write_b32 a136, v60
v_accvgpr_write_b32 a137, v61
v_mfma_f32_16x16x32_bf16 v[112:115], v[44:47], a[172:175], v[112:115]
ds_read_b64_tr_b16 v[36:37], v21 offset:26624
v_accvgpr_write_b32 a138, v62
v_mfma_f32_16x16x32_bf16 v[112:115], v[48:51], a[188:191], v[112:115]
buffer_load_dwordx4 a[64:67], v1, s[28:31], s66 offen offset:0 sc1
v_mfma_f32_16x16x32_bf16 v[108:111], v[48:51], a[184:187], v[108:111]
ds_read_b64_tr_b16 v[38:39], v21 offset:27136
v_accvgpr_write_b32 a139, v63
v_mfma_f32_16x16x32_bf16 v[108:111], v[44:47], a[168:171], v[108:111]
v_accvgpr_write_b32 a140, v64
v_accvgpr_write_b32 a141, v65
v_mfma_f32_16x16x32_bf16 v[104:107], v[44:47], a[164:167], v[104:107]
ds_read_b64_tr_b16 v[40:41], v21 offset:27648
v_accvgpr_write_b32 a142, v66
v_mfma_f32_16x16x32_bf16 v[104:107], v[48:51], a[180:183], v[104:107]
v_accvgpr_write_b32 a143, v67
v_accvgpr_write_b32 a144, v116
v_mfma_f32_16x16x32_bf16 v[100:103], v[48:51], a[176:179], v[100:103]
ds_read_b64_tr_b16 v[42:43], v21 offset:28160
v_accvgpr_write_b32 a145, v117
v_mfma_f32_16x16x32_bf16 v[100:103], v[44:47], a[160:163], v[100:103]
s_waitcnt lgkmcnt(4)
buffer_load_dwordx4 a[68:71], v1, s[28:31], s66 offen offset:1024 sc1
v_mfma_f32_16x16x32_bf16 v[84:87], v[28:31], a[192:195], v[84:87]
ds_read_b64_tr_b16 v[44:45], v21 offset:28672
v_accvgpr_write_b32 a146, v118
v_mfma_f32_16x16x32_bf16 v[84:87], v[32:35], a[208:211], v[84:87]
v_accvgpr_write_b32 a147, v119
v_accvgpr_write_b32 a148, v120
v_mfma_f32_16x16x32_bf16 v[88:91], v[32:35], a[212:215], v[88:91]
ds_read_b64_tr_b16 v[46:47], v21 offset:29184
v_accvgpr_write_b32 a149, v121
v_mfma_f32_16x16x32_bf16 v[88:91], v[28:31], a[196:199], v[88:91]
v_accvgpr_write_b32 a150, v122
v_accvgpr_write_b32 a151, v123
v_mfma_f32_16x16x32_bf16 v[92:95], v[28:31], a[200:203], v[92:95]
ds_read_b64_tr_b16 v[48:49], v21 offset:29696
v_accvgpr_write_b32 a152, v124
v_mfma_f32_16x16x32_bf16 v[92:95], v[32:35], a[216:219], v[92:95]
buffer_load_dwordx4 a[72:75], v1, s[28:31], s66 offen offset:2048 sc1
v_mfma_f32_16x16x32_bf16 v[96:99], v[32:35], a[220:223], v[96:99]
ds_read_b64_tr_b16 v[50:51], v21 offset:30208
v_accvgpr_write_b32 a153, v125
v_mfma_f32_16x16x32_bf16 v[96:99], v[28:31], a[204:207], v[96:99]
s_waitcnt lgkmcnt(4)
v_accvgpr_write_b32 a154, v126
v_accvgpr_write_b32 a155, v127
v_mfma_f32_16x16x32_bf16 v[112:115], v[36:39], a[204:207], v[112:115]
ds_read_b64_tr_b16 v[28:29], v21 offset:30720
v_accvgpr_write_b32 a156, v128
v_mfma_f32_16x16x32_bf16 v[112:115], v[40:43], a[220:223], v[112:115]
v_accvgpr_write_b32 a157, v129
v_accvgpr_write_b32 a158, v130
v_mfma_f32_16x16x32_bf16 v[108:111], v[40:43], a[216:219], v[108:111]
ds_read_b64_tr_b16 v[30:31], v21 offset:31232
v_accvgpr_write_b32 a159, v131
v_mfma_f32_16x16x32_bf16 v[108:111], v[36:39], a[200:203], v[108:111]
buffer_load_dwordx4 a[76:79], v1, s[28:31], s66 offen offset:3072 sc1
v_mfma_f32_16x16x32_bf16 v[104:107], v[36:39], a[196:199], v[104:107]
s_add_u32 s66, s66, 4096
ds_read_b64_tr_b16 v[32:33], v21 offset:31744
v_mfma_f32_16x16x32_bf16 v[104:107], v[40:43], a[212:215], v[104:107]
v_mfma_f32_16x16x32_bf16 v[100:103], v[40:43], a[208:211], v[100:103]
ds_read_b64_tr_b16 v[34:35], v21 offset:32256
v_mfma_f32_16x16x32_bf16 v[100:103], v[36:39], a[192:195], v[100:103]
s_waitcnt lgkmcnt(4)
v_mfma_f32_16x16x32_bf16 v[84:87], v[44:47], a[224:227], v[84:87]
ds_read_b64_tr_b16 v[36:37], v21 offset:32768
v_mfma_f32_16x16x32_bf16 v[84:87], v[48:51], a[240:243], v[84:87]
buffer_load_dwordx4 a[80:83], v1, s[28:31], s66 offen offset:0 sc1
v_mfma_f32_16x16x32_bf16 v[88:91], v[48:51], a[244:247], v[88:91]
ds_read_b64_tr_b16 v[38:39], v21 offset:33280
v_mfma_f32_16x16x32_bf16 v[88:91], v[44:47], a[228:231], v[88:91]
v_mfma_f32_16x16x32_bf16 v[92:95], v[44:47], a[232:235], v[92:95]
ds_read_b64_tr_b16 v[40:41], v21 offset:33792
v_mfma_f32_16x16x32_bf16 v[92:95], v[48:51], a[248:251], v[92:95]
v_mfma_f32_16x16x32_bf16 v[96:99], v[48:51], a[252:255], v[96:99]
ds_read_b64_tr_b16 v[42:43], v21 offset:34304
v_mfma_f32_16x16x32_bf16 v[96:99], v[44:47], a[236:239], v[96:99]
s_waitcnt lgkmcnt(4)
buffer_load_dwordx4 a[84:87], v1, s[28:31], s66 offen offset:1024 sc1
v_mfma_f32_16x16x32_bf16 v[112:115], v[28:31], a[236:239], v[112:115]
ds_read_b64_tr_b16 v[44:45], v21 offset:34816
v_mfma_f32_16x16x32_bf16 v[112:115], v[32:35], a[252:255], v[112:115]
v_mfma_f32_16x16x32_bf16 v[108:111], v[32:35], a[248:251], v[108:111]
ds_read_b64_tr_b16 v[46:47], v21 offset:35328
v_mfma_f32_16x16x32_bf16 v[108:111], v[28:31], a[232:235], v[108:111]
v_mfma_f32_16x16x32_bf16 v[104:107], v[28:31], a[228:231], v[104:107]
ds_read_b64_tr_b16 v[48:49], v21 offset:35840
v_mfma_f32_16x16x32_bf16 v[104:107], v[32:35], a[244:247], v[104:107]
buffer_load_dwordx4 a[88:91], v1, s[28:31], s66 offen offset:2048 sc1
v_mfma_f32_16x16x32_bf16 v[100:103], v[32:35], a[240:243], v[100:103]
ds_read_b64_tr_b16 v[50:51], v21 offset:36352
v_mfma_f32_16x16x32_bf16 v[100:103], v[28:31], a[224:227], v[100:103]
s_waitcnt lgkmcnt(4)
s_barrier
v_mfma_f32_16x16x32_bf16 v[84:87], v[36:39], v[212:215], v[84:87]
ds_read_b64_tr_b16 v[28:29], v13 offset:0
v_mfma_f32_16x16x32_bf16 v[84:87], v[40:43], v[228:231], v[84:87]
v_mfma_f32_16x16x32_bf16 v[88:91], v[40:43], v[232:235], v[88:91]
ds_read_b64_tr_b16 v[30:31], v13 offset:2048
v_mfma_f32_16x16x32_bf16 v[88:91], v[36:39], v[216:219], v[88:91]
buffer_load_dwordx4 a[92:95], v1, s[28:31], s66 offen offset:3072 sc1
v_mfma_f32_16x16x32_bf16 v[92:95], v[36:39], v[220:223], v[92:95]
s_add_u32 s66, s66, 28672
ds_read_b64_tr_b16 v[32:33], v13 offset:4096
v_mfma_f32_16x16x32_bf16 v[92:95], v[40:43], v[236:239], v[92:95]
v_mfma_f32_16x16x32_bf16 v[96:99], v[40:43], v[240:243], v[96:99]
ds_read_b64_tr_b16 v[34:35], v13 offset:6144
v_mfma_f32_16x16x32_bf16 v[96:99], v[36:39], v[224:227], v[96:99]
s_waitcnt lgkmcnt(4)
v_mfma_f32_16x16x32_bf16 v[100:103], v[44:47], v[212:215], v[100:103]
s_waitcnt vmcnt(12)
ds_read_b64_tr_b16 v[36:37], v14 offset:0
v_mfma_f32_16x16x32_bf16 v[100:103], v[48:51], v[228:231], v[100:103]
buffer_store_dword v24, v25, s[28:31], s51 offen offset:256 sc1
v_mfma_f32_16x16x32_bf16 v[104:107], v[48:51], v[232:235], v[104:107]
ds_read_b64_tr_b16 v[38:39], v14 offset:2048
v_mfma_f32_16x16x32_bf16 v[104:107], v[44:47], v[216:219], v[104:107]
v_mfma_f32_16x16x32_bf16 v[108:111], v[44:47], v[220:223], v[108:111]
ds_read_b64_tr_b16 v[40:41], v14 offset:4096
v_mfma_f32_16x16x32_bf16 v[108:111], v[48:51], v[236:239], v[108:111]
buffer_load_dwordx4 a[96:99], v1, s[28:31], s67 offen offset:0 sc1
v_mfma_f32_16x16x32_bf16 v[112:115], v[48:51], v[240:243], v[112:115]
ds_read_b64_tr_b16 v[42:43], v14 offset:6144
v_mfma_f32_16x16x32_bf16 v[112:115], v[44:47], v[224:227], v[112:115]
s_waitcnt lgkmcnt(4)
v_mfma_f32_16x16x32_bf16 v[52:55], v[28:31], a[0:3], 0
ds_read_b64_tr_b16 v[44:45], v15 offset:0
v_mul_f32 v84, v84, v100
v_mfma_f32_16x16x32_bf16 v[52:55], v[32:35], a[16:19], v[52:55]
v_mul_f32 v85, v85, v101
v_mul_f32 v86, v86, v102
v_mfma_f32_16x16x32_bf16 v[56:59], v[32:35], a[20:23], 0
ds_read_b64_tr_b16 v[46:47], v15 offset:2048
v_mul_f32 v87, v87, v103
v_mfma_f32_16x16x32_bf16 v[56:59], v[28:31], a[4:7], v[56:59]
buffer_load_dwordx4 a[100:103], v1, s[28:31], s67 offen offset:1024 sc1
v_mfma_f32_16x16x32_bf16 v[60:63], v[28:31], a[8:11], 0
ds_read_b64_tr_b16 v[48:49], v15 offset:4096
v_cvt_pk_bf16_f32 v100, v84, v85
v_mfma_f32_16x16x32_bf16 v[60:63], v[32:35], a[24:27], v[60:63]
v_cvt_pk_bf16_f32 v101, v86, v87
v_mul_f32 v88, v88, v104
v_mfma_f32_16x16x32_bf16 v[64:67], v[32:35], a[28:31], 0
ds_read_b64_tr_b16 v[50:51], v15 offset:6144
v_mul_f32 v89, v89, v105
v_mfma_f32_16x16x32_bf16 v[64:67], v[28:31], a[12:15], v[64:67]
s_waitcnt lgkmcnt(4)
buffer_load_dwordx4 a[104:107], v1, s[28:31], s67 offen offset:2048 sc1
v_mfma_f32_16x16x32_bf16 v[80:83], v[36:39], a[12:15], 0
ds_read_b64_tr_b16 v[28:29], v16 offset:0
v_mul_f32 v90, v90, v106
v_mfma_f32_16x16x32_bf16 v[80:83], v[40:43], a[28:31], v[80:83]
v_mul_f32 v91, v91, v107
v_cvt_pk_bf16_f32 v102, v88, v89
v_mfma_f32_16x16x32_bf16 v[76:79], v[40:43], a[24:27], 0
ds_read_b64_tr_b16 v[30:31], v16 offset:2048
v_cvt_pk_bf16_f32 v103, v90, v91
v_mfma_f32_16x16x32_bf16 v[76:79], v[36:39], a[8:11], v[76:79]
v_mul_f32 v92, v92, v108
v_mul_f32 v93, v93, v109
v_mfma_f32_16x16x32_bf16 v[72:75], v[36:39], a[4:7], 0
ds_read_b64_tr_b16 v[32:33], v16 offset:4096
v_mul_f32 v94, v94, v110
v_mfma_f32_16x16x32_bf16 v[72:75], v[40:43], a[20:23], v[72:75]
buffer_store_dwordx4 v[100:103], v1, s[28:31], s46 offen offset:0 sc1
v_mul_f32 v95, v95, v111
v_mfma_f32_16x16x32_bf16 v[68:71], v[40:43], a[16:19], 0
ds_read_b64_tr_b16 v[34:35], v16 offset:6144
v_cvt_pk_bf16_f32 v108, v92, v93
v_mfma_f32_16x16x32_bf16 v[68:71], v[36:39], a[0:3], v[68:71]
s_waitcnt lgkmcnt(4)
v_cvt_pk_bf16_f32 v109, v94, v95
v_mul_f32 v96, v96, v112
v_mfma_f32_16x16x32_bf16 v[116:119], v[44:47], a[0:3], 0
ds_read_b64_tr_b16 v[36:37], v13 offset:8192
v_mul_f32 v97, v97, v113
v_mfma_f32_16x16x32_bf16 v[116:119], v[48:51], a[16:19], v[116:119]
buffer_load_dwordx4 a[108:111], v1, s[28:31], s67 offen offset:3072 sc1
v_mfma_f32_16x16x32_bf16 v[120:123], v[48:51], a[20:23], 0
s_add_u32 s67, s67, 4096
ds_read_b64_tr_b16 v[38:39], v13 offset:10240
v_mul_f32 v98, v98, v114
v_mfma_f32_16x16x32_bf16 v[120:123], v[44:47], a[4:7], v[120:123]
v_mul_f32 v99, v99, v115
v_cvt_pk_bf16_f32 v110, v96, v97
v_mfma_f32_16x16x32_bf16 v[124:127], v[44:47], a[8:11], 0
ds_read_b64_tr_b16 v[40:41], v13 offset:12288
v_cvt_pk_bf16_f32 v111, v98, v99
v_mfma_f32_16x16x32_bf16 v[124:127], v[48:51], a[24:27], v[124:127]
v_mfma_f32_16x16x32_bf16 v[128:131], v[48:51], a[28:31], 0
ds_read_b64_tr_b16 v[42:43], v13 offset:14336
v_mfma_f32_16x16x32_bf16 v[128:131], v[44:47], a[12:15], v[128:131]
s_waitcnt lgkmcnt(4)
buffer_store_dwordx4 v[108:111], v1, s[28:31], s46 offen offset:1024 sc1
v_mfma_f32_16x16x32_bf16 v[144:147], v[28:31], a[12:15], 0
ds_read_b64_tr_b16 v[44:45], v14 offset:8192
v_mfma_f32_16x16x32_bf16 v[144:147], v[32:35], a[28:31], v[144:147]
v_mfma_f32_16x16x32_bf16 v[140:143], v[32:35], a[24:27], 0
ds_read_b64_tr_b16 v[46:47], v14 offset:10240
v_mfma_f32_16x16x32_bf16 v[140:143], v[28:31], a[8:11], v[140:143]
buffer_load_dwordx4 a[112:115], v1, s[28:31], s67 offen offset:0 sc1
v_mfma_f32_16x16x32_bf16 v[136:139], v[28:31], a[4:7], 0
ds_read_b64_tr_b16 v[48:49], v14 offset:12288
v_mfma_f32_16x16x32_bf16 v[136:139], v[32:35], a[20:23], v[136:139]
v_mfma_f32_16x16x32_bf16 v[132:135], v[32:35], a[16:19], 0
s_branch iskip10
.p2align 12
ipad10:
s_branch iret1
s_nop 0
iskip10:
ds_read_b64_tr_b16 v[50:51], v14 offset:14336
v_mfma_f32_16x16x32_bf16 v[132:135], v[28:31], a[0:3], v[132:135]
s_waitcnt lgkmcnt(4)
v_mfma_f32_16x16x32_bf16 v[148:151], v[36:39], a[0:3], 0
ds_read_b64_tr_b16 v[28:29], v15 offset:8192
v_mfma_f32_16x16x32_bf16 v[148:151], v[40:43], a[16:19], v[148:151]
buffer_load_dwordx4 a[116:119], v1, s[28:31], s67 offen offset:1024 sc1
v_mfma_f32_16x16x32_bf16 v[152:155], v[40:43], a[20:23], 0
ds_read_b64_tr_b16 v[30:31], v15 offset:10240
v_mfma_f32_16x16x32_bf16 v[152:155], v[36:39], a[4:7], v[152:155]
v_mfma_f32_16x16x32_bf16 v[156:159], v[36:39], a[8:11], 0
ds_read_b64_tr_b16 v[32:33], v15 offset:12288
v_mfma_f32_16x16x32_bf16 v[156:159], v[40:43], a[24:27], v[156:159]
buffer_load_dwordx4 a[120:123], v1, s[28:31], s67 offen offset:2048 sc1
v_mfma_f32_16x16x32_bf16 v[160:163], v[40:43], a[28:31], 0
ds_read_b64_tr_b16 v[34:35], v15 offset:14336
v_mfma_f32_16x16x32_bf16 v[160:163], v[36:39], a[12:15], v[160:163]
s_waitcnt lgkmcnt(4)
v_mfma_f32_16x16x32_bf16 v[176:179], v[44:47], a[12:15], 0
ds_read_b64_tr_b16 v[36:37], v16 offset:8192
v_mfma_f32_16x16x32_bf16 v[176:179], v[48:51], a[28:31], v[176:179]
v_mfma_f32_16x16x32_bf16 v[172:175], v[48:51], a[24:27], 0
ds_read_b64_tr_b16 v[38:39], v16 offset:10240
v_mfma_f32_16x16x32_bf16 v[172:175], v[44:47], a[8:11], v[172:175]
buffer_load_dwordx4 a[124:127], v1, s[28:31], s67 offen offset:3072 sc1
v_mfma_f32_16x16x32_bf16 v[168:171], v[44:47], a[4:7], 0
s_add_u32 s67, s67, 28672
ds_read_b64_tr_b16 v[40:41], v16 offset:12288
s_add_u32 m0, s34, 81920
v_mfma_f32_16x16x32_bf16 v[168:171], v[48:51], a[20:23], v[168:171]
v_mfma_f32_16x16x32_bf16 v[164:167], v[48:51], a[16:19], 0
ds_read_b64_tr_b16 v[42:43], v16 offset:14336
v_mfma_f32_16x16x32_bf16 v[164:167], v[44:47], a[0:3], v[164:167]
s_waitcnt lgkmcnt(4)
buffer_load_dwordx4 v8, s[20:23], s61 offen offset:0 sc1 lds
v_mfma_f32_16x16x32_bf16 v[180:183], v[28:31], a[0:3], 0
ds_read_b64_tr_b16 v[44:45], v21 offset:36864
v_mfma_f32_16x16x32_bf16 v[180:183], v[32:35], a[16:19], v[180:183]
v_mfma_f32_16x16x32_bf16 v[184:187], v[32:35], a[20:23], 0
ds_read_b64_tr_b16 v[46:47], v21 offset:37376
v_mfma_f32_16x16x32_bf16 v[184:187], v[28:31], a[4:7], v[184:187]
buffer_load_dwordx4 v9, s[20:23], s61 offen offset:1024 sc1 lds
v_mfma_f32_16x16x32_bf16 v[188:191], v[28:31], a[8:11], 0
ds_read_b64_tr_b16 v[48:49], v21 offset:37888
v_mfma_f32_16x16x32_bf16 v[188:191], v[32:35], a[24:27], v[188:191]
v_mfma_f32_16x16x32_bf16 v[192:195], v[32:35], a[28:31], 0
ds_read_b64_tr_b16 v[50:51], v21 offset:38400
v_mfma_f32_16x16x32_bf16 v[192:195], v[28:31], a[12:15], v[192:195]
s_waitcnt lgkmcnt(4)
s_barrier
v_mfma_f32_16x16x32_bf16 v[208:211], v[36:39], a[12:15], 0
ds_read_b64_tr_b16 v[28:29], v13 offset:16384
v_mfma_f32_16x16x32_bf16 v[208:211], v[40:43], a[28:31], v[208:211]
buffer_load_dwordx4 v10, s[20:23], s61 offen offset:2048 sc1 lds
v_mfma_f32_16x16x32_bf16 v[204:207], v[40:43], a[24:27], 0
ds_read_b64_tr_b16 v[30:31], v13 offset:18432
v_mfma_f32_16x16x32_bf16 v[204:207], v[36:39], a[8:11], v[204:207]
v_mfma_f32_16x16x32_bf16 v[200:203], v[36:39], a[4:7], 0
ds_read_b64_tr_b16 v[32:33], v13 offset:20480
v_mfma_f32_16x16x32_bf16 v[200:203], v[40:43], a[20:23], v[200:203]
buffer_load_dwordx4 v11, s[20:23], s61 offen offset:3072 sc1 lds
v_mfma_f32_16x16x32_bf16 v[196:199], v[40:43], a[16:19], 0
ds_read_b64_tr_b16 v[34:35], v13 offset:22528
v_mfma_f32_16x16x32_bf16 v[196:199], v[36:39], a[0:3], v[196:199]
s_waitcnt lgkmcnt(4)
v_mfma_f32_16x16x32_bf16 v[84:87], v[44:47], a[0:3], 0
ds_read_b64_tr_b16 v[36:37], v14 offset:16384
v_mfma_f32_16x16x32_bf16 v[84:87], v[48:51], a[16:19], v[84:87]
buffer_load_dword v23, v22, s[28:31], s50 offen offset:256 sc1
v_mfma_f32_16x16x32_bf16 v[88:91], v[48:51], a[20:23], 0
s_add_u32 m0, s34, 98304
ds_read_b64_tr_b16 v[38:39], v14 offset:18432
v_mfma_f32_16x16x32_bf16 v[88:91], v[44:47], a[4:7], v[88:91]
v_mfma_f32_16x16x32_bf16 v[92:95], v[44:47], a[8:11], 0
ds_read_b64_tr_b16 v[40:41], v14 offset:20480
v_mfma_f32_16x16x32_bf16 v[92:95], v[48:51], a[24:27], v[92:95]
buffer_load_dwordx4 v8, s[20:23], s62 offen offset:0 sc1 lds
v_mfma_f32_16x16x32_bf16 v[96:99], v[48:51], a[28:31], 0
ds_read_b64_tr_b16 v[42:43], v14 offset:22528
v_mfma_f32_16x16x32_bf16 v[96:99], v[44:47], a[12:15], v[96:99]
s_waitcnt vmcnt(25) lgkmcnt(4)
v_mfma_f32_16x16x32_bf16 v[64:67], v[28:31], a[44:47], v[64:67]
ds_read_b64_tr_b16 v[44:45], v15 offset:16384
v_and_b32 v113, 15, v245
v_mfma_f32_16x16x32_bf16 v[64:67], v[32:35], a[60:63], v[64:67]
buffer_load_dwordx4 v9, s[20:23], s62 offen offset:1024 sc1 lds
v_mfma_f32_16x16x32_bf16 v[60:63], v[32:35], a[56:59], v[60:63]
ds_read_b64_tr_b16 v[46:47], v15 offset:18432
v_lshrrev_b32 v114, 4, v245
v_mfma_f32_16x16x32_bf16 v[60:63], v[28:31], a[40:43], v[60:63]
v_lshrrev_b32 v111, 2, v113
v_lshlrev_b32 v111, 8, v111
v_mfma_f32_16x16x32_bf16 v[56:59], v[28:31], a[36:39], v[56:59]
ds_read_b64_tr_b16 v[48:49], v15 offset:20480
v_lshl_add_u32 v111, v114, 6, v111
v_mfma_f32_16x16x32_bf16 v[56:59], v[32:35], a[52:55], v[56:59]
buffer_load_dwordx4 v10, s[20:23], s62 offen offset:2048 sc1 lds
v_mfma_f32_16x16x32_bf16 v[52:55], v[32:35], a[48:51], v[52:55]
ds_read_b64_tr_b16 v[50:51], v15 offset:22528
v_and_b32 v112, 3, v245
v_mfma_f32_16x16x32_bf16 v[52:55], v[28:31], a[32:35], v[52:55]
s_waitcnt lgkmcnt(4)
v_lshl_add_u32 v107, v112, 4, v111
v_xor_b32 v111, s13, v245
v_mfma_f32_16x16x32_bf16 v[68:71], v[36:39], a[32:35], v[68:71]
ds_read_b64_tr_b16 v[28:29], v16 offset:16384
v_and_b32 v111, 7, v111
v_mfma_f32_16x16x32_bf16 v[68:71], v[40:43], a[48:51], v[68:71]
buffer_load_dwordx4 v11, s[20:23], s62 offen offset:3072 sc1 lds
v_mfma_f32_16x16x32_bf16 v[72:75], v[40:43], a[52:55], v[72:75]
s_add_u32 m0, s34, 114688
ds_read_b64_tr_b16 v[30:31], v16 offset:18432
v_lshrrev_b32 v112, 1, v113
v_mfma_f32_16x16x32_bf16 v[72:75], v[36:39], a[36:39], v[72:75]
v_sub_u32 v112, 3, v112
v_max_i32 v112, 0, v112
v_mfma_f32_16x16x32_bf16 v[76:79], v[36:39], a[40:43], v[76:79]
ds_read_b64_tr_b16 v[32:33], v16 offset:20480
v_lshl_add_u32 v111, v111, 5, v112
v_mfma_f32_16x16x32_bf16 v[76:79], v[40:43], a[56:59], v[76:79]
buffer_load_dwordx4 v8, s[20:23], s63 offen offset:0 sc1 lds
v_mfma_f32_16x16x32_bf16 v[80:83], v[40:43], a[60:63], v[80:83]
ds_read_b64_tr_b16 v[34:35], v16 offset:22528
v_lshlrev_b32 v108, 7, v111
v_mfma_f32_16x16x32_bf16 v[80:83], v[36:39], a[44:47], v[80:83]
s_waitcnt lgkmcnt(4)
s_mov_b32 s90, 2359296
v_xor_b32 v111, s13, v114
v_mfma_f32_16x16x32_bf16 v[128:131], v[44:47], a[44:47], v[128:131]
s_waitcnt vmcnt(14)
ds_read_b64_tr_b16 v[36:37], v13 offset:24576
v_and_b32 v112, 1, v114
v_mfma_f32_16x16x32_bf16 v[128:131], v[48:51], a[60:63], v[128:131]
buffer_store_dword v24, v25, s[28:31], s51 offen offset:384 sc1
v_mfma_f32_16x16x32_bf16 v[124:127], v[48:51], a[56:59], v[124:127]
ds_read_b64_tr_b16 v[38:39], v13 offset:26624
v_xor_b32 v112, 1, v112
v_mfma_f32_16x16x32_bf16 v[124:127], v[44:47], a[40:43], v[124:127]
v_mul_u32_u24 v112, 9216, v112
v_lshl_add_u32 v112, v113, 4, v112
v_mfma_f32_16x16x32_bf16 v[120:123], v[44:47], a[36:39], v[120:123]
ds_read_b64_tr_b16 v[40:41], v13 offset:28672
v_mad_u32_u24 v105, v111, s90, v112
v_mfma_f32_16x16x32_bf16 v[120:123], v[48:51], a[52:55], v[120:123]
buffer_load_dwordx4 v9, s[20:23], s63 offen offset:1024 sc1 lds
v_mfma_f32_16x16x32_bf16 v[116:119], v[48:51], a[48:51], v[116:119]
ds_read_b64_tr_b16 v[42:43], v13 offset:30720
v_xor_b32 v111, 4, v111
v_mfma_f32_16x16x32_bf16 v[116:119], v[44:47], a[32:35], v[116:119]
s_waitcnt lgkmcnt(4)
v_mad_u32_u24 v106, v111, s90, v112
v_mul_u32_u24 v111, 1152, v113
v_mfma_f32_16x16x32_bf16 v[132:135], v[28:31], a[32:35], v[132:135]
ds_read_b64_tr_b16 v[44:45], v14 offset:24576
v_and_b32 v112, 1, v114
v_mfma_f32_16x16x32_bf16 v[132:135], v[32:35], a[48:51], v[132:135]
buffer_load_dwordx4 v10, s[20:23], s63 offen offset:2048 sc1 lds
v_mfma_f32_16x16x32_bf16 v[136:139], v[32:35], a[52:55], v[136:139]
ds_read_b64_tr_b16 v[46:47], v14 offset:26624
v_lshl_add_u32 v111, v112, 5, v111
v_mfma_f32_16x16x32_bf16 v[136:139], v[28:31], a[36:39], v[136:139]
v_lshrrev_b32 v112, 1, v114
v_lshl_add_u32 v103, v112, 4, v111
v_mfma_f32_16x16x32_bf16 v[140:143], v[28:31], a[40:43], v[140:143]
s_lshl_b32 s91, s14, 2
ds_read_b64_tr_b16 v[48:49], v14 offset:28672
s_add_u32 s91, s91, s58
v_mfma_f32_16x16x32_bf16 v[140:143], v[32:35], a[56:59], v[140:143]
buffer_load_dwordx4 v11, s[20:23], s63 offen offset:3072 sc1 lds
v_mfma_f32_16x16x32_bf16 v[144:147], v[32:35], a[60:63], v[144:147]
s_lshl_b32 s92, s91, 3
ds_read_b64_tr_b16 v[50:51], v14 offset:30720
v_add3_u32 v115, v114, s92, 0
v_mfma_f32_16x16x32_bf16 v[144:147], v[28:31], a[44:47], v[144:147]
s_waitcnt lgkmcnt(4)
v_mul_u32_u24 v111, 7282, v115
v_lshrrev_b32 v111, 16, v111
v_mfma_f32_16x16x32_bf16 v[160:163], v[36:39], a[44:47], v[160:163]
ds_read_b64_tr_b16 v[28:29], v21 offset:38912
v_mad_i32_i24 v115, v111, -9, v115
v_mfma_f32_16x16x32_bf16 v[160:163], v[40:43], a[60:63], v[160:163]
v_cmp_eq_u32 s[88:89], 8, v115
v_lshrrev_b32 v112, 3, v111
v_mfma_f32_16x16x32_bf16 v[156:159], v[40:43], a[56:59], v[156:159]
ds_read_b64_tr_b16 v[30:31], v21 offset:39424
v_lshlrev_b32 v112, 11, v112
v_mfma_f32_16x16x32_bf16 v[156:159], v[36:39], a[40:43], v[156:159]
v_lshl_add_u32 v112, v111, 8, v112
v_lshl_add_u32 v112, v113, 4, v112
v_mfma_f32_16x16x32_bf16 v[152:155], v[36:39], a[36:39], v[152:155]
ds_read_b64_tr_b16 v[32:33], v21 offset:39936
v_add_u32 v112, 65536, v112
v_mfma_f32_16x16x32_bf16 v[152:155], v[40:43], a[52:55], v[152:155]
v_lshlrev_b32 v111, 12, v111
v_lshl_add_u32 v111, v113, 4, v111
v_mfma_f32_16x16x32_bf16 v[148:151], v[40:43], a[48:51], v[148:151]
ds_read_b64_tr_b16 v[34:35], v21 offset:40448
v_and_b32 v100, 3, v115
v_mfma_f32_16x16x32_bf16 v[148:151], v[36:39], a[32:35], v[148:151]
s_waitcnt lgkmcnt(4)
v_lshl_add_u32 v111, v100, 8, v111
s_barrier
v_mfma_f32_16x16x32_bf16 v[164:167], v[44:47], a[32:35], v[164:167]
s_waitcnt vmcnt(9)
ds_read_b64_tr_b16 v[36:37], v13 offset:32768
v_cmp_eq_u32 vcc, 1, v23
v_mfma_f32_16x16x32_bf16 v[164:167], v[48:51], a[48:51], v[164:167]
v_mfma_f32_16x16x32_bf16 v[168:171], v[48:51], a[52:55], v[168:171]
s_cmp_eq_u64 vcc, exec
s_cbranch_scc0 sequential_preLN__linear_kernel_hedgehog__glu_gated_bilinear__prompt_kernel_f_slow1
sequential_preLN__linear_kernel_hedgehog__glu_gated_bilinear__prompt_kernel_f_back1:
ds_read_b64_tr_b16 v[38:39], v13 offset:34816
v_mfma_f32_16x16x32_bf16 v[168:171], v[44:47], a[36:39], v[168:171]
buffer_load_dwordx4 a[160:163], v1, s[28:31], s65 offen offset:0 sc1
v_mfma_f32_16x16x32_bf16 v[172:175], v[44:47], a[40:43], v[172:175]
ds_read_b64_tr_b16 v[40:41], v13 offset:36864
v_lshrrev_b32 v115, 2, v115
v_mfma_f32_16x16x32_bf16 v[172:175], v[48:51], a[56:59], v[172:175]
v_lshl_add_u32 v111, v115, 3, v111
v_cndmask_b32 v100, v111, v112, s[88:89]
v_mfma_f32_16x16x32_bf16 v[176:179], v[48:51], a[60:63], v[176:179]
ds_read_b64_tr_b16 v[42:43], v13 offset:38912
v_cndmask_b32 v112, 10, 3, s[88:89]
v_mfma_f32_16x16x32_bf16 v[176:179], v[44:47], a[44:47], v[176:179]
s_waitcnt lgkmcnt(4)
buffer_load_dwordx4 a[192:195], v1, s[28:31], s66 offen offset:0 sc1
v_mfma_f32_16x16x32_bf16 v[96:99], v[28:31], a[44:47], v[96:99]
ds_read_b64_tr_b16 v[44:45], v14 offset:32768
v_lshl_add_u32 v109, 1, v112, v100
v_mfma_f32_16x16x32_bf16 v[96:99], v[32:35], a[60:63], v[96:99]
v_add3_u32 v115, v114, s92, 4
v_mul_u32_u24 v111, 7282, v115
v_mfma_f32_16x16x32_bf16 v[92:95], v[32:35], a[56:59], v[92:95]
ds_read_b64_tr_b16 v[46:47], v14 offset:34816
v_lshrrev_b32 v111, 16, v111
v_mfma_f32_16x16x32_bf16 v[92:95], v[28:31], a[40:43], v[92:95]
v_mad_i32_i24 v115, v111, -9, v115
v_cmp_eq_u32 s[88:89], 8, v115
v_mfma_f32_16x16x32_bf16 v[88:91], v[28:31], a[36:39], v[88:91]
ds_read_b64_tr_b16 v[48:49], v14 offset:36864
v_lshrrev_b32 v112, 3, v111
v_mfma_f32_16x16x32_bf16 v[88:91], v[32:35], a[52:55], v[88:91]
buffer_load_dwordx4 a[224:227], v1, s[28:31], s67 offen offset:0 sc1
v_mfma_f32_16x16x32_bf16 v[84:87], v[32:35], a[48:51], v[84:87]
ds_read_b64_tr_b16 v[50:51], v14 offset:38912
v_lshlrev_b32 v112, 11, v112
v_mfma_f32_16x16x32_bf16 v[84:87], v[28:31], a[32:35], v[84:87]
s_waitcnt lgkmcnt(4)
v_lshl_add_u32 v112, v111, 8, v112
v_lshl_add_u32 v112, v113, 4, v112
v_mfma_f32_16x16x32_bf16 v[52:55], v[36:39], a[64:67], v[52:55]
ds_read_b64_tr_b16 v[28:29], v15 offset:32768
v_add_u32 v112, 65536, v112
v_mfma_f32_16x16x32_bf16 v[52:55], v[40:43], a[80:83], v[52:55]
buffer_load_dwordx4 a[164:167], v1, s[28:31], s65 offen offset:1024 sc1
v_mfma_f32_16x16x32_bf16 v[56:59], v[40:43], a[84:87], v[56:59]
ds_read_b64_tr_b16 v[30:31], v15 offset:34816
v_lshlrev_b32 v111, 12, v111
v_mfma_f32_16x16x32_bf16 v[56:59], v[36:39], a[68:71], v[56:59]
v_lshl_add_u32 v111, v113, 4, v111
v_and_b32 v101, 3, v115
v_mfma_f32_16x16x32_bf16 v[60:63], v[36:39], a[72:75], v[60:63]
ds_read_b64_tr_b16 v[32:33], v15 offset:36864
v_lshl_add_u32 v111, v101, 8, v111
v_mfma_f32_16x16x32_bf16 v[60:63], v[40:43], a[88:91], v[60:63]
v_lshrrev_b32 v115, 2, v115
v_lshl_add_u32 v111, v115, 3, v111
v_mfma_f32_16x16x32_bf16 v[64:67], v[40:43], a[92:95], v[64:67]
ds_read_b64_tr_b16 v[34:35], v15 offset:38912
v_cndmask_b32 v101, v111, v112, s[88:89]
v_mfma_f32_16x16x32_bf16 v[64:67], v[36:39], a[76:79], v[64:67]
s_waitcnt lgkmcnt(4)
buffer_load_dwordx4 a[196:199], v1, s[28:31], s66 offen offset:1024 sc1
v_mfma_f32_16x16x32_bf16 v[80:83], v[44:47], a[76:79], v[80:83]
ds_read_b64_tr_b16 v[36:37], v16 offset:32768
v_cndmask_b32 v112, 10, 3, s[88:89]
v_mfma_f32_16x16x32_bf16 v[80:83], v[48:51], a[92:95], v[80:83]
v_lshl_add_u32 v2, 1, v112, v101
s_lshl_b32 s92, s58, 2
v_mfma_f32_16x16x32_bf16 v[76:79], v[48:51], a[88:91], v[76:79]
ds_read_b64_tr_b16 v[38:39], v16 offset:34816
v_and_b32 v113, 3, v245
v_mfma_f32_16x16x32_bf16 v[76:79], v[44:47], a[72:75], v[76:79]
buffer_load_dwordx4 a[228:231], v1, s[28:31], s67 offen offset:1024 sc1
v_mfma_f32_16x16x32_bf16 v[72:75], v[44:47], a[68:71], v[72:75]
ds_read_b64_tr_b16 v[40:41], v16 offset:36864
v_add_u32 v113, s92, v113
v_mfma_f32_16x16x32_bf16 v[72:75], v[48:51], a[84:87], v[72:75]
v_and_or_b32 v111, v245, 32, v113
v_lshlrev_b32 v110, 2, v111
v_mfma_f32_16x16x32_bf16 v[68:71], v[48:51], a[80:83], v[68:71]
ds_read_b64_tr_b16 v[42:43], v16 offset:38912
v_lshrrev_b32 v111, 5, v245
v_mfma_f32_16x16x32_bf16 v[68:71], v[44:47], a[64:67], v[68:71]
s_waitcnt lgkmcnt(4)
v_lshl_add_u32 v111, v111, 4, v113
v_mul_u32_u24 v111, 1152, v111
v_mfma_f32_16x16x32_bf16 v[116:119], v[28:31], a[64:67], v[116:119]
ds_read_b64_tr_b16 v[44:45], v13 offset:40960
v_bfe_u32 v115, v245, 2, 2
v_mfma_f32_16x16x32_bf16 v[116:119], v[32:35], a[80:83], v[116:119]
buffer_load_dwordx4 a[168:171], v1, s[28:31], s65 offen offset:2048 sc1
v_mfma_f32_16x16x32_bf16 v[120:123], v[32:35], a[84:87], v[120:123]
ds_read_b64_tr_b16 v[46:47], v13 offset:43008
v_lshl_add_u32 v111, v115, 3, v111
v_mfma_f32_16x16x32_bf16 v[120:123], v[28:31], a[68:71], v[120:123]
v_and_b32 v114, 1, v114
v_lshl_add_u32 v104, v114, 2, v111
v_mfma_f32_16x16x32_bf16 v[124:127], v[28:31], a[72:75], v[124:127]
s_lshl_b32 s92, s14, 2
ds_read_b64_tr_b16 v[48:49], v13 offset:45056
s_add_u32 s92, s92, 128
v_mfma_f32_16x16x32_bf16 v[124:127], v[32:35], a[88:91], v[124:127]
buffer_load_dwordx4 a[200:203], v1, s[28:31], s66 offen offset:2048 sc1
v_mfma_f32_16x16x32_bf16 v[128:131], v[32:35], a[92:95], v[128:131]
ds_read_b64_tr_b16 v[50:51], v13 offset:47104
v_add_u32 v115, s92, v115
v_mfma_f32_16x16x32_bf16 v[128:131], v[28:31], a[76:79], v[128:131]
s_waitcnt lgkmcnt(4)
v_mul_u32_u24 v111, 7282, v115
v_lshrrev_b32 v111, 16, v111
v_mfma_f32_16x16x32_bf16 v[144:147], v[36:39], a[76:79], v[144:147]
ds_read_b64_tr_b16 v[28:29], v14 offset:40960
v_mad_i32_i24 v115, v111, -9, v115
v_mfma_f32_16x16x32_bf16 v[144:147], v[40:43], a[92:95], v[144:147]
v_cmp_eq_u32 s[88:89], 8, v115
v_lshrrev_b32 v112, 3, v111
v_mfma_f32_16x16x32_bf16 v[140:143], v[40:43], a[88:91], v[140:143]
ds_read_b64_tr_b16 v[30:31], v14 offset:43008
v_lshlrev_b32 v112, 11, v112
v_mfma_f32_16x16x32_bf16 v[140:143], v[36:39], a[72:75], v[140:143]
buffer_load_dwordx4 a[232:235], v1, s[28:31], s67 offen offset:2048 sc1
v_mfma_f32_16x16x32_bf16 v[136:139], v[36:39], a[68:71], v[136:139]
ds_read_b64_tr_b16 v[32:33], v14 offset:45056
v_lshl_add_u32 v112, v111, 8, v112
v_mfma_f32_16x16x32_bf16 v[136:139], v[40:43], a[84:87], v[136:139]
v_lshl_add_u32 v112, v113, 4, v112
v_add_u32 v112, 65536, v112
v_mfma_f32_16x16x32_bf16 v[132:135], v[40:43], a[80:83], v[132:135]
ds_read_b64_tr_b16 v[34:35], v14 offset:47104
v_lshlrev_b32 v111, 12, v111
v_mfma_f32_16x16x32_bf16 v[132:135], v[36:39], a[64:67], v[132:135]
s_waitcnt lgkmcnt(4)
buffer_load_dwordx4 a[172:175], v1, s[28:31], s65 offen offset:3072 sc1
v_mfma_f32_16x16x32_bf16 v[148:151], v[44:47], a[64:67], v[148:151]
ds_read_b64_tr_b16 v[36:37], v21 offset:40960
v_lshl_add_u32 v111, v113, 4, v111
v_mfma_f32_16x16x32_bf16 v[148:151], v[48:51], a[80:83], v[148:151]
v_and_b32 v102, 3, v115
v_lshl_add_u32 v111, v102, 8, v111
v_mfma_f32_16x16x32_bf16 v[152:155], v[48:51], a[84:87], v[152:155]
ds_read_b64_tr_b16 v[38:39], v21 offset:41472
v_lshrrev_b32 v115, 2, v115
v_mfma_f32_16x16x32_bf16 v[152:155], v[44:47], a[68:71], v[152:155]
v_lshl_add_u32 v111, v115, 3, v111
v_cndmask_b32 v102, v111, v112, s[88:89]
v_mfma_f32_16x16x32_bf16 v[156:159], v[44:47], a[72:75], v[156:159]
ds_read_b64_tr_b16 v[40:41], v21 offset:41984
v_cndmask_b32 v112, 10, 3, s[88:89]
v_mfma_f32_16x16x32_bf16 v[156:159], v[48:51], a[88:91], v[156:159]
buffer_load_dwordx4 a[204:207], v1, s[28:31], s66 offen offset:3072 sc1
v_mfma_f32_16x16x32_bf16 v[160:163], v[48:51], a[92:95], v[160:163]
ds_read_b64_tr_b16 v[42:43], v21 offset:42496
v_lshl_add_u32 v102, v114, 2, v102
v_mfma_f32_16x16x32_bf16 v[160:163], v[44:47], a[76:79], v[160:163]
s_waitcnt lgkmcnt(4)
v_lshrrev_b32 v111, 5, v245
v_lshl_add_u32 v102, v111, v112, v102
v_mfma_f32_16x16x32_bf16 v[176:179], v[28:31], a[76:79], v[176:179]
ds_read_b64_tr_b16 v[44:45], v13 offset:49152
v_cmp_le_u32 s[88:89], 32, v245
v_mfma_f32_16x16x32_bf16 v[176:179], v[32:35], a[92:95], v[176:179]
buffer_load_dwordx4 a[236:239], v1, s[28:31], s67 offen offset:3072 sc1
v_mfma_f32_16x16x32_bf16 v[172:175], v[32:35], a[88:91], v[172:175]
s_add_u32 s65, s65, 4096
ds_read_b64_tr_b16 v[46:47], v13 offset:51200
s_add_u32 s66, s66, 4096
v_mfma_f32_16x16x32_bf16 v[172:175], v[28:31], a[72:75], v[172:175]
s_add_u32 s67, s67, 4096
s_lshl_b32 s7, s15, 1
s_add_u32 s7, s7, s59
v_mfma_f32_16x16x32_bf16 v[168:171], v[28:31], a[68:71], v[168:171]
s_mov_b32 s24, s78
ds_read_b64_tr_b16 v[48:49], v13 offset:53248
s_and_b32 s25, s79, 0xffff
v_mfma_f32_16x16x32_bf16 v[168:171], v[32:35], a[84:87], v[168:171]
s_mov_b32 s26, 2359296
s_mov_b32 s27, 0x20000
s_mul_i32 s11, s15, 73728
v_mfma_f32_16x16x32_bf16 v[164:167], v[32:35], a[80:83], v[164:167]
s_lshl_b32 s6, s59, 11
ds_read_b64_tr_b16 v[50:51], v13 offset:55296
s_add_u32 s6, s6, s11
v_mfma_f32_16x16x32_bf16 v[164:167], v[28:31], a[64:67], v[164:167]
s_waitcnt lgkmcnt(4)
buffer_load_dword v23, v22, s[28:31], s50 offen offset:384 sc1
v_mfma_f32_16x16x32_bf16 v[84:87], v[36:39], a[64:67], v[84:87]
s_add_u32 s6, s6, 0
ds_read_b64_tr_b16 v[28:29], v14 offset:49152
s_mul_i32 s7, s7, 36864
v_mfma_f32_16x16x32_bf16 v[84:87], v[40:43], a[80:83], v[84:87]
s_lshl_b32 s8, s14, 5
s_add_u32 s8, s8, s7
s_add_u32 s8, s8, 1024
v_mfma_f32_16x16x32_bf16 v[88:91], v[40:43], a[84:87], v[88:91]
s_lshl_b32 s91, s91, 6
ds_read_b64_tr_b16 v[30:31], v14 offset:51200
s_add_u32 s7, s7, s91
v_mfma_f32_16x16x32_bf16 v[88:91], v[36:39], a[68:71], v[88:91]
buffer_load_dwordx4 a[176:179], v1, s[28:31], s65 offen offset:0 sc1
v_mfma_f32_16x16x32_bf16 v[92:95], v[36:39], a[72:75], v[92:95]
s_add_u32 s10, s51, 512
ds_read_b64_tr_b16 v[32:33], v14 offset:53248
s_lshl_b32 s9, s13, 12
v_mfma_f32_16x16x32_bf16 v[92:95], v[40:43], a[88:91], v[92:95]
s_sub_u32 s9, s10, s9
s_mul_i32 s91, s14, 18432
s_add_u32 s11, s11, s91
v_mfma_f32_16x16x32_bf16 v[96:99], v[40:43], a[92:95], v[96:99]
s_add_u32 s11, s11, 41943040
ds_read_b64_tr_b16 v[34:35], v14 offset:55296
s_add_u32 s93, s52, 8192
v_mfma_f32_16x16x32_bf16 v[96:99], v[36:39], a[76:79], v[96:99]
s_waitcnt lgkmcnt(4)
s_add_u32 s95, s53, 8192
s_lshl_b32 s94, s58, 8
v_mfma_f32_16x16x32_bf16 v[64:67], v[44:47], a[108:111], v[64:67]
s_add_u32 s94, s94, s11
ds_read_b64_tr_b16 v[36:37], v15 offset:49152
s_add_u32 s94, s94, 8192
v_mfma_f32_16x16x32_bf16 v[64:67], v[48:51], a[124:127], v[64:67]
buffer_load_dwordx4 a[208:211], v1, s[28:31], s66 offen offset:0 sc1
v_mfma_f32_16x16x32_bf16 v[60:63], v[48:51], a[120:123], v[60:63]
s_xor_b32 s91, s13, 1
ds_read_b64_tr_b16 v[38:39], v15 offset:51200
s_mul_i32 s91, s91, s90
v_mfma_f32_16x16x32_bf16 v[60:63], v[44:47], a[104:107], v[60:63]
s_add_u32 s91, s91, 6144
s_add_u32 s39, s91, s11
s_xor_b32 s91, s13, 2
v_mfma_f32_16x16x32_bf16 v[56:59], v[44:47], a[100:103], v[56:59]
s_mul_i32 s91, s91, s90
ds_read_b64_tr_b16 v[40:41], v15 offset:53248
s_add_u32 s91, s91, 13312
v_mfma_f32_16x16x32_bf16 v[56:59], v[48:51], a[116:119], v[56:59]
buffer_load_dwordx4 a[240:243], v1, s[28:31], s67 offen offset:0 sc1
v_mfma_f32_16x16x32_bf16 v[52:55], v[48:51], a[112:115], v[52:55]
s_add_u32 s40, s91, s11
ds_read_b64_tr_b16 v[42:43], v15 offset:55296
s_xor_b32 s91, s13, 3
v_mfma_f32_16x16x32_bf16 v[52:55], v[44:47], a[96:99], v[52:55]
s_waitcnt lgkmcnt(4)
s_mul_i32 s91, s91, s90
s_add_u32 s91, s91, 4096
v_mfma_f32_16x16x32_bf16 v[68:71], v[28:31], a[96:99], v[68:71]
s_add_u32 s41, s91, s11
ds_read_b64_tr_b16 v[44:45], v16 offset:49152
s_xor_b32 s91, s13, 4
v_mfma_f32_16x16x32_bf16 v[68:71], v[32:35], a[112:115], v[68:71]
s_mul_i32 s91, s91, s90
s_add_u32 s91, s91, 11264
s_add_u32 s42, s91, s11
v_mfma_f32_16x16x32_bf16 v[72:75], v[32:35], a[116:119], v[72:75]
s_xor_b32 s91, s13, 5
ds_read_b64_tr_b16 v[46:47], v16 offset:51200
s_mul_i32 s91, s91, s90
v_mfma_f32_16x16x32_bf16 v[72:75], v[28:31], a[100:103], v[72:75]
buffer_load_dwordx4 a[180:183], v1, s[28:31], s65 offen offset:1024 sc1
v_mfma_f32_16x16x32_bf16 v[76:79], v[28:31], a[104:107], v[76:79]
s_add_u32 s91, s91, 2048
ds_read_b64_tr_b16 v[48:49], v16 offset:53248
s_add_u32 s43, s91, s11
v_mfma_f32_16x16x32_bf16 v[76:79], v[32:35], a[120:123], v[76:79]
s_xor_b32 s91, s13, 6
s_mul_i32 s91, s91, s90
s_add_u32 s91, s91, 9216
v_mfma_f32_16x16x32_bf16 v[80:83], v[32:35], a[124:127], v[80:83]
s_add_u32 s44, s91, s11
ds_read_b64_tr_b16 v[50:51], v16 offset:55296
s_xor_b32 s91, s13, 7
v_mfma_f32_16x16x32_bf16 v[80:83], v[28:31], a[108:111], v[80:83]
s_waitcnt lgkmcnt(4)
buffer_load_dwordx4 a[212:215], v1, s[28:31], s66 offen offset:1024 sc1
v_mfma_f32_16x16x32_bf16 v[128:131], v[36:39], a[108:111], v[128:131]
s_mul_i32 s91, s91, s90
ds_read_b64_tr_b16 v[28:29], v13 offset:57344
s_add_u32 s91, s91, 0
v_mfma_f32_16x16x32_bf16 v[128:131], v[40:43], a[124:127], v[128:131]
s_add_u32 s45, s91, s11
s_movk_i32 s90, 0x3f80
s_mov_b32 s91, 0x3f800000
v_mfma_f32_16x16x32_bf16 v[124:127], v[40:43], a[120:123], v[124:127]
s_mov_b32 s92, 0xffff0000
ds_read_b64_tr_b16 v[30:31], v13 offset:59392
s_add_u32 s97, s7, 18432
v_mfma_f32_16x16x32_bf16 v[124:127], v[36:39], a[104:107], v[124:127]
v_mfma_f32_16x16x32_bf16 v[120:123], v[36:39], a[100:103], v[120:123]
ds_read_b64_tr_b16 v[32:33], v13 offset:61440
v_mfma_f32_16x16x32_bf16 v[120:123], v[40:43], a[116:119], v[120:123]
buffer_load_dwordx4 a[244:247], v1, s[28:31], s67 offen offset:1024 sc1
v_mfma_f32_16x16x32_bf16 v[116:119], v[40:43], a[112:115], v[116:119]
ds_read_b64_tr_b16 v[34:35], v13 offset:63488
v_mfma_f32_16x16x32_bf16 v[116:119], v[36:39], a[96:99], v[116:119]
s_waitcnt lgkmcnt(4)
v_mfma_f32_16x16x32_bf16 v[132:135], v[44:47], a[96:99], v[132:135]
ds_read_b64_tr_b16 v[36:37], v14 offset:57344
v_mfma_f32_16x16x32_bf16 v[132:135], v[48:51], a[112:115], v[132:135]
buffer_load_dwordx4 a[184:187], v1, s[28:31], s65 offen offset:2048 sc1
v_mfma_f32_16x16x32_bf16 v[136:139], v[48:51], a[116:119], v[136:139]
ds_read_b64_tr_b16 v[38:39], v14 offset:59392
v_mfma_f32_16x16x32_bf16 v[136:139], v[44:47], a[100:103], v[136:139]
v_mfma_f32_16x16x32_bf16 v[140:143], v[44:47], a[104:107], v[140:143]
ds_read_b64_tr_b16 v[40:41], v14 offset:61440
v_mfma_f32_16x16x32_bf16 v[140:143], v[48:51], a[120:123], v[140:143]
v_mfma_f32_16x16x32_bf16 v[144:147], v[48:51], a[124:127], v[144:147]
ds_read_b64_tr_b16 v[42:43], v14 offset:63488
v_mfma_f32_16x16x32_bf16 v[144:147], v[44:47], a[108:111], v[144:147]
s_waitcnt lgkmcnt(4)
buffer_load_dwordx4 a[216:219], v1, s[28:31], s66 offen offset:2048 sc1
v_mfma_f32_16x16x32_bf16 v[160:163], v[28:31], a[108:111], v[160:163]
ds_read_b64_tr_b16 v[44:45], v21 offset:43008
v_mfma_f32_16x16x32_bf16 v[160:163], v[32:35], a[124:127], v[160:163]
v_mfma_f32_16x16x32_bf16 v[156:159], v[32:35], a[120:123], v[156:159]
ds_read_b64_tr_b16 v[46:47], v21 offset:43520
v_mfma_f32_16x16x32_bf16 v[156:159], v[28:31], a[104:107], v[156:159]
buffer_load_dwordx4 a[248:251], v1, s[28:31], s67 offen offset:2048 sc1
v_mfma_f32_16x16x32_bf16 v[152:155], v[28:31], a[100:103], v[152:155]
ds_read_b64_tr_b16 v[48:49], v21 offset:44032
v_mfma_f32_16x16x32_bf16 v[152:155], v[32:35], a[116:119], v[152:155]
v_mfma_f32_16x16x32_bf16 v[148:151], v[32:35], a[112:115], v[148:151]
ds_read_b64_tr_b16 v[50:51], v21 offset:44544
v_mfma_f32_16x16x32_bf16 v[148:151], v[28:31], a[96:99], v[148:151]
s_waitcnt lgkmcnt(4)
v_mfma_f32_16x16x32_bf16 v[164:167], v[36:39], a[96:99], v[164:167]
ds_read_b64_tr_b16 v[28:29], v17 offset:0
v_mfma_f32_16x16x32_bf16 v[164:167], v[40:43], a[112:115], v[164:167]
buffer_load_dwordx4 a[188:191], v1, s[28:31], s65 offen offset:3072 sc1
v_mfma_f32_16x16x32_bf16 v[168:171], v[40:43], a[116:119], v[168:171]
ds_read_b64_tr_b16 v[30:31], v17 offset:2048
v_mfma_f32_16x16x32_bf16 v[168:171], v[36:39], a[100:103], v[168:171]
v_mfma_f32_16x16x32_bf16 v[172:175], v[36:39], a[104:107], v[172:175]
ds_read_b64_tr_b16 v[32:33], v17 offset:4096
v_mfma_f32_16x16x32_bf16 v[172:175], v[40:43], a[120:123], v[172:175]
buffer_load_dwordx4 a[220:223], v1, s[28:31], s66 offen offset:3072 sc1
v_mfma_f32_16x16x32_bf16 v[176:179], v[40:43], a[124:127], v[176:179]
ds_read_b64_tr_b16 v[34:35], v17 offset:6144
v_mfma_f32_16x16x32_bf16 v[176:179], v[36:39], a[108:111], v[176:179]
s_waitcnt lgkmcnt(4)
v_mfma_f32_16x16x32_bf16 v[96:99], v[44:47], a[108:111], v[96:99]
ds_read_b64_tr_b16 v[36:37], v18 offset:0
v_mfma_f32_16x16x32_bf16 v[96:99], v[48:51], a[124:127], v[96:99]
v_mfma_f32_16x16x32_bf16 v[92:95], v[48:51], a[120:123], v[92:95]
ds_read_b64_tr_b16 v[38:39], v18 offset:2048
v_mfma_f32_16x16x32_bf16 v[92:95], v[44:47], a[104:107], v[92:95]
buffer_load_dwordx4 a[252:255], v1, s[28:31], s67 offen offset:3072 sc1
v_mfma_f32_16x16x32_bf16 v[88:91], v[44:47], a[100:103], v[88:91]
s_add_u32 s65, s65, 28672
ds_read_b64_tr_b16 v[40:41], v18 offset:4096
s_add_u32 s66, s66, 28672
v_mfma_f32_16x16x32_bf16 v[88:91], v[48:51], a[116:119], v[88:91]
s_add_u32 s67, s67, 28672
s_waitcnt vmcnt(12)
v_cmp_eq_u32 vcc, 1, v23
v_mfma_f32_16x16x32_bf16 v[84:87], v[48:51], a[112:115], v[84:87]
ds_read_b64_tr_b16 v[42:43], v18 offset:6144
v_mfma_f32_16x16x32_bf16 v[84:87], v[44:47], a[96:99], v[84:87]
s_waitcnt lgkmcnt(4)
v_mfma_f32_16x16x32_bf16 v[52:55], v[28:31], a[128:131], v[52:55]
ds_read_b64_tr_b16 v[44:45], v19 offset:0
v_mfma_f32_16x16x32_bf16 v[52:55], v[32:35], a[144:147], v[52:55]
s_branch iskip11
.p2align 12
ipad11:
s_branch iret1
s_nop 0
iskip11:
v_mfma_f32_16x16x32_bf16 v[56:59], v[32:35], a[148:151], v[56:59]
s_cmp_eq_u64 vcc, exec
s_cbranch_scc0 sequential_preLN__linear_kernel_hedgehog__glu_gated_bilinear__prompt_kernel_f_slow2
sequential_preLN__linear_kernel_hedgehog__glu_gated_bilinear__prompt_kernel_f_back2:
ds_read_b64_tr_b16 v[46:47], v19 offset:2048
v_mfma_f32_16x16x32_bf16 v[56:59], v[28:31], a[132:135], v[56:59]
buffer_load_dwordx4 v[212:215], v1, s[28:31], s47 offen offset:0 sc1
v_mfma_f32_16x16x32_bf16 v[60:63], v[28:31], a[136:139], v[60:63]
ds_read_b64_tr_b16 v[48:49], v19 offset:4096
v_mfma_f32_16x16x32_bf16 v[60:63], v[32:35], a[152:155], v[60:63]
v_mfma_f32_16x16x32_bf16 v[64:67], v[32:35], a[156:159], v[64:67]
ds_read_b64_tr_b16 v[50:51], v19 offset:6144
v_mfma_f32_16x16x32_bf16 v[64:67], v[28:31], a[140:143], v[64:67]
s_waitcnt lgkmcnt(4)
buffer_load_dwordx4 v[216:219], v1, s[28:31], s47 offen offset:2048 sc1
v_mfma_f32_16x16x32_bf16 v[80:83], v[36:39], a[140:143], v[80:83]
ds_read_b64_tr_b16 v[28:29], v20 offset:0
v_mfma_f32_16x16x32_bf16 v[80:83], v[40:43], a[156:159], v[80:83]
v_mfma_f32_16x16x32_bf16 v[76:79], v[40:43], a[152:155], v[76:79]
ds_read_b64_tr_b16 v[30:31], v20 offset:2048
v_mfma_f32_16x16x32_bf16 v[76:79], v[36:39], a[136:139], v[76:79]
v_mfma_f32_16x16x32_bf16 v[72:75], v[36:39], a[132:135], v[72:75]
ds_read_b64_tr_b16 v[32:33], v20 offset:4096
v_mfma_f32_16x16x32_bf16 v[72:75], v[40:43], a[148:151], v[72:75]
buffer_load_dwordx4 v[220:223], v1, s[28:31], s47 offen offset:1024 sc1
v_mfma_f32_16x16x32_bf16 v[68:71], v[40:43], a[144:147], v[68:71]
ds_read_b64_tr_b16 v[34:35], v20 offset:6144
v_mfma_f32_16x16x32_bf16 v[68:71], v[36:39], a[128:131], v[68:71]
s_waitcnt lgkmcnt(4)
v_mfma_f32_16x16x32_bf16 v[116:119], v[44:47], a[128:131], v[116:119]
ds_read_b64_tr_b16 v[36:37], v17 offset:8192
v_mfma_f32_16x16x32_bf16 v[116:119], v[48:51], a[144:147], v[116:119]
buffer_load_dwordx4 v[224:227], v1, s[28:31], s47 offen offset:3072 sc1
v_mfma_f32_16x16x32_bf16 v[120:123], v[48:51], a[148:151], v[120:123]
s_add_u32 s47, s47, 4096
ds_read_b64_tr_b16 v[38:39], v17 offset:10240
v_mfma_f32_16x16x32_bf16 v[120:123], v[44:47], a[132:135], v[120:123]
v_mfma_f32_16x16x32_bf16 v[124:127], v[44:47], a[136:139], v[124:127]
ds_read_b64_tr_b16 v[40:41], v17 offset:12288
v_mfma_f32_16x16x32_bf16 v[124:127], v[48:51], a[152:155], v[124:127]
v_mfma_f32_16x16x32_bf16 v[128:131], v[48:51], a[156:159], v[128:131]
ds_read_b64_tr_b16 v[42:43], v17 offset:14336
v_mfma_f32_16x16x32_bf16 v[128:131], v[44:47], a[140:143], v[128:131]
s_waitcnt lgkmcnt(4)
buffer_load_dwordx4 v[228:231], v1, s[28:31], s47 offen offset:0 sc1
v_mfma_f32_16x16x32_bf16 v[144:147], v[28:31], a[140:143], v[144:147]
ds_read_b64_tr_b16 v[44:45], v18 offset:8192
v_mfma_f32_16x16x32_bf16 v[144:147], v[32:35], a[156:159], v[144:147]
v_mfma_f32_16x16x32_bf16 v[140:143], v[32:35], a[152:155], v[140:143]
ds_read_b64_tr_b16 v[46:47], v18 offset:10240
v_mfma_f32_16x16x32_bf16 v[140:143], v[28:31], a[136:139], v[140:143]
buffer_load_dwordx4 v[232:235], v1, s[28:31], s47 offen offset:2048 sc1
v_mfma_f32_16x16x32_bf16 v[136:139], v[28:31], a[132:135], v[136:139]
ds_read_b64_tr_b16 v[48:49], v18 offset:12288
v_mfma_f32_16x16x32_bf16 v[136:139], v[32:35], a[148:151], v[136:139]
v_mfma_f32_16x16x32_bf16 v[132:135], v[32:35], a[144:147], v[132:135]
ds_read_b64_tr_b16 v[50:51], v18 offset:14336
v_mfma_f32_16x16x32_bf16 v[132:135], v[28:31], a[128:131], v[132:135]
s_waitcnt lgkmcnt(4)
v_mfma_f32_16x16x32_bf16 v[148:151], v[36:39], a[128:131], v[148:151]
ds_read_b64_tr_b16 v[28:29], v21 offset:45056
v_mfma_f32_16x16x32_bf16 v[148:151], v[40:43], a[144:147], v[148:151]
buffer_load_dwordx4 v[236:239], v1, s[28:31], s47 offen offset:1024 sc1
v_mfma_f32_16x16x32_bf16 v[152:155], v[40:43], a[148:151], v[152:155]
ds_read_b64_tr_b16 v[30:31], v21 offset:45568
v_mfma_f32_16x16x32_bf16 v[152:155], v[36:39], a[132:135], v[152:155]
v_mfma_f32_16x16x32_bf16 v[156:159], v[36:39], a[136:139], v[156:159]
ds_read_b64_tr_b16 v[32:33], v21 offset:46080
v_mfma_f32_16x16x32_bf16 v[156:159], v[40:43], a[152:155], v[156:159]
buffer_load_dwordx4 v[240:243], v1, s[28:31], s47 offen offset:3072 sc1
v_mfma_f32_16x16x32_bf16 v[160:163], v[40:43], a[156:159], v[160:163]
s_add_u32 s47, s47, 4096
ds_read_b64_tr_b16 v[34:35], v21 offset:46592
s_add_u32 m0, s34, 0
v_mfma_f32_16x16x32_bf16 v[160:163], v[36:39], a[140:143], v[160:163]
s_waitcnt lgkmcnt(4)
s_barrier
v_mfma_f32_16x16x32_bf16 v[176:179], v[44:47], a[140:143], v[176:179]
ds_read_b64_tr_b16 v[36:37], v21 offset:47104
v_mfma_f32_16x16x32_bf16 v[176:179], v[48:51], a[156:159], v[176:179]
v_mfma_f32_16x16x32_bf16 v[172:175], v[48:51], a[152:155], v[172:175]
ds_read_b64_tr_b16 v[38:39], v21 offset:47616
v_mfma_f32_16x16x32_bf16 v[172:175], v[44:47], a[136:139], v[172:175]
buffer_load_dwordx4 v8, s[20:23], s48 offen offset:0 sc1 lds
v_mfma_f32_16x16x32_bf16 v[168:171], v[44:47], a[132:135], v[168:171]
ds_read_b64_tr_b16 v[40:41], v21 offset:48128
v_mfma_f32_16x16x32_bf16 v[168:171], v[48:51], a[148:151], v[168:171]
v_mfma_f32_16x16x32_bf16 v[164:167], v[48:51], a[144:147], v[164:167]
ds_read_b64_tr_b16 v[42:43], v21 offset:48640
v_mfma_f32_16x16x32_bf16 v[164:167], v[44:47], a[128:131], v[164:167]
s_waitcnt lgkmcnt(4)
buffer_load_dwordx4 v9, s[20:23], s48 offen offset:1024 sc1 lds
v_mfma_f32_16x16x32_bf16 v[84:87], v[28:31], a[128:131], v[84:87]
ds_read_b64_tr_b16 v[44:45], v21 offset:49152
v_mfma_f32_16x16x32_bf16 v[84:87], v[32:35], a[144:147], v[84:87]
v_mfma_f32_16x16x32_bf16 v[88:91], v[32:35], a[148:151], v[88:91]
ds_read_b64_tr_b16 v[46:47], v21 offset:49664
v_mfma_f32_16x16x32_bf16 v[88:91], v[28:31], a[132:135], v[88:91]
buffer_load_dwordx4 v10, s[20:23], s48 offen offset:2048 sc1 lds
v_mfma_f32_16x16x32_bf16 v[92:95], v[28:31], a[136:139], v[92:95]
ds_read_b64_tr_b16 v[48:49], v21 offset:50176
v_mfma_f32_16x16x32_bf16 v[92:95], v[32:35], a[152:155], v[92:95]
v_mfma_f32_16x16x32_bf16 v[96:99], v[32:35], a[156:159], v[96:99]
ds_read_b64_tr_b16 v[50:51], v21 offset:50688
v_mfma_f32_16x16x32_bf16 v[96:99], v[28:31], a[140:143], v[96:99]
s_waitcnt vmcnt(13) lgkmcnt(4)
buffer_load_dwordx4 v11, s[20:23], s48 offen offset:3072 sc1 lds
v_mfma_f32_16x16x32_bf16 v[96:99], v[36:39], a[172:175], v[96:99]
ds_read_b64_tr_b16 v[28:29], v21 offset:51200
v_mfma_f32_16x16x32_bf16 v[96:99], v[40:43], a[188:191], v[96:99]
v_mfma_f32_16x16x32_bf16 v[92:95], v[40:43], a[184:187], v[92:95]
ds_read_b64_tr_b16 v[30:31], v21 offset:51712
v_mfma_f32_16x16x32_bf16 v[92:95], v[36:39], a[168:171], v[92:95]
buffer_load_dwordx2 v[246:247], v100, s[28:31], s6 offen offset:0 sc1
v_mfma_f32_16x16x32_bf16 v[88:91], v[36:39], a[164:167], v[88:91]
ds_read_b64_tr_b16 v[32:33], v21 offset:52224
v_mfma_f32_16x16x32_bf16 v[88:91], v[40:43], a[180:183], v[88:91]
v_mfma_f32_16x16x32_bf16 v[84:87], v[40:43], a[176:179], v[84:87]
ds_read_b64_tr_b16 v[34:35], v21 offset:52736
v_mfma_f32_16x16x32_bf16 v[84:87], v[36:39], a[160:163], v[84:87]
s_waitcnt vmcnt(14) lgkmcnt(4)
buffer_load_dwordx2 v[248:249], v109, s[28:31], s6 offen offset:0 sc1
v_mfma_f32_16x16x32_bf16 v[84:87], v[44:47], a[192:195], v[84:87]
ds_read_b64_tr_b16 v[36:37], v17 offset:16384
v_mfma_f32_16x16x32_bf16 v[84:87], v[48:51], a[208:211], v[84:87]
v_mfma_f32_16x16x32_bf16 v[88:91], v[48:51], a[212:215], v[88:91]
ds_read_b64_tr_b16 v[38:39], v17 offset:18432
v_mfma_f32_16x16x32_bf16 v[88:91], v[44:47], a[196:199], v[88:91]
buffer_load_dwordx2 v[252:253], v101, s[28:31], s6 offen offset:0 sc1
v_mfma_f32_16x16x32_bf16 v[92:95], v[44:47], a[200:203], v[92:95]
ds_read_b64_tr_b16 v[40:41], v17 offset:20480
v_mfma_f32_16x16x32_bf16 v[92:95], v[48:51], a[216:219], v[92:95]
v_mfma_f32_16x16x32_bf16 v[96:99], v[48:51], a[220:223], v[96:99]
ds_read_b64_tr_b16 v[42:43], v17 offset:22528
v_mfma_f32_16x16x32_bf16 v[96:99], v[44:47], a[204:207], v[96:99]
s_waitcnt vmcnt(15) lgkmcnt(4)
buffer_load_dwordx2 v[254:255], v2, s[28:31], s6 offen offset:0 sc1
v_mfma_f32_16x16x32_bf16 v[84:87], v[28:31], a[224:227], v[84:87]
ds_read_b64_tr_b16 v[44:45], v17 offset:32768
v_mfma_f32_16x16x32_bf16 v[84:87], v[32:35], a[240:243], v[84:87]
v_mfma_f32_16x16x32_bf16 v[88:91], v[32:35], a[244:247], v[88:91]
ds_read_b64_tr_b16 v[46:47], v17 offset:34816
v_mfma_f32_16x16x32_bf16 v[88:91], v[28:31], a[228:231], v[88:91]
buffer_load_dword v3, v102, s[28:31], s6 offen offset:0 sc1
v_mfma_f32_16x16x32_bf16 v[92:95], v[28:31], a[232:235], v[92:95]
ds_read_b64_tr_b16 v[48:49], v17 offset:36864
v_mfma_f32_16x16x32_bf16 v[92:95], v[32:35], a[248:251], v[92:95]
v_mfma_f32_16x16x32_bf16 v[96:99], v[32:35], a[252:255], v[96:99]
ds_read_b64_tr_b16 v[50:51], v17 offset:38912
v_mfma_f32_16x16x32_bf16 v[96:99], v[28:31], a[236:239], v[96:99]
s_waitcnt lgkmcnt(4)
v_mfma_f32_16x16x32_bf16 v[52:55], v[36:39], a[160:163], v[52:55]
s_waitcnt vmcnt(9)
ds_read_b64_tr_b16 v[28:29], v17 offset:49152
v_mfma_f32_16x16x32_bf16 v[52:55], v[40:43], a[176:179], v[52:55]
v_swap_b32 v214, v216
v_mfma_f32_16x16x32_bf16 v[56:59], v[40:43], a[180:183], v[56:59]
ds_read_b64_tr_b16 v[30:31], v17 offset:51200
v_mfma_f32_16x16x32_bf16 v[56:59], v[36:39], a[164:167], v[56:59]
v_swap_b32 v215, v217
v_mfma_f32_16x16x32_bf16 v[60:63], v[36:39], a[168:171], v[60:63]
ds_read_b64_tr_b16 v[32:33], v17 offset:53248
v_mfma_f32_16x16x32_bf16 v[60:63], v[40:43], a[184:187], v[60:63]
v_swap_b32 v222, v224
v_mfma_f32_16x16x32_bf16 v[64:67], v[40:43], a[188:191], v[64:67]
ds_read_b64_tr_b16 v[34:35], v17 offset:55296
v_mfma_f32_16x16x32_bf16 v[64:67], v[36:39], a[172:175], v[64:67]
s_waitcnt lgkmcnt(4)
v_swap_b32 v223, v225
v_mfma_f32_16x16x32_bf16 v[64:67], v[44:47], a[204:207], v[64:67]
ds_read_b64_tr_b16 v[36:37], v21 offset:53248
v_mfma_f32_16x16x32_bf16 v[64:67], v[48:51], a[220:223], v[64:67]
v_swap_b32 v230, v232
v_mfma_f32_16x16x32_bf16 v[60:63], v[48:51], a[216:219], v[60:63]
ds_read_b64_tr_b16 v[38:39], v21 offset:53760
v_mfma_f32_16x16x32_bf16 v[60:63], v[44:47], a[200:203], v[60:63]
v_swap_b32 v231, v233
v_mfma_f32_16x16x32_bf16 v[56:59], v[44:47], a[196:199], v[56:59]
ds_read_b64_tr_b16 v[40:41], v21 offset:54272
v_mfma_f32_16x16x32_bf16 v[56:59], v[48:51], a[212:215], v[56:59]
v_swap_b32 v238, v240
v_mfma_f32_16x16x32_bf16 v[52:55], v[48:51], a[208:211], v[52:55]
ds_read_b64_tr_b16 v[42:43], v21 offset:54784
v_mfma_f32_16x16x32_bf16 v[52:55], v[44:47], a[192:195], v[52:55]
s_waitcnt vmcnt(5) lgkmcnt(4)
s_barrier
v_mfma_f32_16x16x32_bf16 v[52:55], v[28:31], a[224:227], v[52:55]
ds_read_b64_tr_b16 v[44:45], v13 offset:0
v_mfma_f32_16x16x32_bf16 v[52:55], v[32:35], a[240:243], v[52:55]
v_swap_b32 v239, v241
v_mfma_f32_16x16x32_bf16 v[56:59], v[32:35], a[244:247], v[56:59]
ds_read_b64_tr_b16 v[46:47], v13 offset:2048
v_mfma_f32_16x16x32_bf16 v[56:59], v[28:31], a[228:231], v[56:59]
v_mfma_f32_16x16x32_bf16 v[60:63], v[28:31], a[232:235], v[60:63]
ds_read_b64_tr_b16 v[48:49], v13 offset:4096
v_mfma_f32_16x16x32_bf16 v[60:63], v[32:35], a[248:251], v[60:63]
v_mfma_f32_16x16x32_bf16 v[64:67], v[32:35], a[252:255], v[64:67]
ds_read_b64_tr_b16 v[50:51], v13 offset:6144
v_mfma_f32_16x16x32_bf16 v[64:67], v[28:31], a[236:239], v[64:67]
s_waitcnt lgkmcnt(4)
v_mfma_f32_16x16x32_bf16 v[84:87], v[36:39], v[212:215], v[84:87]
ds_read_b64_tr_b16 v[28:29], v18 offset:16384
v_mfma_f32_16x16x32_bf16 v[84:87], v[40:43], v[228:231], v[84:87]
v_mfma_f32_16x16x32_bf16 v[88:91], v[40:43], v[232:235], v[88:91]
ds_read_b64_tr_b16 v[30:31], v18 offset:18432
v_mfma_f32_16x16x32_bf16 v[88:91], v[36:39], v[216:219], v[88:91]
v_mfma_f32_16x16x32_bf16 v[92:95], v[36:39], v[220:223], v[92:95]
ds_read_b64_tr_b16 v[32:33], v18 offset:20480
v_mfma_f32_16x16x32_bf16 v[92:95], v[40:43], v[236:239], v[92:95]
v_mfma_f32_16x16x32_bf16 v[96:99], v[40:43], v[240:243], v[96:99]
ds_read_b64_tr_b16 v[34:35], v18 offset:22528
v_mfma_f32_16x16x32_bf16 v[96:99], v[36:39], v[224:227], v[96:99]
s_waitcnt lgkmcnt(4)
v_mfma_f32_16x16x32_bf16 v[52:55], v[44:47], v[212:215], v[52:55]
ds_read_b64_tr_b16 v[36:37], v18 offset:32768
v_cvt_pk_bf16_f32 v84, v84, v85
v_mfma_f32_16x16x32_bf16 v[52:55], v[48:51], v[228:231], v[52:55]
v_cvt_pk_bf16_f32 v85, v86, v87
v_cvt_pk_bf16_f32 v86, v88, v89
v_mfma_f32_16x16x32_bf16 v[56:59], v[48:51], v[232:235], v[56:59]
ds_read_b64_tr_b16 v[38:39], v18 offset:34816
v_cvt_pk_bf16_f32 v87, v90, v91
v_mfma_f32_16x16x32_bf16 v[56:59], v[44:47], v[216:219], v[56:59]
buffer_store_dwordx4 v[84:87], v107, s[28:31], s93 offen sc1
v_cvt_pk_bf16_f32 v92, v92, v93
v_mfma_f32_16x16x32_bf16 v[60:63], v[44:47], v[220:223], v[60:63]
ds_read_b64_tr_b16 v[40:41], v18 offset:36864
v_cvt_pk_bf16_f32 v93, v94, v95
v_mfma_f32_16x16x32_bf16 v[60:63], v[48:51], v[236:239], v[60:63]
v_cvt_pk_bf16_f32 v94, v96, v97
v_cvt_pk_bf16_f32 v95, v98, v99
v_mfma_f32_16x16x32_bf16 v[64:67], v[48:51], v[240:243], v[64:67]
ds_read_b64_tr_b16 v[42:43], v18 offset:38912
v_mfma_f32_16x16x32_bf16 v[64:67], v[44:47], v[224:227], v[64:67]
s_waitcnt lgkmcnt(4)
buffer_store_dwordx4 v[92:95], v107, s[28:31], s95 offen sc1
v_mfma_f32_16x16x32_bf16 v[80:83], v[28:31], a[172:175], v[80:83]
ds_read_b64_tr_b16 v[44:45], v18 offset:49152
v_cvt_pk_bf16_f32 v52, v52, v53
v_mfma_f32_16x16x32_bf16 v[80:83], v[32:35], a[188:191], v[80:83]
v_cvt_pk_bf16_f32 v53, v54, v55
v_cvt_pk_bf16_f32 v54, v56, v57
v_mfma_f32_16x16x32_bf16 v[76:79], v[32:35], a[184:187], v[76:79]
ds_read_b64_tr_b16 v[46:47], v18 offset:51200
v_cvt_pk_bf16_f32 v55, v58, v59
v_mfma_f32_16x16x32_bf16 v[76:79], v[28:31], a[168:171], v[76:79]
buffer_store_dwordx4 v[52:55], v1, s[28:31], s52 offen offset:0 sc1
v_cvt_pk_bf16_f32 v60, v60, v61
v_mfma_f32_16x16x32_bf16 v[72:75], v[28:31], a[164:167], v[72:75]
ds_read_b64_tr_b16 v[48:49], v18 offset:53248
v_cvt_pk_bf16_f32 v61, v62, v63
v_mfma_f32_16x16x32_bf16 v[72:75], v[32:35], a[180:183], v[72:75]
v_cvt_pk_bf16_f32 v62, v64, v65
v_cvt_pk_bf16_f32 v63, v66, v67
v_mfma_f32_16x16x32_bf16 v[68:71], v[32:35], a[176:179], v[68:71]
ds_read_b64_tr_b16 v[50:51], v18 offset:55296
v_mfma_f32_16x16x32_bf16 v[68:71], v[28:31], a[160:163], v[68:71]
s_waitcnt lgkmcnt(4)
buffer_store_dwordx4 v[60:63], v1, s[28:31], s53 offen offset:0 sc1
v_mfma_f32_16x16x32_bf16 v[68:71], v[36:39], a[192:195], v[68:71]
ds_read_b64_tr_b16 v[28:29], v14 offset:0
v_mfma_f32_16x16x32_bf16 v[68:71], v[40:43], a[208:211], v[68:71]
v_mfma_f32_16x16x32_bf16 v[72:75], v[40:43], a[212:215], v[72:75]
ds_read_b64_tr_b16 v[30:31], v14 offset:2048
v_mfma_f32_16x16x32_bf16 v[72:75], v[36:39], a[196:199], v[72:75]
v_mfma_f32_16x16x32_bf16 v[76:79], v[36:39], a[200:203], v[76:79]
ds_read_b64_tr_b16 v[32:33], v14 offset:4096
v_mfma_f32_16x16x32_bf16 v[76:79], v[40:43], a[216:219], v[76:79]
v_mfma_f32_16x16x32_bf16 v[80:83], v[40:43], a[220:223], v[80:83]
ds_read_b64_tr_b16 v[34:35], v14 offset:6144
v_mfma_f32_16x16x32_bf16 v[80:83], v[36:39], a[204:207], v[80:83]
s_waitcnt lgkmcnt(4)
v_mfma_f32_16x16x32_bf16 v[80:83], v[44:47], a[236:239], v[80:83]
ds_read_b64_tr_b16 v[36:37], v19 offset:16384
v_mfma_f32_16x16x32_bf16 v[80:83], v[48:51], a[252:255], v[80:83]
v_mfma_f32_16x16x32_bf16 v[76:79], v[48:51], a[248:251], v[76:79]
ds_read_b64_tr_b16 v[38:39], v19 offset:18432
v_mfma_f32_16x16x32_bf16 v[76:79], v[44:47], a[232:235], v[76:79]
v_mfma_f32_16x16x32_bf16 v[72:75], v[44:47], a[228:231], v[72:75]
ds_read_b64_tr_b16 v[40:41], v19 offset:20480
v_mfma_f32_16x16x32_bf16 v[72:75], v[48:51], a[244:247], v[72:75]
v_mfma_f32_16x16x32_bf16 v[68:71], v[48:51], a[240:243], v[68:71]
ds_read_b64_tr_b16 v[42:43], v19 offset:22528
v_mfma_f32_16x16x32_bf16 v[68:71], v[44:47], a[224:227], v[68:71]
s_waitcnt lgkmcnt(4)
v_mfma_f32_16x16x32_bf16 v[68:71], v[28:31], v[212:215], v[68:71]
ds_read_b64_tr_b16 v[44:45], v19 offset:32768
v_mfma_f32_16x16x32_bf16 v[68:71], v[32:35], v[228:231], v[68:71]
v_mfma_f32_16x16x32_bf16 v[72:75], v[32:35], v[232:235], v[72:75]
ds_read_b64_tr_b16 v[46:47], v19 offset:34816
v_mfma_f32_16x16x32_bf16 v[72:75], v[28:31], v[216:219], v[72:75]
v_mfma_f32_16x16x32_bf16 v[76:79], v[28:31], v[220:223], v[76:79]
ds_read_b64_tr_b16 v[48:49], v19 offset:36864
v_mfma_f32_16x16x32_bf16 v[76:79], v[32:35], v[236:239], v[76:79]
v_mfma_f32_16x16x32_bf16 v[80:83], v[32:35], v[240:243], v[80:83]
ds_read_b64_tr_b16 v[50:51], v19 offset:38912
v_mfma_f32_16x16x32_bf16 v[80:83], v[28:31], v[224:227], v[80:83]
s_waitcnt lgkmcnt(4)
v_mfma_f32_16x16x32_bf16 v[128:131], v[36:39], a[172:175], v[128:131]
ds_read_b64_tr_b16 v[28:29], v19 offset:49152
v_cvt_pk_bf16_f32 v68, v68, v69
v_mfma_f32_16x16x32_bf16 v[128:131], v[40:43], a[188:191], v[128:131]
v_cvt_pk_bf16_f32 v69, v70, v71
v_cvt_pk_bf16_f32 v70, v72, v73
v_mfma_f32_16x16x32_bf16 v[124:127], v[40:43], a[184:187], v[124:127]
ds_read_b64_tr_b16 v[30:31], v19 offset:51200
v_cvt_pk_bf16_f32 v71, v74, v75
v_mfma_f32_16x16x32_bf16 v[124:127], v[36:39], a[168:171], v[124:127]
buffer_store_dwordx4 v[68:71], v1, s[28:31], s52 offen offset:1024 sc1
v_cvt_pk_bf16_f32 v76, v76, v77
v_mfma_f32_16x16x32_bf16 v[120:123], v[36:39], a[164:167], v[120:123]
ds_read_b64_tr_b16 v[32:33], v19 offset:53248
v_cvt_pk_bf16_f32 v77, v78, v79
v_mfma_f32_16x16x32_bf16 v[120:123], v[40:43], a[180:183], v[120:123]
v_cvt_pk_bf16_f32 v78, v80, v81
v_cvt_pk_bf16_f32 v79, v82, v83
v_mfma_f32_16x16x32_bf16 v[116:119], v[40:43], a[176:179], v[116:119]
ds_read_b64_tr_b16 v[34:35], v19 offset:55296
v_mfma_f32_16x16x32_bf16 v[116:119], v[36:39], a[160:163], v[116:119]
s_waitcnt lgkmcnt(4)
buffer_store_dwordx4 v[76:79], v1, s[28:31], s53 offen offset:1024 sc1
v_mfma_f32_16x16x32_bf16 v[116:119], v[44:47], a[192:195], v[116:119]
ds_read_b64_tr_b16 v[36:37], v15 offset:0
v_mfma_f32_16x16x32_bf16 v[116:119], v[48:51], a[208:211], v[116:119]
v_mfma_f32_16x16x32_bf16 v[120:123], v[48:51], a[212:215], v[120:123]
ds_read_b64_tr_b16 v[38:39], v15 offset:2048
v_mfma_f32_16x16x32_bf16 v[120:123], v[44:47], a[196:199], v[120:123]
v_mfma_f32_16x16x32_bf16 v[124:127], v[44:47], a[200:203], v[124:127]
ds_read_b64_tr_b16 v[40:41], v15 offset:4096
v_mfma_f32_16x16x32_bf16 v[124:127], v[48:51], a[216:219], v[124:127]
v_mfma_f32_16x16x32_bf16 v[128:131], v[48:51], a[220:223], v[128:131]
ds_read_b64_tr_b16 v[42:43], v15 offset:6144
v_mfma_f32_16x16x32_bf16 v[128:131], v[44:47], a[204:207], v[128:131]
s_waitcnt lgkmcnt(4)
v_mfma_f32_16x16x32_bf16 v[128:131], v[28:31], a[236:239], v[128:131]
ds_read_b64_tr_b16 v[44:45], v20 offset:16384
v_mfma_f32_16x16x32_bf16 v[128:131], v[32:35], a[252:255], v[128:131]
v_mfma_f32_16x16x32_bf16 v[124:127], v[32:35], a[248:251], v[124:127]
ds_read_b64_tr_b16 v[46:47], v20 offset:18432
v_mfma_f32_16x16x32_bf16 v[124:127], v[28:31], a[232:235], v[124:127]
v_mfma_f32_16x16x32_bf16 v[120:123], v[28:31], a[228:231], v[120:123]
ds_read_b64_tr_b16 v[48:49], v20 offset:20480
v_mfma_f32_16x16x32_bf16 v[120:123], v[32:35], a[244:247], v[120:123]
v_mfma_f32_16x16x32_bf16 v[116:119], v[32:35], a[240:243], v[116:119]
ds_read_b64_tr_b16 v[50:51], v20 offset:22528
v_mfma_f32_16x16x32_bf16 v[116:119], v[28:31], a[224:227], v[116:119]
s_waitcnt lgkmcnt(4)
v_mfma_f32_16x16x32_bf16 v[116:119], v[36:39], v[212:215], v[116:119]
ds_read_b64_tr_b16 v[28:29], v20 offset:32768
v_mfma_f32_16x16x32_bf16 v[116:119], v[40:43], v[228:231], v[116:119]
v_mfma_f32_16x16x32_bf16 v[120:123], v[40:43], v[232:235], v[120:123]
ds_read_b64_tr_b16 v[30:31], v20 offset:34816
v_mfma_f32_16x16x32_bf16 v[120:123], v[36:39], v[216:219], v[120:123]
v_mfma_f32_16x16x32_bf16 v[124:127], v[36:39], v[220:223], v[124:127]
ds_read_b64_tr_b16 v[32:33], v20 offset:36864
v_mfma_f32_16x16x32_bf16 v[124:127], v[40:43], v[236:239], v[124:127]
v_mfma_f32_16x16x32_bf16 v[128:131], v[40:43], v[240:243], v[128:131]
ds_read_b64_tr_b16 v[34:35], v20 offset:38912
v_mfma_f32_16x16x32_bf16 v[128:131], v[36:39], v[224:227], v[128:131]
s_waitcnt lgkmcnt(4)
v_mfma_f32_16x16x32_bf16 v[144:147], v[44:47], a[172:175], v[144:147]
s_waitcnt vmcnt(6)
ds_read_b64_tr_b16 v[36:37], v20 offset:49152
v_cvt_pk_bf16_f32 v116, v116, v117
v_mfma_f32_16x16x32_bf16 v[144:147], v[48:51], a[188:191], v[144:147]
v_cvt_pk_bf16_f32 v117, v118, v119
v_cvt_pk_bf16_f32 v118, v120, v121
v_mfma_f32_16x16x32_bf16 v[140:143], v[48:51], a[184:187], v[140:143]
ds_read_b64_tr_b16 v[38:39], v20 offset:51200
v_cvt_pk_bf16_f32 v119, v122, v123
v_mfma_f32_16x16x32_bf16 v[140:143], v[44:47], a[168:171], v[140:143]
buffer_store_dwordx4 v[116:119], v1, s[28:31], s52 offen offset:2048 sc1
v_cvt_pk_bf16_f32 v124, v124, v125
v_mfma_f32_16x16x32_bf16 v[136:139], v[44:47], a[164:167], v[136:139]
ds_read_b64_tr_b16 v[40:41], v20 offset:53248
v_cvt_pk_bf16_f32 v125, v126, v127
v_mfma_f32_16x16x32_bf16 v[136:139], v[48:51], a[180:183], v[136:139]
v_cvt_pk_bf16_f32 v126, v128, v129
v_cvt_pk_bf16_f32 v127, v130, v131
v_mfma_f32_16x16x32_bf16 v[132:135], v[48:51], a[176:179], v[132:135]
ds_read_b64_tr_b16 v[42:43], v20 offset:55296
v_lshlrev_b32 v84, 16, v246
v_mfma_f32_16x16x32_bf16 v[132:135], v[44:47], a[160:163], v[132:135]
s_waitcnt lgkmcnt(4)
buffer_store_dwordx4 v[124:127], v1, s[28:31], s53 offen offset:2048 sc1
v_and_b32 v85, s92, v246
v_mfma_f32_16x16x32_bf16 v[132:135], v[28:31], a[192:195], v[132:135]
ds_read_b64_tr_b16 v[44:45], v16 offset:0
v_add_f32 v84, v84, v6
v_mfma_f32_16x16x32_bf16 v[132:135], v[32:35], a[208:211], v[132:135]
v_add_f32 v85, v85, v6
v_lshlrev_b32 v86, 16, v247
v_mfma_f32_16x16x32_bf16 v[136:139], v[32:35], a[212:215], v[136:139]
ds_read_b64_tr_b16 v[46:47], v16 offset:2048
v_and_b32 v87, s92, v247
v_mfma_f32_16x16x32_bf16 v[136:139], v[28:31], a[196:199], v[136:139]
v_add_f32 v86, v86, v6
v_add_f32 v87, v87, v6
v_mfma_f32_16x16x32_bf16 v[140:143], v[28:31], a[200:203], v[140:143]
ds_read_b64_tr_b16 v[48:49], v16 offset:4096
v_lshlrev_b32 v88, 16, v248
v_mfma_f32_16x16x32_bf16 v[140:143], v[32:35], a[216:219], v[140:143]
v_and_b32 v89, s92, v248
v_add_f32 v88, v88, v7
v_mfma_f32_16x16x32_bf16 v[144:147], v[32:35], a[220:223], v[144:147]
ds_read_b64_tr_b16 v[50:51], v16 offset:6144
v_add_f32 v89, v89, v7
v_mfma_f32_16x16x32_bf16 v[144:147], v[28:31], a[204:207], v[144:147]
s_waitcnt lgkmcnt(4)
v_lshlrev_b32 v90, 16, v249
v_and_b32 v91, s92, v249
v_mfma_f32_16x16x32_bf16 v[144:147], v[36:39], a[236:239], v[144:147]
ds_read_b64_tr_b16 v[28:29], v17 offset:24576
v_add_f32 v90, v90, v7
v_mfma_f32_16x16x32_bf16 v[144:147], v[40:43], a[252:255], v[144:147]
v_add_f32 v91, v91, v7
v_lshlrev_b32 v92, 16, v252
v_mfma_f32_16x16x32_bf16 v[140:143], v[40:43], a[248:251], v[140:143]
ds_read_b64_tr_b16 v[30:31], v17 offset:26624
v_and_b32 v93, s92, v252
v_mfma_f32_16x16x32_bf16 v[140:143], v[36:39], a[232:235], v[140:143]
v_add_f32 v92, v92, v6
v_add_f32 v93, v93, v6
v_mfma_f32_16x16x32_bf16 v[136:139], v[36:39], a[228:231], v[136:139]
ds_read_b64_tr_b16 v[32:33], v17 offset:28672
v_lshlrev_b32 v94, 16, v253
v_mfma_f32_16x16x32_bf16 v[136:139], v[40:43], a[244:247], v[136:139]
v_and_b32 v95, s92, v253
v_add_f32 v94, v94, v6
v_mfma_f32_16x16x32_bf16 v[132:135], v[40:43], a[240:243], v[132:135]
ds_read_b64_tr_b16 v[34:35], v17 offset:30720
v_add_f32 v95, v95, v6
v_mfma_f32_16x16x32_bf16 v[132:135], v[36:39], a[224:227], v[132:135]
s_waitcnt lgkmcnt(4)
v_lshlrev_b32 v96, 16, v254
v_and_b32 v97, s92, v254
v_mfma_f32_16x16x32_bf16 v[132:135], v[44:47], v[212:215], v[132:135]
ds_read_b64_tr_b16 v[36:37], v17 offset:40960
v_add_f32 v96, v96, v7
v_mfma_f32_16x16x32_bf16 v[132:135], v[48:51], v[228:231], v[132:135]
v_add_f32 v97, v97, v7
v_lshlrev_b32 v98, 16, v255
v_mfma_f32_16x16x32_bf16 v[136:139], v[48:51], v[232:235], v[136:139]
ds_read_b64_tr_b16 v[38:39], v17 offset:43008
v_and_b32 v99, s92, v255
v_mfma_f32_16x16x32_bf16 v[136:139], v[44:47], v[216:219], v[136:139]
v_add_f32 v98, v98, v7
v_add_f32 v99, v99, v7
v_mfma_f32_16x16x32_bf16 v[140:143], v[44:47], v[220:223], v[140:143]
ds_read_b64_tr_b16 v[40:41], v17 offset:45056
v_cndmask_b32 v52, v4, v5, s[88:89]
v_mfma_f32_16x16x32_bf16 v[140:143], v[48:51], v[236:239], v[140:143]
v_cndmask_b32 v53, v6, v7, s[88:89]
v_lshlrev_b32 v56, 16, v3
v_mfma_f32_16x16x32_bf16 v[144:147], v[48:51], v[240:243], v[144:147]
ds_read_b64_tr_b16 v[42:43], v17 offset:47104
v_and_b32 v57, s92, v3
v_mfma_f32_16x16x32_bf16 v[144:147], v[44:47], v[224:227], v[144:147]
s_waitcnt lgkmcnt(4)
ds_bpermute_b32 v54, v110, v52
ds_bpermute_b32 v55, v110, v53
v_mfma_f32_16x16x32_bf16 v[160:163], v[28:31], a[172:175], v[160:163]
ds_read_b64_tr_b16 v[44:45], v17 offset:57344
v_cvt_pk_bf16_f32 v132, v132, v133
v_mfma_f32_16x16x32_bf16 v[160:163], v[32:35], a[188:191], v[160:163]
v_cvt_pk_bf16_f32 v133, v134, v135
v_cvt_pk_bf16_f32 v134, v136, v137
v_mfma_f32_16x16x32_bf16 v[156:159], v[32:35], a[184:187], v[156:159]
ds_read_b64_tr_b16 v[46:47], v17 offset:59392
v_cvt_pk_bf16_f32 v135, v138, v139
v_mfma_f32_16x16x32_bf16 v[156:159], v[28:31], a[168:171], v[156:159]
buffer_store_dwordx4 v[132:135], v1, s[28:31], s52 offen offset:3072 sc1
v_cvt_pk_bf16_f32 v140, v140, v141
v_mfma_f32_16x16x32_bf16 v[152:155], v[28:31], a[164:167], v[152:155]
s_add_u32 s52, s52, 4096
ds_read_b64_tr_b16 v[48:49], v17 offset:61440
v_cvt_pk_bf16_f32 v141, v142, v143
v_mfma_f32_16x16x32_bf16 v[152:155], v[32:35], a[180:183], v[152:155]
v_cvt_pk_bf16_f32 v142, v144, v145
v_cvt_pk_bf16_f32 v143, v146, v147
v_mfma_f32_16x16x32_bf16 v[148:151], v[32:35], a[176:179], v[148:151]
ds_read_b64_tr_b16 v[50:51], v17 offset:63488
v_mov_b32 v60, 0
v_mfma_f32_16x16x32_bf16 v[148:151], v[28:31], a[160:163], v[148:151]
s_waitcnt lgkmcnt(6)
buffer_store_dwordx4 v[140:143], v1, s[28:31], s53 offen offset:3072 sc1
v_mov_b32 v61, 0
v_mfma_f32_16x16x32_bf16 v[148:151], v[36:39], a[192:195], v[148:151]
s_add_u32 s53, s53, 4096
ds_read_b64_tr_b16 v[28:29], v13 offset:8192
v_mov_b32 v62, 0
v_mfma_f32_16x16x32_bf16 v[148:151], v[40:43], a[208:211], v[148:151]
v_mov_b32 v63, 0
v_mov_b32 v64, 0
v_mfma_f32_16x16x32_bf16 v[152:155], v[40:43], a[212:215], v[152:155]
ds_read_b64_tr_b16 v[30:31], v13 offset:10240
v_mov_b32 v65, 0
v_mfma_f32_16x16x32_bf16 v[152:155], v[36:39], a[196:199], v[152:155]
v_mov_b32 v66, 0
v_mov_b32 v67, 0
v_mfma_f32_16x16x32_bf16 v[156:159], v[36:39], a[200:203], v[156:159]
s_waitcnt lgkmcnt(6)
ds_read_b64_tr_b16 v[32:33], v13 offset:12288
v_add_f32 v56, v56, v55
v_mfma_f32_16x16x32_bf16 v[156:159], v[40:43], a[216:219], v[156:159]
v_add_f32 v57, v57, v55
s_movk_i32 s60, 0xff
v_mfma_f32_16x16x32_bf16 v[160:163], v[40:43], a[220:223], v[160:163]
s_mov_b32 s61, 0
ds_read_b64_tr_b16 v[34:35], v13 offset:14336
s_mov_b32 s54, 0x40000
v_mfma_f32_16x16x32_bf16 v[160:163], v[36:39], a[204:207], v[160:163]
s_waitcnt lgkmcnt(4)
v_mfma_f32_16x16x32_bf16 v[160:163], v[44:47], a[236:239], v[160:163]
ds_read_b64_tr_b16 v[36:37], v18 offset:24576
v_mfma_f32_16x16x32_bf16 v[160:163], v[48:51], a[252:255], v[160:163]
v_mfma_f32_16x16x32_bf16 v[156:159], v[48:51], a[248:251], v[156:159]
ds_read_b64_tr_b16 v[38:39], v18 offset:26624
v_mfma_f32_16x16x32_bf16 v[156:159], v[44:47], a[232:235], v[156:159]
v_mfma_f32_16x16x32_bf16 v[152:155], v[44:47], a[228:231], v[152:155]
ds_read_b64_tr_b16 v[40:41], v18 offset:28672
v_mfma_f32_16x16x32_bf16 v[152:155], v[48:51], a[244:247], v[152:155]
v_mfma_f32_16x16x32_bf16 v[148:151], v[48:51], a[240:243], v[148:151]
ds_read_b64_tr_b16 v[42:43], v18 offset:30720
v_mfma_f32_16x16x32_bf16 v[148:151], v[44:47], a[224:227], v[148:151]
s_waitcnt lgkmcnt(4)
v_mfma_f32_16x16x32_bf16 v[148:151], v[28:31], v[212:215], v[148:151]
s_waitcnt vmcnt(4)
ds_read_b64_tr_b16 v[44:45], v18 offset:40960
v_mfma_f32_16x16x32_bf16 v[148:151], v[32:35], v[228:231], v[148:151]
buffer_store_dword v24, v25, s[28:31], s10 offen offset:0 sc1
v_mfma_f32_16x16x32_bf16 v[152:155], v[32:35], v[232:235], v[152:155]
ds_read_b64_tr_b16 v[46:47], v18 offset:43008
v_mfma_f32_16x16x32_bf16 v[152:155], v[28:31], v[216:219], v[152:155]
v_mfma_f32_16x16x32_bf16 v[156:159], v[28:31], v[220:223], v[156:159]
ds_read_b64_tr_b16 v[48:49], v18 offset:45056
v_mfma_f32_16x16x32_bf16 v[156:159], v[32:35], v[236:239], v[156:159]
v_mfma_f32_16x16x32_bf16 v[160:163], v[32:35], v[240:243], v[160:163]
ds_read_b64_tr_b16 v[50:51], v18 offset:47104
v_mfma_f32_16x16x32_bf16 v[160:163], v[28:31], v[224:227], v[160:163]
s_branch iskip12
.p2align 12
ipad12:
s_branch iret1
iskip12:
s_waitcnt lgkmcnt(4)
v_mfma_f32_16x16x32_bf16 v[176:179], v[36:39], a[172:175], v[176:179]
ds_read_b64_tr_b16 v[28:29], v18 offset:57344
v_cvt_pk_bf16_f32 v148, v148, v149
v_mfma_f32_16x16x32_bf16 v[176:179], v[40:43], a[188:191], v[176:179]
v_cvt_pk_bf16_f32 v149, v150, v151
v_cvt_pk_bf16_f32 v150, v152, v153
v_mfma_f32_16x16x32_bf16 v[172:175], v[40:43], a[184:187], v[172:175]
ds_read_b64_tr_b16 v[30:31], v18 offset:59392
v_cvt_pk_bf16_f32 v151, v154, v155
v_mfma_f32_16x16x32_bf16 v[172:175], v[36:39], a[168:171], v[172:175]
buffer_store_dwordx4 v[148:151], v1, s[28:31], s52 offen offset:0 sc1
v_cvt_pk_bf16_f32 v156, v156, v157
v_mfma_f32_16x16x32_bf16 v[168:171], v[36:39], a[164:167], v[168:171]
ds_read_b64_tr_b16 v[32:33], v18 offset:61440
v_cvt_pk_bf16_f32 v157, v158, v159
v_mfma_f32_16x16x32_bf16 v[168:171], v[40:43], a[180:183], v[168:171]
v_cvt_pk_bf16_f32 v158, v160, v161
v_cvt_pk_bf16_f32 v159, v162, v163
v_mfma_f32_16x16x32_bf16 v[164:167], v[40:43], a[176:179], v[164:167]
ds_read_b64_tr_b16 v[34:35], v18 offset:63488
v_mfma_f32_16x16x32_bf16 v[164:167], v[36:39], a[160:163], v[164:167]
s_waitcnt lgkmcnt(4)
buffer_store_dwordx4 v[156:159], v1, s[28:31], s53 offen offset:0 sc1
v_mfma_f32_16x16x32_bf16 v[164:167], v[44:47], a[192:195], v[164:167]
ds_read_b64_tr_b16 v[36:37], v14 offset:8192
v_mfma_f32_16x16x32_bf16 v[164:167], v[48:51], a[208:211], v[164:167]
v_mfma_f32_16x16x32_bf16 v[168:171], v[48:51], a[212:215], v[168:171]
ds_read_b64_tr_b16 v[38:39], v14 offset:10240
v_mfma_f32_16x16x32_bf16 v[168:171], v[44:47], a[196:199], v[168:171]
v_mfma_f32_16x16x32_bf16 v[172:175], v[44:47], a[200:203], v[172:175]
ds_read_b64_tr_b16 v[40:41], v14 offset:12288
v_mfma_f32_16x16x32_bf16 v[172:175], v[48:51], a[216:219], v[172:175]
v_mfma_f32_16x16x32_bf16 v[176:179], v[48:51], a[220:223], v[176:179]
ds_read_b64_tr_b16 v[42:43], v14 offset:14336
v_mfma_f32_16x16x32_bf16 v[176:179], v[44:47], a[204:207], v[176:179]
s_waitcnt lgkmcnt(4)
v_mfma_f32_16x16x32_bf16 v[176:179], v[28:31], a[236:239], v[176:179]
ds_read_b64_tr_b16 v[44:45], v15 offset:24576
v_mfma_f32_16x16x32_bf16 v[176:179], v[32:35], a[252:255], v[176:179]
v_mfma_f32_16x16x32_bf16 v[172:175], v[32:35], a[248:251], v[172:175]
ds_read_b64_tr_b16 v[46:47], v15 offset:26624
v_mfma_f32_16x16x32_bf16 v[172:175], v[28:31], a[232:235], v[172:175]
v_mfma_f32_16x16x32_bf16 v[168:171], v[28:31], a[228:231], v[168:171]
ds_read_b64_tr_b16 v[48:49], v15 offset:28672
v_mfma_f32_16x16x32_bf16 v[168:171], v[32:35], a[244:247], v[168:171]
v_mfma_f32_16x16x32_bf16 v[164:167], v[32:35], a[240:243], v[164:167]
ds_read_b64_tr_b16 v[50:51], v15 offset:30720
v_mfma_f32_16x16x32_bf16 v[164:167], v[28:31], a[224:227], v[164:167]
s_waitcnt lgkmcnt(4)
v_mfma_f32_16x16x32_bf16 v[164:167], v[36:39], v[212:215], v[164:167]
ds_read_b64_tr_b16 v[28:29], v15 offset:40960
v_mfma_f32_16x16x32_bf16 v[164:167], v[40:43], v[228:231], v[164:167]
v_mfma_f32_16x16x32_bf16 v[168:171], v[40:43], v[232:235], v[168:171]
ds_read_b64_tr_b16 v[30:31], v15 offset:43008
v_mfma_f32_16x16x32_bf16 v[168:171], v[36:39], v[216:219], v[168:171]
v_mfma_f32_16x16x32_bf16 v[172:175], v[36:39], v[220:223], v[172:175]
ds_read_b64_tr_b16 v[32:33], v15 offset:45056
v_mfma_f32_16x16x32_bf16 v[172:175], v[40:43], v[236:239], v[172:175]
v_mfma_f32_16x16x32_bf16 v[176:179], v[40:43], v[240:243], v[176:179]
ds_read_b64_tr_b16 v[34:35], v15 offset:47104
v_mfma_f32_16x16x32_bf16 v[176:179], v[36:39], v[224:227], v[176:179]
s_waitcnt lgkmcnt(4)
v_mfma_f32_16x16x32_bf16 v[184:187], v[44:47], a[36:39], v[184:187]
ds_read_b64_tr_b16 v[36:37], v15 offset:57344
v_cvt_pk_bf16_f32 v164, v164, v165
v_mfma_f32_16x16x32_bf16 v[184:187], v[48:51], a[52:55], v[184:187]
ds_read_b64_tr_b16 v[38:39], v15 offset:59392
v_cvt_pk_bf16_f32 v165, v166, v167
v_mfma_f32_16x16x32_bf16 v[180:183], v[48:51], a[48:51], v[180:183]
ds_read_b64_tr_b16 v[40:41], v15 offset:61440
v_cvt_pk_bf16_f32 v166, v168, v169
v_mfma_f32_16x16x32_bf16 v[180:183], v[44:47], a[32:35], v[180:183]
s_waitcnt lgkmcnt(3)
ds_read_b64_tr_b16 v[42:43], v15 offset:63488
v_cvt_pk_bf16_f32 v167, v170, v171
v_mfma_f32_16x16x32_bf16 v[180:183], v[28:31], a[64:67], v[180:183]
buffer_store_dwordx4 v[164:167], v1, s[28:31], s52 offen offset:1024 sc1
ds_read_b64_tr_b16 v[44:45], v19 offset:8192
v_mfma_f32_16x16x32_bf16 v[180:183], v[32:35], a[80:83], v[180:183]
ds_read_b64_tr_b16 v[46:47], v19 offset:10240
v_cvt_pk_bf16_f32 v172, v172, v173
v_mfma_f32_16x16x32_bf16 v[184:187], v[32:35], a[84:87], v[184:187]
ds_read_b64_tr_b16 v[48:49], v19 offset:12288
v_cvt_pk_bf16_f32 v173, v174, v175
v_mfma_f32_16x16x32_bf16 v[184:187], v[28:31], a[68:71], v[184:187]
s_waitcnt lgkmcnt(3)
ds_read_b64_tr_b16 v[50:51], v19 offset:14336
v_cvt_pk_bf16_f32 v174, v176, v177
v_mfma_f32_16x16x32_bf16 v[184:187], v[36:39], a[100:103], v[184:187]
ds_read_b64_tr_b16 v[28:29], v19 offset:24576
v_cvt_pk_bf16_f32 v175, v178, v179
v_mfma_f32_16x16x32_bf16 v[184:187], v[40:43], a[116:119], v[184:187]
buffer_store_dwordx4 v[172:175], v1, s[28:31], s53 offen offset:1024 sc1
ds_read_b64_tr_b16 v[30:31], v19 offset:26624
v_mfma_f32_16x16x32_bf16 v[180:183], v[40:43], a[112:115], v[180:183]
ds_read_b64_tr_b16 v[32:33], v19 offset:28672
v_mfma_f32_16x16x32_bf16 v[180:183], v[36:39], a[96:99], v[180:183]
s_waitcnt lgkmcnt(3)
ds_read_b64_tr_b16 v[34:35], v19 offset:30720
v_mfma_f32_16x16x32_bf16 v[180:183], v[44:47], a[128:131], v[180:183]
ds_read_b64_tr_b16 v[36:37], v19 offset:40960
v_mfma_f32_16x16x32_bf16 v[180:183], v[48:51], a[144:147], v[180:183]
ds_read_b64_tr_b16 v[38:39], v19 offset:43008
v_mfma_f32_16x16x32_bf16 v[184:187], v[48:51], a[148:151], v[184:187]
ds_read_b64_tr_b16 v[40:41], v19 offset:45056
v_mfma_f32_16x16x32_bf16 v[184:187], v[44:47], a[132:135], v[184:187]
s_waitcnt lgkmcnt(3)
ds_read_b64_tr_b16 v[42:43], v19 offset:47104
v_mfma_f32_16x16x32_bf16 v[184:187], v[28:31], a[164:167], v[184:187]
s_waitcnt vmcnt(5)
ds_read_b64_tr_b16 v[44:45], v19 offset:57344
v_mfma_f32_16x16x32_bf16 v[184:187], v[32:35], a[180:183], v[184:187]
buffer_store_dword v24, v25, s[28:31], s10 offen offset:128 sc1
ds_read_b64_tr_b16 v[46:47], v19 offset:59392
v_mfma_f32_16x16x32_bf16 v[180:183], v[32:35], a[176:179], v[180:183]
ds_read_b64_tr_b16 v[48:49], v19 offset:61440
v_mfma_f32_16x16x32_bf16 v[180:183], v[28:31], a[160:163], v[180:183]
s_waitcnt lgkmcnt(3)
ds_read_b64_tr_b16 v[50:51], v19 offset:63488
v_mfma_f32_16x16x32_bf16 v[180:183], v[36:39], a[192:195], v[180:183]
ds_read_b64_tr_b16 v[28:29], v15 offset:8192
v_and_b32 v111, 15, v245
v_mfma_f32_16x16x32_bf16 v[180:183], v[40:43], a[208:211], v[180:183]
ds_read_b64_tr_b16 v[30:31], v15 offset:10240
v_subrev_u32 v111, 6, v111
v_mfma_f32_16x16x32_bf16 v[184:187], v[40:43], a[212:215], v[184:187]
ds_read_b64_tr_b16 v[32:33], v15 offset:12288
v_and_b32 v111, 0x40000000, v111
v_mfma_f32_16x16x32_bf16 v[184:187], v[36:39], a[196:199], v[184:187]
s_waitcnt lgkmcnt(3)
ds_read_b64_tr_b16 v[34:35], v15 offset:14336
v_or_b32 v111, v111, v108
v_mfma_f32_16x16x32_bf16 v[184:187], v[44:47], a[228:231], v[184:187]
buffer_load_dword v23, v111, s[28:31], s9 offen sc1
ds_read_b64_tr_b16 v[36:37], v16 offset:24576
v_mfma_f32_16x16x32_bf16 v[184:187], v[48:51], a[244:247], v[184:187]
s_mov_b32 s4, 0x40000000
ds_read_b64_tr_b16 v[38:39], v16 offset:26624
v_mfma_f32_16x16x32_bf16 v[180:183], v[48:51], a[240:243], v[180:183]
ds_read_b64_tr_b16 v[40:41], v16 offset:28672
v_mfma_f32_16x16x32_bf16 v[180:183], v[44:47], a[224:227], v[180:183]
s_waitcnt lgkmcnt(3)
ds_read_b64_tr_b16 v[42:43], v16 offset:30720
v_mfma_f32_16x16x32_bf16 v[180:183], v[28:31], v[212:215], v[180:183]
ds_read_b64_tr_b16 v[44:45], v16 offset:40960
v_mfma_f32_16x16x32_bf16 v[180:183], v[32:35], v[228:231], v[180:183]
ds_read_b64_tr_b16 v[46:47], v16 offset:43008
v_mfma_f32_16x16x32_bf16 v[184:187], v[32:35], v[232:235], v[184:187]
ds_read_b64_tr_b16 v[48:49], v16 offset:45056
v_mfma_f32_16x16x32_bf16 v[184:187], v[28:31], v[216:219], v[184:187]
s_waitcnt lgkmcnt(3)
ds_read_b64_tr_b16 v[50:51], v16 offset:47104
v_mfma_f32_16x16x32_bf16 v[196:199], v[36:39], a[32:35], v[196:199]
ds_read_b64_tr_b16 v[28:29], v16 offset:57344
v_mfma_f32_16x16x32_bf16 v[196:199], v[40:43], a[48:51], v[196:199]
ds_read_b64_tr_b16 v[30:31], v16 offset:59392
v_mfma_f32_16x16x32_bf16 v[200:203], v[40:43], a[52:55], v[200:203]
ds_read_b64_tr_b16 v[32:33], v16 offset:61440
v_mfma_f32_16x16x32_bf16 v[200:203], v[36:39], a[36:39], v[200:203]
s_waitcnt lgkmcnt(3)
ds_read_b64_tr_b16 v[34:35], v16 offset:63488
v_mfma_f32_16x16x32_bf16 v[196:199], v[44:47], a[64:67], v[196:199]
ds_read_b64_tr_b16 v[36:37], v20 offset:8192
v_cvt_pk_bf16_f32 v180, v180, v181
v_mfma_f32_16x16x32_bf16 v[196:199], v[48:51], a[80:83], v[196:199]
ds_read_b64_tr_b16 v[38:39], v20 offset:10240
v_cvt_pk_bf16_f32 v181, v182, v183
v_mfma_f32_16x16x32_bf16 v[200:203], v[48:51], a[84:87], v[200:203]
ds_read_b64_tr_b16 v[40:41], v20 offset:12288
v_cvt_pk_bf16_f32 v182, v184, v185
v_mfma_f32_16x16x32_bf16 v[200:203], v[44:47], a[68:71], v[200:203]
s_waitcnt lgkmcnt(3)
ds_read_b64_tr_b16 v[42:43], v20 offset:14336
v_cvt_pk_bf16_f32 v183, v186, v187
v_mfma_f32_16x16x32_bf16 v[200:203], v[28:31], a[100:103], v[200:203]
buffer_store_dwordx4 v[180:183], v1, s[28:31], s52 offen offset:2048 sc1
ds_read_b64_tr_b16 v[44:45], v20 offset:24576
v_mfma_f32_16x16x32_bf16 v[200:203], v[32:35], a[116:119], v[200:203]
ds_read_b64_tr_b16 v[46:47], v20 offset:26624
v_mfma_f32_16x16x32_bf16 v[196:199], v[32:35], a[112:115], v[196:199]
ds_read_b64_tr_b16 v[48:49], v20 offset:28672
v_mfma_f32_16x16x32_bf16 v[196:199], v[28:31], a[96:99], v[196:199]
s_waitcnt lgkmcnt(3)
ds_read_b64_tr_b16 v[50:51], v20 offset:30720
v_mfma_f32_16x16x32_bf16 v[196:199], v[36:39], a[128:131], v[196:199]
ds_read_b64_tr_b16 v[28:29], v20 offset:40960
v_mfma_f32_16x16x32_bf16 v[196:199], v[40:43], a[144:147], v[196:199]
ds_read_b64_tr_b16 v[30:31], v20 offset:43008
v_mfma_f32_16x16x32_bf16 v[200:203], v[40:43], a[148:151], v[200:203]
ds_read_b64_tr_b16 v[32:33], v20 offset:45056
v_mfma_f32_16x16x32_bf16 v[200:203], v[36:39], a[132:135], v[200:203]
s_waitcnt lgkmcnt(3)
ds_read_b64_tr_b16 v[34:35], v20 offset:47104
v_mfma_f32_16x16x32_bf16 v[200:203], v[44:47], a[164:167], v[200:203]
ds_read_b64_tr_b16 v[36:37], v20 offset:57344
v_mfma_f32_16x16x32_bf16 v[200:203], v[48:51], a[180:183], v[200:203]
ds_read_b64_tr_b16 v[38:39], v20 offset:59392
v_mfma_f32_16x16x32_bf16 v[196:199], v[48:51], a[176:179], v[196:199]
ds_read_b64_tr_b16 v[40:41], v20 offset:61440
v_mfma_f32_16x16x32_bf16 v[196:199], v[44:47], a[160:163], v[196:199]
s_waitcnt lgkmcnt(3)
ds_read_b64_tr_b16 v[42:43], v20 offset:63488
v_mfma_f32_16x16x32_bf16 v[196:199], v[28:31], a[192:195], v[196:199]
ds_read_b64_tr_b16 v[44:45], v16 offset:8192
v_mfma_f32_16x16x32_bf16 v[196:199], v[32:35], a[208:211], v[196:199]
ds_read_b64_tr_b16 v[46:47], v16 offset:10240
v_mfma_f32_16x16x32_bf16 v[200:203], v[32:35], a[212:215], v[200:203]
ds_read_b64_tr_b16 v[48:49], v16 offset:12288
v_mfma_f32_16x16x32_bf16 v[200:203], v[28:31], a[196:199], v[200:203]
s_waitcnt lgkmcnt(3)
ds_read_b64_tr_b16 v[50:51], v16 offset:14336
v_mfma_f32_16x16x32_bf16 v[200:203], v[36:39], a[228:231], v[200:203]
ds_read_b64_tr_b16 v[28:29], v15 offset:24576
v_mfma_f32_16x16x32_bf16 v[200:203], v[40:43], a[244:247], v[200:203]
ds_read_b64_tr_b16 v[30:31], v15 offset:26624
v_mfma_f32_16x16x32_bf16 v[196:199], v[40:43], a[240:243], v[196:199]
ds_read_b64_tr_b16 v[32:33], v15 offset:28672
v_mfma_f32_16x16x32_bf16 v[196:199], v[36:39], a[224:227], v[196:199]
s_waitcnt lgkmcnt(3)
ds_read_b64_tr_b16 v[34:35], v15 offset:30720
v_mfma_f32_16x16x32_bf16 v[196:199], v[44:47], v[212:215], v[196:199]
ds_read_b64_tr_b16 v[36:37], v15 offset:40960
v_mfma_f32_16x16x32_bf16 v[196:199], v[48:51], v[228:231], v[196:199]
ds_read_b64_tr_b16 v[38:39], v15 offset:43008
v_mfma_f32_16x16x32_bf16 v[200:203], v[48:51], v[232:235], v[200:203]
ds_read_b64_tr_b16 v[40:41], v15 offset:45056
v_mfma_f32_16x16x32_bf16 v[200:203], v[44:47], v[216:219], v[200:203]
s_waitcnt lgkmcnt(3)
ds_read_b64_tr_b16 v[42:43], v15 offset:47104
v_mfma_f32_16x16x32_bf16 v[188:191], v[28:31], a[40:43], v[188:191]
ds_read_b64_tr_b16 v[44:45], v15 offset:57344
v_mfma_f32_16x16x32_bf16 v[188:191], v[32:35], a[56:59], v[188:191]
ds_read_b64_tr_b16 v[46:47], v15 offset:59392
v_mfma_f32_16x16x32_bf16 v[192:195], v[32:35], a[60:63], v[192:195]
ds_read_b64_tr_b16 v[48:49], v15 offset:61440
v_mfma_f32_16x16x32_bf16 v[192:195], v[28:31], a[44:47], v[192:195]
s_waitcnt lgkmcnt(3)
ds_read_b64_tr_b16 v[50:51], v15 offset:63488
v_mfma_f32_16x16x32_bf16 v[188:191], v[36:39], a[72:75], v[188:191]
ds_read_b64_tr_b16 v[28:29], v19 offset:8192
v_cvt_pk_bf16_f32 v196, v196, v197
v_mfma_f32_16x16x32_bf16 v[188:191], v[40:43], a[88:91], v[188:191]
ds_read_b64_tr_b16 v[30:31], v19 offset:10240
v_cvt_pk_bf16_f32 v197, v198, v199
v_mfma_f32_16x16x32_bf16 v[192:195], v[40:43], a[92:95], v[192:195]
ds_read_b64_tr_b16 v[32:33], v19 offset:12288
v_cvt_pk_bf16_f32 v198, v200, v201
v_mfma_f32_16x16x32_bf16 v[192:195], v[36:39], a[76:79], v[192:195]
s_waitcnt lgkmcnt(3)
ds_read_b64_tr_b16 v[34:35], v19 offset:14336
v_cvt_pk_bf16_f32 v199, v202, v203
v_mfma_f32_16x16x32_bf16 v[192:195], v[44:47], a[108:111], v[192:195]
buffer_store_dwordx4 v[196:199], v1, s[28:31], s52 offen offset:3072 sc1
ds_read_b64_tr_b16 v[36:37], v19 offset:24576
v_mfma_f32_16x16x32_bf16 v[192:195], v[48:51], a[124:127], v[192:195]
s_waitcnt vmcnt(4)
ds_read_b64_tr_b16 v[38:39], v19 offset:26624
v_mfma_f32_16x16x32_bf16 v[188:191], v[48:51], a[120:123], v[188:191]
ds_read_b64_tr_b16 v[40:41], v19 offset:28672
v_mfma_f32_16x16x32_bf16 v[188:191], v[44:47], a[104:107], v[188:191]
s_waitcnt lgkmcnt(3)
ds_read_b64_tr_b16 v[42:43], v19 offset:30720
v_mfma_f32_16x16x32_bf16 v[188:191], v[28:31], a[136:139], v[188:191]
buffer_store_dword v24, v25, s[28:31], s10 offen offset:256 sc1
ds_read_b64_tr_b16 v[44:45], v19 offset:40960
v_mfma_f32_16x16x32_bf16 v[188:191], v[32:35], a[152:155], v[188:191]
s_waitcnt vmcnt(3)
ds_read_b64_tr_b16 v[46:47], v19 offset:43008
v_cmp_eq_u32 vcc, 1, v23
v_mfma_f32_16x16x32_bf16 v[192:195], v[32:35], a[156:159], v[192:195]
ds_read_b64_tr_b16 v[48:49], v19 offset:45056
v_mfma_f32_16x16x32_bf16 v[192:195], v[28:31], a[140:143], v[192:195]
s_waitcnt lgkmcnt(3)
ds_read_b64_tr_b16 v[50:51], v19 offset:47104
v_mfma_f32_16x16x32_bf16 v[192:195], v[36:39], a[172:175], v[192:195]
buffer_load_dword v27, v108, s[28:31], s9 offen sc1
ds_read_b64_tr_b16 v[28:29], v19 offset:57344
v_mfma_f32_16x16x32_bf16 v[192:195], v[40:43], a[188:191], v[192:195]
s_and_b32 s63, vcc_lo, 192
ds_read_b64_tr_b16 v[30:31], v19 offset:59392
s_bfe_u32 s37, vcc_lo, 0x80008
v_mfma_f32_16x16x32_bf16 v[188:191], v[40:43], a[184:187], v[188:191]
s_add_u32 s37, s37, 1
ds_read_b64_tr_b16 v[32:33], v19 offset:61440
s_lshr_b32 s37, s37, 8
v_mfma_f32_16x16x32_bf16 v[188:191], v[36:39], a[168:171], v[188:191]
s_waitcnt lgkmcnt(3)
ds_read_b64_tr_b16 v[34:35], v19 offset:63488
s_or_b32 s63, s63, s37
v_mfma_f32_16x16x32_bf16 v[188:191], v[44:47], a[200:203], v[188:191]
s_andn2_b32 s60, s60, s63
ds_read_b64_tr_b16 v[36:37], v15 offset:8192
v_mfma_f32_16x16x32_bf16 v[188:191], v[48:51], a[216:219], v[188:191]
s_bitcmp1_b32 s63, 7
s_cselect_b32 s62, s45, s4
ds_read_b64_tr_b16 v[38:39], v15 offset:10240
v_mfma_f32_16x16x32_bf16 v[192:195], v[48:51], a[220:223], v[192:195]
buffer_load_dwordx4 v[172:175], v1, s[28:31], s62 offen offset:0 sc1
ds_read_b64_tr_b16 v[40:41], v15 offset:12288
v_mfma_f32_16x16x32_bf16 v[192:195], v[44:47], a[204:207], v[192:195]
s_waitcnt lgkmcnt(3)
ds_read_b64_tr_b16 v[42:43], v15 offset:14336
v_mfma_f32_16x16x32_bf16 v[192:195], v[28:31], a[236:239], v[192:195]
ds_read_b64_tr_b16 v[44:45], v16 offset:24576
v_mfma_f32_16x16x32_bf16 v[192:195], v[32:35], a[252:255], v[192:195]
ds_read_b64_tr_b16 v[46:47], v16 offset:26624
v_mfma_f32_16x16x32_bf16 v[188:191], v[32:35], a[248:251], v[188:191]
buffer_load_dwordx4 v[176:179], v1, s[28:31], s62 offen offset:1024 sc1
ds_read_b64_tr_b16 v[48:49], v16 offset:28672
v_mfma_f32_16x16x32_bf16 v[188:191], v[28:31], a[232:235], v[188:191]
s_waitcnt lgkmcnt(3)
ds_read_b64_tr_b16 v[50:51], v16 offset:30720
v_mfma_f32_16x16x32_bf16 v[188:191], v[36:39], v[220:223], v[188:191]
s_bitcmp1_b32 s63, 6
s_cselect_b32 s62, s44, s4
ds_read_b64_tr_b16 v[28:29], v16 offset:40960
v_mfma_f32_16x16x32_bf16 v[188:191], v[40:43], v[236:239], v[188:191]
ds_read_b64_tr_b16 v[30:31], v16 offset:43008
v_mfma_f32_16x16x32_bf16 v[192:195], v[40:43], v[240:243], v[192:195]
buffer_load_dwordx4 v[164:167], v1, s[28:31], s62 offen offset:0 sc1
ds_read_b64_tr_b16 v[32:33], v16 offset:45056
v_mfma_f32_16x16x32_bf16 v[192:195], v[36:39], v[224:227], v[192:195]
s_waitcnt lgkmcnt(3)
ds_read_b64_tr_b16 v[34:35], v16 offset:47104
v_mfma_f32_16x16x32_bf16 v[208:211], v[44:47], a[44:47], v[208:211]
ds_read_b64_tr_b16 v[36:37], v16 offset:57344
v_mfma_f32_16x16x32_bf16 v[208:211], v[48:51], a[60:63], v[208:211]
ds_read_b64_tr_b16 v[38:39], v16 offset:59392
v_mfma_f32_16x16x32_bf16 v[204:207], v[48:51], a[56:59], v[204:207]
buffer_load_dwordx4 v[168:171], v1, s[28:31], s62 offen offset:1024 sc1
ds_read_b64_tr_b16 v[40:41], v16 offset:61440
v_mfma_f32_16x16x32_bf16 v[204:207], v[44:47], a[40:43], v[204:207]
s_waitcnt lgkmcnt(3)
ds_read_b64_tr_b16 v[42:43], v16 offset:63488
v_mfma_f32_16x16x32_bf16 v[204:207], v[28:31], a[72:75], v[204:207]
s_bitcmp1_b32 s63, 0
s_cselect_b32 s62, s94, s4
ds_read_b64_tr_b16 v[44:45], v20 offset:8192
v_mfma_f32_16x16x32_bf16 v[204:207], v[32:35], a[88:91], v[204:207]
ds_read_b64_tr_b16 v[46:47], v20 offset:10240
v_mfma_f32_16x16x32_bf16 v[208:211], v[32:35], a[92:95], v[208:211]
buffer_load_dwordx4 v[116:119], v105, s[28:31], s62 offen offset:0 sc1
ds_read_b64_tr_b16 v[48:49], v20 offset:12288
v_mfma_f32_16x16x32_bf16 v[208:211], v[28:31], a[76:79], v[208:211]
s_waitcnt lgkmcnt(3)
ds_read_b64_tr_b16 v[50:51], v20 offset:14336
v_mfma_f32_16x16x32_bf16 v[208:211], v[36:39], a[108:111], v[208:211]
ds_read_b64_tr_b16 v[28:29], v20 offset:24576
v_mfma_f32_16x16x32_bf16 v[208:211], v[40:43], a[124:127], v[208:211]
ds_read_b64_tr_b16 v[30:31], v20 offset:26624
v_mfma_f32_16x16x32_bf16 v[204:207], v[40:43], a[120:123], v[204:207]
buffer_load_dwordx4 v[120:123], v106, s[28:31], s62 offen offset:0 sc1
ds_read_b64_tr_b16 v[32:33], v20 offset:28672
v_mfma_f32_16x16x32_bf16 v[204:207], v[36:39], a[104:107], v[204:207]
s_waitcnt lgkmcnt(3)
ds_read_b64_tr_b16 v[34:35], v20 offset:30720
v_mfma_f32_16x16x32_bf16 v[204:207], v[44:47], a[136:139], v[204:207]
ds_read_b64_tr_b16 v[36:37], v20 offset:40960
v_mfma_f32_16x16x32_bf16 v[204:207], v[48:51], a[152:155], v[204:207]
ds_read_b64_tr_b16 v[38:39], v20 offset:43008
v_mfma_f32_16x16x32_bf16 v[208:211], v[48:51], a[156:159], v[208:211]
ds_read_b64_tr_b16 v[40:41], v20 offset:45056
v_mfma_f32_16x16x32_bf16 v[208:211], v[44:47], a[140:143], v[208:211]
s_waitcnt lgkmcnt(3)
ds_read_b64_tr_b16 v[42:43], v20 offset:47104
v_mfma_f32_16x16x32_bf16 v[208:211], v[28:31], a[172:175], v[208:211]
ds_read_b64_tr_b16 v[44:45], v20 offset:57344
v_mfma_f32_16x16x32_bf16 v[208:211], v[32:35], a[188:191], v[208:211]
ds_read_b64_tr_b16 v[46:47], v20 offset:59392
v_mfma_f32_16x16x32_bf16 v[204:207], v[32:35], a[184:187], v[204:207]
ds_read_b64_tr_b16 v[48:49], v20 offset:61440
v_mfma_f32_16x16x32_bf16 v[204:207], v[28:31], a[168:171], v[204:207]
s_waitcnt lgkmcnt(3)
ds_read_b64_tr_b16 v[50:51], v20 offset:63488
v_mfma_f32_16x16x32_bf16 v[204:207], v[36:39], a[200:203], v[204:207]
ds_read_b64_tr_b16 v[28:29], v16 offset:8192
v_mfma_f32_16x16x32_bf16 v[204:207], v[40:43], a[216:219], v[204:207]
ds_read_b64_tr_b16 v[30:31], v16 offset:10240
v_mfma_f32_16x16x32_bf16 v[208:211], v[40:43], a[220:223], v[208:211]
ds_read_b64_tr_b16 v[32:33], v16 offset:12288
v_mfma_f32_16x16x32_bf16 v[208:211], v[36:39], a[204:207], v[208:211]
s_waitcnt lgkmcnt(3)
ds_read_b64_tr_b16 v[34:35], v16 offset:14336
v_mfma_f32_16x16x32_bf16 v[208:211], v[44:47], a[236:239], v[208:211]
v_mfma_f32_16x16x32_bf16 v[208:211], v[48:51], a[252:255], v[208:211]
v_mfma_f32_16x16x32_bf16 v[204:207], v[48:51], a[248:251], v[204:207]
v_mfma_f32_16x16x32_bf16 v[204:207], v[44:47], a[232:235], v[204:207]
s_waitcnt lgkmcnt(0)
v_mfma_f32_16x16x32_bf16 v[204:207], v[28:31], v[220:223], v[204:207]
v_mfma_f32_16x16x32_bf16 v[204:207], v[32:35], v[236:239], v[204:207]
v_mfma_f32_16x16x32_bf16 v[208:211], v[32:35], v[240:243], v[208:211]
v_mfma_f32_16x16x32_bf16 v[208:211], v[28:31], v[224:227], v[208:211]
s_waitcnt vmcnt(8)
buffer_store_dword v24, v25, s[28:31], s10 offen offset:384 sc1
s_waitcnt vmcnt(7)
v_cmp_eq_u32 vcc, 1, v27
s_nop 0
s_and_b32 s63, vcc_lo, 62
s_andn2_b32 s60, s60, s63
s_bitcmp1_b32 s63, 5
s_cselect_b32 s62, s43, s4
buffer_load_dwordx4 v[156:159], v1, s[28:31], s62 offen offset:0 sc1
buffer_load_dwordx4 v[160:163], v1, s[28:31], s62 offen offset:1024 sc1
s_bitcmp1_b32 s63, 4
s_cselect_b32 s62, s42, s4
buffer_load_dwordx4 v[148:151], v1, s[28:31], s62 offen offset:0 sc1
buffer_load_dwordx4 v[152:155], v1, s[28:31], s62 offen offset:1024 sc1
s_bitcmp1_b32 s63, 3
s_cselect_b32 s62, s41, s4
buffer_load_dwordx4 v[140:143], v1, s[28:31], s62 offen offset:0 sc1
buffer_load_dwordx4 v[144:147], v1, s[28:31], s62 offen offset:1024 sc1
s_bitcmp1_b32 s63, 2
s_cselect_b32 s62, s40, s4
buffer_load_dwordx4 v[132:135], v1, s[28:31], s62 offen offset:0 sc1
buffer_load_dwordx4 v[136:139], v1, s[28:31], s62 offen offset:1024 sc1
s_bitcmp1_b32 s63, 1
s_cselect_b32 s62, s39, s4
buffer_load_dwordx4 v[124:127], v1, s[28:31], s62 offen offset:0 sc1
buffer_load_dwordx4 v[128:131], v1, s[28:31], s62 offen offset:1024 sc1
buffer_load_dword v23, v108, s[28:31], s9 offen sc1
s_waitcnt vmcnt(16)
v_dot2c_f32_bf16 v188, s90, v172
v_dot2c_f32_bf16 v189, s91, v172
v_dot2c_f32_bf16 v190, s90, v173
v_dot2c_f32_bf16 v191, s91, v173
v_dot2c_f32_bf16 v192, s90, v174
v_dot2c_f32_bf16 v193, s91, v174
v_dot2c_f32_bf16 v194, s90, v175
v_dot2c_f32_bf16 v195, s91, v175
v_dot2c_f32_bf16 v204, s90, v176
v_dot2c_f32_bf16 v205, s91, v176
v_dot2c_f32_bf16 v206, s90, v177
v_dot2c_f32_bf16 v207, s91, v177
v_dot2c_f32_bf16 v208, s90, v178
v_dot2c_f32_bf16 v209, s91, v178
v_dot2c_f32_bf16 v210, s90, v179
v_dot2c_f32_bf16 v211, s91, v179
s_waitcnt vmcnt(14)
v_dot2c_f32_bf16 v188, s90, v164
v_dot2c_f32_bf16 v189, s91, v164
v_dot2c_f32_bf16 v190, s90, v165
v_dot2c_f32_bf16 v191, s91, v165
v_dot2c_f32_bf16 v192, s90, v166
v_dot2c_f32_bf16 v193, s91, v166
v_dot2c_f32_bf16 v194, s90, v167
v_dot2c_f32_bf16 v195, s91, v167
v_dot2c_f32_bf16 v204, s90, v168
v_dot2c_f32_bf16 v205, s91, v168
v_dot2c_f32_bf16 v206, s90, v169
v_dot2c_f32_bf16 v207, s91, v169
v_dot2c_f32_bf16 v208, s90, v170
v_dot2c_f32_bf16 v209, s91, v170
v_dot2c_f32_bf16 v210, s90, v171
v_dot2c_f32_bf16 v211, s91, v171
s_waitcnt vmcnt(9)
v_dot2c_f32_bf16 v188, s90, v156
v_dot2c_f32_bf16 v189, s91, v156
v_dot2c_f32_bf16 v190, s90, v157
v_dot2c_f32_bf16 v191, s91, v157
v_dot2c_f32_bf16 v192, s90, v158
v_dot2c_f32_bf16 v193, s91, v158
v_dot2c_f32_bf16 v194, s90, v159
v_dot2c_f32_bf16 v195, s91, v159
v_dot2c_f32_bf16 v204, s90, v160
v_dot2c_f32_bf16 v205, s91, v160
v_dot2c_f32_bf16 v206, s90, v161
v_dot2c_f32_bf16 v207, s91, v161
v_dot2c_f32_bf16 v208, s90, v162
v_dot2c_f32_bf16 v209, s91, v162
v_dot2c_f32_bf16 v210, s90, v163
v_dot2c_f32_bf16 v211, s91, v163
s_waitcnt vmcnt(7)
v_dot2c_f32_bf16 v188, s90, v148
v_dot2c_f32_bf16 v189, s91, v148
v_dot2c_f32_bf16 v190, s90, v149
v_dot2c_f32_bf16 v191, s91, v149
v_dot2c_f32_bf16 v192, s90, v150
v_dot2c_f32_bf16 v193, s91, v150
v_dot2c_f32_bf16 v194, s90, v151
v_dot2c_f32_bf16 v195, s91, v151
v_dot2c_f32_bf16 v204, s90, v152
v_dot2c_f32_bf16 v205, s91, v152
v_dot2c_f32_bf16 v206, s90, v153
v_dot2c_f32_bf16 v207, s91, v153
v_dot2c_f32_bf16 v208, s90, v154
v_dot2c_f32_bf16 v209, s91, v154
v_dot2c_f32_bf16 v210, s90, v155
v_dot2c_f32_bf16 v211, s91, v155
s_waitcnt vmcnt(5)
v_dot2c_f32_bf16 v188, s90, v140
v_dot2c_f32_bf16 v189, s91, v140
v_dot2c_f32_bf16 v190, s90, v141
v_dot2c_f32_bf16 v191, s91, v141
v_dot2c_f32_bf16 v192, s90, v142
v_dot2c_f32_bf16 v193, s91, v142
v_dot2c_f32_bf16 v194, s90, v143
v_dot2c_f32_bf16 v195, s91, v143
v_dot2c_f32_bf16 v204, s90, v144
v_dot2c_f32_bf16 v205, s91, v144
v_dot2c_f32_bf16 v206, s90, v145
v_dot2c_f32_bf16 v207, s91, v145
v_dot2c_f32_bf16 v208, s90, v146
v_dot2c_f32_bf16 v209, s91, v146
v_dot2c_f32_bf16 v210, s90, v147
v_dot2c_f32_bf16 v211, s91, v147
s_waitcnt vmcnt(3)
v_dot2c_f32_bf16 v188, s90, v132
v_dot2c_f32_bf16 v189, s91, v132
v_dot2c_f32_bf16 v190, s90, v133
v_dot2c_f32_bf16 v191, s91, v133
v_dot2c_f32_bf16 v192, s90, v134
v_dot2c_f32_bf16 v193, s91, v134
v_dot2c_f32_bf16 v194, s90, v135
v_dot2c_f32_bf16 v195, s91, v135
v_dot2c_f32_bf16 v204, s90, v136
v_dot2c_f32_bf16 v205, s91, v136
v_dot2c_f32_bf16 v206, s90, v137
v_dot2c_f32_bf16 v207, s91, v137
v_dot2c_f32_bf16 v208, s90, v138
v_dot2c_f32_bf16 v209, s91, v138
v_dot2c_f32_bf16 v210, s90, v139
v_dot2c_f32_bf16 v211, s91, v139
s_waitcnt vmcnt(1)
v_dot2c_f32_bf16 v188, s90, v124
v_dot2c_f32_bf16 v189, s91, v124
v_dot2c_f32_bf16 v190, s90, v125
v_dot2c_f32_bf16 v191, s91, v125
v_dot2c_f32_bf16 v192, s90, v126
v_dot2c_f32_bf16 v193, s91, v126
v_dot2c_f32_bf16 v194, s90, v127
v_dot2c_f32_bf16 v195, s91, v127
v_dot2c_f32_bf16 v204, s90, v128
v_dot2c_f32_bf16 v205, s91, v128
v_dot2c_f32_bf16 v206, s90, v129
v_dot2c_f32_bf16 v207, s91, v129
v_dot2c_f32_bf16 v208, s90, v130
v_dot2c_f32_bf16 v209, s91, v130
v_dot2c_f32_bf16 v210, s90, v131
v_dot2c_f32_bf16 v211, s91, v131
s_andn2_b32 s61, 1, s60
s_mov_b32 s62, 0
s_cmp_eq_u32 s60, 0
s_cbranch_scc1 sequential_preLN__linear_kernel_hedgehog__glu_gated_bilinear__prompt_kernel_f_ra
s_waitcnt vmcnt(0)
sequential_preLN__linear_kernel_hedgehog__glu_gated_bilinear__prompt_kernel_f_rl:
v_cmp_eq_u32 vcc, 1, v23
s_sub_u32 s54, s54, 1
s_cselect_b32 s63, -1, vcc_lo
s_bfe_u32 s37, s63, 0x80008
s_add_u32 s37, s37, 1
s_lshr_b32 s37, s37, 8
s_and_b32 s63, s63, 0xfe
s_or_b32 s63, s63, s37
s_and_b32 s62, s63, s60
s_cbranch_scc0 sequential_preLN__linear_kernel_hedgehog__glu_gated_bilinear__prompt_kernel_f_rn
s_bitcmp1_b32 s62, 0
s_cbranch_scc0 sequential_preLN__linear_kernel_hedgehog__glu_gated_bilinear__prompt_kernel_f_rl0
buffer_load_dwordx4 v[116:119], v105, s[28:31], s94 offen sc1
buffer_load_dwordx4 v[120:123], v106, s[28:31], s94 offen sc1
sequential_preLN__linear_kernel_hedgehog__glu_gated_bilinear__prompt_kernel_f_rl0:
s_bitcmp1_b32 s62, 7
s_cbranch_scc0 sequential_preLN__linear_kernel_hedgehog__glu_gated_bilinear__prompt_kernel_f_rl7
buffer_load_dwordx4 v[172:175], v1, s[28:31], s45 offen offset:0 sc1
buffer_load_dwordx4 v[176:179], v1, s[28:31], s45 offen offset:1024 sc1
sequential_preLN__linear_kernel_hedgehog__glu_gated_bilinear__prompt_kernel_f_rl7:
s_bitcmp1_b32 s62, 6
s_cbranch_scc0 sequential_preLN__linear_kernel_hedgehog__glu_gated_bilinear__prompt_kernel_f_rl6
buffer_load_dwordx4 v[164:167], v1, s[28:31], s44 offen offset:0 sc1
buffer_load_dwordx4 v[168:171], v1, s[28:31], s44 offen offset:1024 sc1
sequential_preLN__linear_kernel_hedgehog__glu_gated_bilinear__prompt_kernel_f_rl6:
s_bitcmp1_b32 s62, 5
s_cbranch_scc0 sequential_preLN__linear_kernel_hedgehog__glu_gated_bilinear__prompt_kernel_f_rl5
buffer_load_dwordx4 v[156:159], v1, s[28:31], s43 offen offset:0 sc1
buffer_load_dwordx4 v[160:163], v1, s[28:31], s43 offen offset:1024 sc1
sequential_preLN__linear_kernel_hedgehog__glu_gated_bilinear__prompt_kernel_f_rl5:
s_bitcmp1_b32 s62, 4
s_cbranch_scc0 sequential_preLN__linear_kernel_hedgehog__glu_gated_bilinear__prompt_kernel_f_rl4
buffer_load_dwordx4 v[148:151], v1, s[28:31], s42 offen offset:0 sc1
buffer_load_dwordx4 v[152:155], v1, s[28:31], s42 offen offset:1024 sc1
sequential_preLN__linear_kernel_hedgehog__glu_gated_bilinear__prompt_kernel_f_rl4:
s_bitcmp1_b32 s62, 3
s_cbranch_scc0 sequential_preLN__linear_kernel_hedgehog__glu_gated_bilinear__prompt_kernel_f_rl3
buffer_load_dwordx4 v[140:143], v1, s[28:31], s41 offen offset:0 sc1
buffer_load_dwordx4 v[144:147], v1, s[28:31], s41 offen offset:1024 sc1
sequential_preLN__linear_kernel_hedgehog__glu_gated_bilinear__prompt_kernel_f_rl3:
s_bitcmp1_b32 s62, 2
s_cbranch_scc0 sequential_preLN__linear_kernel_hedgehog__glu_gated_bilinear__prompt_kernel_f_rl2
buffer_load_dwordx4 v[132:135], v1, s[28:31], s40 offen offset:0 sc1
buffer_load_dwordx4 v[136:139], v1, s[28:31], s40 offen offset:1024 sc1
sequential_preLN__linear_kernel_hedgehog__glu_gated_bilinear__prompt_kernel_f_rl2:
s_bitcmp1_b32 s62, 1
s_cbranch_scc0 sequential_preLN__linear_kernel_hedgehog__glu_gated_bilinear__prompt_kernel_f_rl1
buffer_load_dwordx4 v[124:127], v1, s[28:31], s39 offen offset:0 sc1
buffer_load_dwordx4 v[128:131], v1, s[28:31], s39 offen offset:1024 sc1
sequential_preLN__linear_kernel_hedgehog__glu_gated_bilinear__prompt_kernel_f_rl1:
sequential_preLN__linear_kernel_hedgehog__glu_gated_bilinear__prompt_kernel_f_rn:
s_andn2_b32 s60, s60, s62
s_cbranch_scc0 sequential_preLN__linear_kernel_hedgehog__glu_gated_bilinear__prompt_kernel_f_ra
buffer_load_dword v23, v108, s[28:31], s9 offen sc1
sequential_preLN__linear_kernel_hedgehog__glu_gated_bilinear__prompt_kernel_f_ra:
s_cmp_eq_u32 s61, 0
s_cbranch_scc1 sequential_preLN__linear_kernel_hedgehog__glu_gated_bilinear__prompt_kernel_f_rb
s_bitcmp1_b32 s61, 0
s_cbranch_scc0 sequential_preLN__linear_kernel_hedgehog__glu_gated_bilinear__prompt_kernel_f_ra0
v_dot2c_f32_bf16 v60, s90, v116
v_dot2c_f32_bf16 v61, s91, v116
v_dot2c_f32_bf16 v62, s90, v117
v_dot2c_f32_bf16 v63, s91, v117
v_dot2c_f32_bf16 v64, s90, v118
v_dot2c_f32_bf16 v65, s91, v118
v_dot2c_f32_bf16 v66, s90, v119
v_dot2c_f32_bf16 v67, s91, v119
v_dot2c_f32_bf16 v60, s90, v120
v_dot2c_f32_bf16 v61, s91, v120
v_dot2c_f32_bf16 v62, s90, v121
v_dot2c_f32_bf16 v63, s91, v121
v_dot2c_f32_bf16 v64, s90, v122
v_dot2c_f32_bf16 v65, s91, v122
v_dot2c_f32_bf16 v66, s90, v123
v_dot2c_f32_bf16 v67, s91, v123
v_permlane32_swap_b32 v60, v64
v_permlane32_swap_b32 v61, v65
v_permlane32_swap_b32 v62, v66
v_permlane32_swap_b32 v63, v67
v_pk_add_f32 v[60:61], v[60:61], v[64:65]
v_pk_add_f32 v[62:63], v[62:63], v[66:67]
s_nop 1
v_permlane16_swap_b32 v60, v62
v_permlane16_swap_b32 v61, v63
v_pk_add_f32 v[60:61], v[60:61], v[62:63]
v_fma_f32 v60, v60, v54, v56
v_fma_f32 v61, v61, v54, v57
v_cvt_pk_bf16_f32 v60, v60, v61
buffer_store_dword v60, v104, s[24:27], s8 offen sc1
sequential_preLN__linear_kernel_hedgehog__glu_gated_bilinear__prompt_kernel_f_ra0:
s_bitcmp1_b32 s61, 7
s_cbranch_scc0 sequential_preLN__linear_kernel_hedgehog__glu_gated_bilinear__prompt_kernel_f_ra7
v_dot2c_f32_bf16 v188, s90, v172
v_dot2c_f32_bf16 v189, s91, v172
v_dot2c_f32_bf16 v190, s90, v173
v_dot2c_f32_bf16 v191, s91, v173
v_dot2c_f32_bf16 v192, s90, v174
v_dot2c_f32_bf16 v193, s91, v174
v_dot2c_f32_bf16 v194, s90, v175
v_dot2c_f32_bf16 v195, s91, v175
v_dot2c_f32_bf16 v204, s90, v176
v_dot2c_f32_bf16 v205, s91, v176
v_dot2c_f32_bf16 v206, s90, v177
v_dot2c_f32_bf16 v207, s91, v177
v_dot2c_f32_bf16 v208, s90, v178
v_dot2c_f32_bf16 v209, s91, v178
v_dot2c_f32_bf16 v210, s90, v179
v_dot2c_f32_bf16 v211, s91, v179
sequential_preLN__linear_kernel_hedgehog__glu_gated_bilinear__prompt_kernel_f_ra7:
s_bitcmp1_b32 s61, 6
s_cbranch_scc0 sequential_preLN__linear_kernel_hedgehog__glu_gated_bilinear__prompt_kernel_f_ra6
v_dot2c_f32_bf16 v188, s90, v164
v_dot2c_f32_bf16 v189, s91, v164
s_branch iskip13
.p2align 12
ipad13:
s_branch iret1
iskip13:
v_dot2c_f32_bf16 v190, s90, v165
v_dot2c_f32_bf16 v191, s91, v165
v_dot2c_f32_bf16 v192, s90, v166
v_dot2c_f32_bf16 v193, s91, v166
v_dot2c_f32_bf16 v194, s90, v167
v_dot2c_f32_bf16 v195, s91, v167
v_dot2c_f32_bf16 v204, s90, v168
v_dot2c_f32_bf16 v205, s91, v168
v_dot2c_f32_bf16 v206, s90, v169
v_dot2c_f32_bf16 v207, s91, v169
v_dot2c_f32_bf16 v208, s90, v170
v_dot2c_f32_bf16 v209, s91, v170
v_dot2c_f32_bf16 v210, s90, v171
v_dot2c_f32_bf16 v211, s91, v171
sequential_preLN__linear_kernel_hedgehog__glu_gated_bilinear__prompt_kernel_f_ra6:
s_bitcmp1_b32 s61, 5
s_cbranch_scc0 sequential_preLN__linear_kernel_hedgehog__glu_gated_bilinear__prompt_kernel_f_ra5
v_dot2c_f32_bf16 v188, s90, v156
v_dot2c_f32_bf16 v189, s91, v156
v_dot2c_f32_bf16 v190, s90, v157
v_dot2c_f32_bf16 v191, s91, v157
v_dot2c_f32_bf16 v192, s90, v158
v_dot2c_f32_bf16 v193, s91, v158
v_dot2c_f32_bf16 v194, s90, v159
v_dot2c_f32_bf16 v195, s91, v159
v_dot2c_f32_bf16 v204, s90, v160
v_dot2c_f32_bf16 v205, s91, v160
v_dot2c_f32_bf16 v206, s90, v161
v_dot2c_f32_bf16 v207, s91, v161
v_dot2c_f32_bf16 v208, s90, v162
v_dot2c_f32_bf16 v209, s91, v162
v_dot2c_f32_bf16 v210, s90, v163
v_dot2c_f32_bf16 v211, s91, v163
sequential_preLN__linear_kernel_hedgehog__glu_gated_bilinear__prompt_kernel_f_ra5:
s_bitcmp1_b32 s61, 4
s_cbranch_scc0 sequential_preLN__linear_kernel_hedgehog__glu_gated_bilinear__prompt_kernel_f_ra4
v_dot2c_f32_bf16 v188, s90, v148
v_dot2c_f32_bf16 v189, s91, v148
v_dot2c_f32_bf16 v190, s90, v149
v_dot2c_f32_bf16 v191, s91, v149
v_dot2c_f32_bf16 v192, s90, v150
v_dot2c_f32_bf16 v193, s91, v150
v_dot2c_f32_bf16 v194, s90, v151
v_dot2c_f32_bf16 v195, s91, v151
v_dot2c_f32_bf16 v204, s90, v152
v_dot2c_f32_bf16 v205, s91, v152
v_dot2c_f32_bf16 v206, s90, v153
v_dot2c_f32_bf16 v207, s91, v153
v_dot2c_f32_bf16 v208, s90, v154
v_dot2c_f32_bf16 v209, s91, v154
v_dot2c_f32_bf16 v210, s90, v155
v_dot2c_f32_bf16 v211, s91, v155
sequential_preLN__linear_kernel_hedgehog__glu_gated_bilinear__prompt_kernel_f_ra4:
s_bitcmp1_b32 s61, 3
s_cbranch_scc0 sequential_preLN__linear_kernel_hedgehog__glu_gated_bilinear__prompt_kernel_f_ra3
v_dot2c_f32_bf16 v188, s90, v140
v_dot2c_f32_bf16 v189, s91, v140
v_dot2c_f32_bf16 v190, s90, v141
v_dot2c_f32_bf16 v191, s91, v141
v_dot2c_f32_bf16 v192, s90, v142
v_dot2c_f32_bf16 v193, s91, v142
v_dot2c_f32_bf16 v194, s90, v143
v_dot2c_f32_bf16 v195, s91, v143
v_dot2c_f32_bf16 v204, s90, v144
v_dot2c_f32_bf16 v205, s91, v144
v_dot2c_f32_bf16 v206, s90, v145
v_dot2c_f32_bf16 v207, s91, v145
v_dot2c_f32_bf16 v208, s90, v146
v_dot2c_f32_bf16 v209, s91, v146
v_dot2c_f32_bf16 v210, s90, v147
v_dot2c_f32_bf16 v211, s91, v147
sequential_preLN__linear_kernel_hedgehog__glu_gated_bilinear__prompt_kernel_f_ra3:
s_bitcmp1_b32 s61, 2
s_cbranch_scc0 sequential_preLN__linear_kernel_hedgehog__glu_gated_bilinear__prompt_kernel_f_ra2
v_dot2c_f32_bf16 v188, s90, v132
v_dot2c_f32_bf16 v189, s91, v132
v_dot2c_f32_bf16 v190, s90, v133
v_dot2c_f32_bf16 v191, s91, v133
v_dot2c_f32_bf16 v192, s90, v134
v_dot2c_f32_bf16 v193, s91, v134
v_dot2c_f32_bf16 v194, s90, v135
v_dot2c_f32_bf16 v195, s91, v135
v_dot2c_f32_bf16 v204, s90, v136
v_dot2c_f32_bf16 v205, s91, v136
v_dot2c_f32_bf16 v206, s90, v137
v_dot2c_f32_bf16 v207, s91, v137
v_dot2c_f32_bf16 v208, s90, v138
v_dot2c_f32_bf16 v209, s91, v138
v_dot2c_f32_bf16 v210, s90, v139
v_dot2c_f32_bf16 v211, s91, v139
sequential_preLN__linear_kernel_hedgehog__glu_gated_bilinear__prompt_kernel_f_ra2:
s_bitcmp1_b32 s61, 1
s_cbranch_scc0 sequential_preLN__linear_kernel_hedgehog__glu_gated_bilinear__prompt_kernel_f_ra1
v_dot2c_f32_bf16 v188, s90, v124
v_dot2c_f32_bf16 v189, s91, v124
v_dot2c_f32_bf16 v190, s90, v125
v_dot2c_f32_bf16 v191, s91, v125
v_dot2c_f32_bf16 v192, s90, v126
v_dot2c_f32_bf16 v193, s91, v126
v_dot2c_f32_bf16 v194, s90, v127
v_dot2c_f32_bf16 v195, s91, v127
v_dot2c_f32_bf16 v204, s90, v128
v_dot2c_f32_bf16 v205, s91, v128
v_dot2c_f32_bf16 v206, s90, v129
v_dot2c_f32_bf16 v207, s91, v129
v_dot2c_f32_bf16 v208, s90, v130
v_dot2c_f32_bf16 v209, s91, v130
v_dot2c_f32_bf16 v210, s90, v131
v_dot2c_f32_bf16 v211, s91, v131
sequential_preLN__linear_kernel_hedgehog__glu_gated_bilinear__prompt_kernel_f_ra1:
sequential_preLN__linear_kernel_hedgehog__glu_gated_bilinear__prompt_kernel_f_rb:
s_or_b32 s37, s60, s62
s_cbranch_scc0 sequential_preLN__linear_kernel_hedgehog__glu_gated_bilinear__prompt_kernel_f_rd
s_bitcmp1_b32 s61, 0
s_mov_b32 s61, s62
s_cbranch_scc1 sequential_preLN__linear_kernel_hedgehog__glu_gated_bilinear__prompt_kernel_f_rw
s_waitcnt vmcnt(0)
sequential_preLN__linear_kernel_hedgehog__glu_gated_bilinear__prompt_kernel_f_rw:
s_waitcnt vmcnt(1)
s_cmp_lg_u32 s60, 0
s_cbranch_scc1 sequential_preLN__linear_kernel_hedgehog__glu_gated_bilinear__prompt_kernel_f_rl
s_mov_b32 s62, 0
s_branch sequential_preLN__linear_kernel_hedgehog__glu_gated_bilinear__prompt_kernel_f_ra
sequential_preLN__linear_kernel_hedgehog__glu_gated_bilinear__prompt_kernel_f_rd:
s_nop 0
v_pk_fma_f32 v[188:189], v[188:189], v[4:5], v[84:85] op_sel:[0,0,0] op_sel_hi:[1,0,1]
v_pk_fma_f32 v[190:191], v[190:191], v[4:5], v[86:87] op_sel:[0,0,0] op_sel_hi:[1,0,1]
v_pk_fma_f32 v[204:205], v[204:205], v[4:5], v[92:93] op_sel:[0,0,0] op_sel_hi:[1,0,1]
v_pk_fma_f32 v[206:207], v[206:207], v[4:5], v[94:95] op_sel:[0,0,0] op_sel_hi:[1,0,1]
v_cvt_pk_bf16_f32 v36, v188, v189
v_cvt_pk_bf16_f32 v37, v190, v191
v_cvt_pk_bf16_f32 v38, v204, v205
v_cvt_pk_bf16_f32 v39, v206, v207
s_nop 0
v_permlane16_swap_b32 v36, v38
v_permlane16_swap_b32 v37, v39
buffer_store_dwordx4 v[36:39], v103, s[24:27], s7 offen sc1
v_pk_fma_f32 v[192:193], v[192:193], v[4:5], v[88:89] op_sel:[0,1,0] op_sel_hi:[1,1,1]
v_pk_fma_f32 v[194:195], v[194:195], v[4:5], v[90:91] op_sel:[0,1,0] op_sel_hi:[1,1,1]
v_pk_fma_f32 v[208:209], v[208:209], v[4:5], v[96:97] op_sel:[0,1,0] op_sel_hi:[1,1,1]
v_pk_fma_f32 v[210:211], v[210:211], v[4:5], v[98:99] op_sel:[0,1,0] op_sel_hi:[1,1,1]
v_cvt_pk_bf16_f32 v40, v192, v193
v_cvt_pk_bf16_f32 v41, v194, v195
v_cvt_pk_bf16_f32 v42, v208, v209
v_cvt_pk_bf16_f32 v43, v210, v211
s_nop 0
v_permlane16_swap_b32 v40, v42
v_permlane16_swap_b32 v41, v43
buffer_store_dwordx4 v[40:43], v103, s[24:27], s97 offen sc1
sequential_preLN__linear_kernel_hedgehog__glu_gated_bilinear__prompt_kernel_end:
s_endpgm
sequential_preLN__linear_kernel_hedgehog__glu_gated_bilinear__prompt_kernel_f_slow4:
s_mov_b32 s54, 0x40000
sequential_preLN__linear_kernel_hedgehog__glu_gated_bilinear__prompt_kernel_f_spin4:
buffer_load_dword v23, v12, s[28:31], s98 offen offset:1024 sc1
s_waitcnt vmcnt(0)
v_cmp_eq_u32 vcc, 1, v23
s_sub_u32 s54, s54, 1
s_cmp_eq_u64 vcc, exec
s_cbranch_scc1 sequential_preLN__linear_kernel_hedgehog__glu_gated_bilinear__prompt_kernel_f_back4
s_cmp_lg_u32 s54, 0
s_cbranch_scc1 sequential_preLN__linear_kernel_hedgehog__glu_gated_bilinear__prompt_kernel_f_spin4
s_branch sequential_preLN__linear_kernel_hedgehog__glu_gated_bilinear__prompt_kernel_f_back4
sequential_preLN__linear_kernel_hedgehog__glu_gated_bilinear__prompt_kernel_f_slow3:
s_mov_b32 s54, 0x40000
sequential_preLN__linear_kernel_hedgehog__glu_gated_bilinear__prompt_kernel_f_spin3:
buffer_load_dword v23, v244, s[28:31], s99 offen sc1
s_waitcnt vmcnt(0)
v_cmp_eq_u32 vcc, 1, v23
s_sub_u32 s54, s54, 1
s_cmp_eq_u64 vcc, exec
s_cbranch_scc1 sequential_preLN__linear_kernel_hedgehog__glu_gated_bilinear__prompt_kernel_f_back3
s_cmp_lg_u32 s54, 0
s_cbranch_scc1 sequential_preLN__linear_kernel_hedgehog__glu_gated_bilinear__prompt_kernel_f_spin3
s_branch sequential_preLN__linear_kernel_hedgehog__glu_gated_bilinear__prompt_kernel_f_back3
sequential_preLN__linear_kernel_hedgehog__glu_gated_bilinear__prompt_kernel_f_slow0:
s_mov_b32 s54, 0x40000
sequential_preLN__linear_kernel_hedgehog__glu_gated_bilinear__prompt_kernel_f_spin0:
buffer_load_dword v23, v22, s[28:31], s50 offen offset:128 sc1
s_waitcnt vmcnt(0)
v_cmp_eq_u32 vcc, 1, v23
s_sub_u32 s54, s54, 1
s_cmp_eq_u64 vcc, exec
s_cbranch_scc1 sequential_preLN__linear_kernel_hedgehog__glu_gated_bilinear__prompt_kernel_f_back0
s_cmp_lg_u32 s54, 0
s_cbranch_scc1 sequential_preLN__linear_kernel_hedgehog__glu_gated_bilinear__prompt_kernel_f_spin0
s_branch sequential_preLN__linear_kernel_hedgehog__glu_gated_bilinear__prompt_kernel_f_back0
sequential_preLN__linear_kernel_hedgehog__glu_gated_bilinear__prompt_kernel_f_slow1:
s_mov_b32 s54, 0x40000
sequential_preLN__linear_kernel_hedgehog__glu_gated_bilinear__prompt_kernel_f_spin1:
buffer_load_dword v23, v22, s[28:31], s50 offen offset:256 sc1
s_waitcnt vmcnt(0)
v_cmp_eq_u32 vcc, 1, v23
s_sub_u32 s54, s54, 1
s_cmp_eq_u64 vcc, exec
s_cbranch_scc1 sequential_preLN__linear_kernel_hedgehog__glu_gated_bilinear__prompt_kernel_f_back1
s_cmp_lg_u32 s54, 0
s_cbranch_scc1 sequential_preLN__linear_kernel_hedgehog__glu_gated_bilinear__prompt_kernel_f_spin1
s_branch sequential_preLN__linear_kernel_hedgehog__glu_gated_bilinear__prompt_kernel_f_back1
sequential_preLN__linear_kernel_hedgehog__glu_gated_bilinear__prompt_kernel_f_slow2:
s_mov_b32 s54, 0x40000
sequential_preLN__linear_kernel_hedgehog__glu_gated_bilinear__prompt_kernel_f_spin2:
buffer_load_dword v23, v22, s[28:31], s50 offen offset:384 sc1
s_waitcnt vmcnt(0)
v_cmp_eq_u32 vcc, 1, v23
s_sub_u32 s54, s54, 1
s_cmp_eq_u64 vcc, exec
s_cbranch_scc1 sequential_preLN__linear_kernel_hedgehog__glu_gated_bilinear__prompt_kernel_f_back2
s_cmp_lg_u32 s54, 0
s_cbranch_scc1 sequential_preLN__linear_kernel_hedgehog__glu_gated_bilinear__prompt_kernel_f_spin2
s_branch sequential_preLN__linear_kernel_hedgehog__glu_gated_bilinear__prompt_kernel_f_back2
sequential_preLN__linear_kernel_hedgehog__glu_gated_bilinear__prompt_kernel_slow0:
s_mov_b32 s37, 0x40000
sequential_preLN__linear_kernel_hedgehog__glu_gated_bilinear__prompt_kernel_spin0:
buffer_load_dword v50, v49, s[24:27], 0 offen sc1
s_waitcnt vmcnt(0)
v_cmp_eq_u32 s[92:93], 1, v50
s_sub_u32 s37, s37, 1
s_cmp_eq_u64 s[92:93], exec
s_cbranch_scc1 sequential_preLN__linear_kernel_hedgehog__glu_gated_bilinear__prompt_kernel_back0
s_cmp_lg_u32 s37, 0
s_cbranch_scc1 sequential_preLN__linear_kernel_hedgehog__glu_gated_bilinear__prompt_kernel_spin0
s_branch sequential_preLN__linear_kernel_hedgehog__glu_gated_bilinear__prompt_kernel_back0
sequential_preLN__linear_kernel_hedgehog__glu_gated_bilinear__prompt_kernel_slow1:
s_mov_b32 s37, 0x40000
sequential_preLN__linear_kernel_hedgehog__glu_gated_bilinear__prompt_kernel_spin1:
buffer_load_dword v51, v46, s[28:31], s78 offen sc1
s_waitcnt vmcnt(0)
v_cmp_eq_u32 s[92:93], 1, v51
s_sub_u32 s37, s37, 1
s_cmp_eq_u64 s[92:93], exec
s_cbranch_scc1 sequential_preLN__linear_kernel_hedgehog__glu_gated_bilinear__prompt_kernel_back1
s_cmp_lg_u32 s37, 0
s_cbranch_scc1 sequential_preLN__linear_kernel_hedgehog__glu_gated_bilinear__prompt_kernel_spin1
s_branch sequential_preLN__linear_kernel_hedgehog__glu_gated_bilinear__prompt_kernel_back1
sequential_preLN__linear_kernel_hedgehog__glu_gated_bilinear__prompt_kernel_slow2:
s_mov_b64 s[76:77], 0
v_bfe_u32 v84, v1, 2, 1
v_lshrrev_b32 v85, 3, v1
v_lshl_add_u32 v84, v85, 3, v84
v_lshlrev_b32 v84, 12, v84
s_and_b32 s39, s2, 57
s_lshl_b32 s39, s39, 12
s_sub_u32 s39, s3, s39
s_mov_b32 s37, 0x40000
s_sub_u32 s45, s45, 73728
v_lshlrev_b32 v85, 3, v78
v_sub_u32 v29, v29, v85
v_sub_u32 v30, v30, v85
sequential_preLN__linear_kernel_hedgehog__glu_gated_bilinear__prompt_kernel_spin2b:
buffer_load_dword v51, v84, s[28:31], s39 offen offset:132 sc1
s_waitcnt vmcnt(0)
v_cmp_eq_u32 vcc, 1, v51
s_sub_u32 s37, s37, 1
s_cmp_eq_u64 vcc, exec
s_cbranch_scc1 sequential_preLN__linear_kernel_hedgehog__glu_gated_bilinear__prompt_kernel_back2b
s_cmp_lg_u32 s37, 0
s_cbranch_scc1 sequential_preLN__linear_kernel_hedgehog__glu_gated_bilinear__prompt_kernel_spin2b
sequential_preLN__linear_kernel_hedgehog__glu_gated_bilinear__prompt_kernel_back2b:
buffer_load_dwordx4 a[0:3], v5, s[28:31], s45 offen offset:0 sc1
buffer_load_dwordx4 a[4:7], v5, s[28:31], s45 offen offset:1024 sc1
s_add_u32 s45, s45, 4096
buffer_load_dwordx4 a[8:11], v5, s[28:31], s45 offen offset:0 sc1
buffer_load_dwordx4 a[12:15], v5, s[28:31], s45 offen offset:1024 sc1
s_add_u32 s45, s45, 4096
buffer_load_dwordx4 a[16:19], v5, s[28:31], s45 offen offset:0 sc1
buffer_load_dwordx4 a[20:23], v5, s[28:31], s45 offen offset:1024 sc1
s_add_u32 s45, s45, 4096
buffer_load_dwordx4 a[24:27], v5, s[28:31], s45 offen offset:0 sc1
buffer_load_dwordx4 a[28:31], v5, s[28:31], s45 offen offset:1024 sc1
s_add_u32 s45, s45, 4096
buffer_load_dwordx4 a[32:35], v5, s[28:31], s45 offen offset:0 sc1
buffer_load_dwordx4 a[36:39], v5, s[28:31], s45 offen offset:1024 sc1
s_add_u32 s45, s45, 4096
buffer_load_dwordx4 a[40:43], v5, s[28:31], s45 offen offset:0 sc1
buffer_load_dwordx4 a[44:47], v5, s[28:31], s45 offen offset:1024 sc1
s_add_u32 s45, s45, 4096
buffer_load_dwordx4 a[48:51], v5, s[28:31], s45 offen offset:0 sc1
buffer_load_dwordx4 a[52:55], v5, s[28:31], s45 offen offset:1024 sc1
s_add_u32 s45, s45, 4096
s_branch sequential_preLN__linear_kernel_hedgehog__glu_gated_bilinear__prompt_kernel_redo2
sequential_preLN__linear_kernel_hedgehog__glu_gated_bilinear__prompt_kernel_back1:
s_mov_b32 s50, s53
buffer_load_dwordx4 v[188:191], v59, s[28:31], s50 offen sc1
buffer_load_dwordx4 v[192:195], v59, s[28:31], s50 offen offset:3200 sc1
s_add_u32 s50, s50, 6400
buffer_load_dwordx4 v[196:199], v59, s[28:31], s50 offen sc1
buffer_load_dwordx4 v[200:203], v59, s[28:31], s50 offen offset:3200 sc1
s_add_u32 s50, s50, 6400
buffer_load_dwordx4 v[204:207], v59, s[28:31], s50 offen sc1
buffer_load_dwordx4 v[208:211], v59, s[28:31], s50 offen offset:3200 sc1
s_add_u32 s50, s50, 6400
buffer_load_dwordx4 v[212:215], v59, s[28:31], s50 offen sc1
buffer_load_dwordx4 v[216:219], v59, s[28:31], s50 offen offset:3200 sc1
s_add_u32 s50, s50, 6400
buffer_load_dwordx4 v[220:223], v59, s[28:31], s50 offen sc1
buffer_load_dwordx4 v[224:227], v59, s[28:31], s50 offen offset:3200 sc1
s_add_u32 s50, s50, 6400
buffer_load_dwordx4 v[228:231], v59, s[28:31], s50 offen sc1
buffer_load_dwordx4 v[232:235], v59, s[28:31], s50 offen offset:3200 sc1
s_add_u32 s50, s50, 6400
buffer_load_dwordx4 v[236:239], v59, s[28:31], s50 offen sc1
buffer_load_dwordx4 v[240:243], v59, s[28:31], s50 offen offset:3200 sc1
s_add_u32 s50, s50, 6400
buffer_load_dwordx4 v[244:247], v59, s[28:31], s50 offen sc1
buffer_load_dwordx4 v[248:251], v59, s[28:31], s50 offen offset:3200 sc1
s_branch sequential_preLN__linear_kernel_hedgehog__glu_gated_bilinear__prompt_kernel_back1b

code_end:
.section .rodata,"a"
.p2align 6
.amdhsa_kernel sequential_preLN__linear_kernel_hedgehog__glu_gated_bilinear__prompt_kernel
  .amdhsa_next_free_vgpr 512
  .amdhsa_next_free_sgpr 102
  .amdhsa_accum_offset 256
  .amdhsa_group_segment_fixed_size 0
  .amdhsa_kernarg_size 88
  .amdhsa_user_sgpr_count 2
  .amdhsa_user_sgpr_kernarg_segment_ptr 1
  .amdhsa_system_sgpr_workgroup_id_x 1
  .amdhsa_float_denorm_mode_32 3
.end_amdhsa_kernel
```
